```python
import torch

def _softmax(x, axis=-1):
    return torch.softmax(x, dim=axis)
def _gelu(x):
    return torch.nn.functional.gelu(x, approximate="tanh")
def _silu(x):
    return torch.nn.functional.silu(x)
def _sigmoid(x):
    return torch.sigmoid(x)
def _layernorm(x, axis=-1, eps=1e-5):
    m = x.mean(dim=axis, keepdim=True)
    v = x.var(dim=axis, keepdim=True, unbiased=False)
    return (x - m) / torch.sqrt(v + eps)
def _scatter_add(tgt, idx, src, axis=0):
    return tgt.clone().index_add_(axis, idx, src)
def _segment_sum(src, seg, n):
    out = torch.zeros((n,) + src.shape[1:], dtype=src.dtype)
    return out.index_add_(0, seg, src)
def _pad(x, pw):
    flat = tuple(v for pair in reversed(pw) for v in pair)
    return torch.nn.functional.pad(x, flat)

kernel_name = 'gated_mix__linear_attn_block__glu_gated_bilinear__prompt'

def setup_inputs():

    _w = (lambda a: (lambda t: t.to(torch.bfloat16) if t.is_floating_point() else t)(torch.as_tensor(a)))
    def _A_setup():
        B, S, D = 1, 2048, 576
        return {
            "x": _w((lambda *s: torch.randn(*s, dtype=torch.bfloat16) * 0.05)(B, S, D)),
            "wqkv": _w((lambda *s: torch.randn(*s, dtype=torch.bfloat16) * 0.8)(D, 3 * D)),
            "wo": _w((lambda *s: torch.randn(*s, dtype=torch.bfloat16) * 0.05)(D, D)),
        }
    _A_in = _A_setup()

    def _B_setup():
        B, S, D, F = 1, 2048, 576, 4608
        return {
            "x": _w((lambda *s: torch.randn(*s, dtype=torch.bfloat16) * 0.05)(B, S, D)),
            "w_gate": _w((lambda *s: torch.randn(*s, dtype=torch.bfloat16) * 1.6)(D, F) * (D ** -0.5)),
            "w_up": _w((lambda *s: torch.randn(*s, dtype=torch.bfloat16) * 1.6)(D, F) * (D ** -0.5)),
            "w_down": _w((lambda *s: torch.randn(*s, dtype=torch.bfloat16) * 1.6)(F, D) * (F ** -0.5)),
        }
    _B_in = _B_setup()

    return {
        "A_x": _A_in["x"],
        "A_wqkv": _A_in["wqkv"],
        "A_wo": _A_in["wo"],
        "B_x": _B_in["x"],
        "B_w_gate": _B_in["w_gate"],
        "B_w_up": _B_in["w_up"],
        "B_w_down": _B_in["w_down"],
        "gate_w": _w((lambda *s: torch.randn(*s, dtype=torch.bfloat16) * 0.05)(576) * 16.0),
    }

def reference(A_x, A_wqkv, A_wo, B_x, B_w_gate, B_w_up, B_w_down, gate_w):
    def _A_ref(x, wqkv, wo):
        B, S, D = x.shape
        H = 32; Dh = D // H
        qkv = (lambda x, *d: x.permute(*d))((x @ wqkv).reshape(B, S, 3, H, Dh), 2, 0, 3, 1, 4)
        q, k, v = qkv[0], qkv[1], qkv[2]
        phi = lambda t: torch.where(t > 0, t + 1, torch.exp(t)) + 1e-6
        pq, pk = phi(q), phi(k)
        kv = torch.einsum("bhsd,bhse->bhde", pk, v)
        z = torch.einsum("bhsd->bhd", pk)
        num = torch.einsum("bhqd,bhde->bhqe", pq, kv)
        den = torch.einsum("bhqd,bhd->bhq", pq, z)[..., None] + 1e-6
        o = num / den
        return (lambda x, *d: x.permute(*d))(o, 0, 2, 1, 3).reshape(B, S, D) @ wo

    def _B_ref(x, w_gate, w_up, w_down):
        g = torch.einsum("bsd,df->bsf", x, w_gate)
        u = torch.einsum("bsd,df->bsf", x, w_up)
        h = g * u
        return torch.einsum("bsf,fd->bsd", h, w_down)

    x = A_x
    g = _sigmoid((x * gate_w).sum(-1, keepdims=True))
    a = _A_ref(x, A_wqkv, A_wo)
    b = _B_ref(x, B_w_gate, B_w_up, B_w_down)
    return g * a + (1 - g) * b
```

```asm
; @launch grid=(256,1,1) block=(256,1,1) lds=163840
.amdgcn_target "amdgcn-amd-amdhsa--gfx950"
.text
.globl gated_mix__linear_attn_block__glu_gated_bilinear__prompt_kernel
.p2align 8
.type gated_mix__linear_attn_block__glu_gated_bilinear__prompt_kernel,@function
gated_mix__linear_attn_block__glu_gated_bilinear__prompt_kernel:
  s_load_dwordx2 s[16:17], s[0:1], 32
  s_load_dwordx2 s[20:21], s[0:1], 40
  s_load_dwordx2 s[4:5], s[0:1], 0
  s_load_dwordx2 s[28:29], s[0:1], 56
  s_load_dwordx2 s[8:9], s[0:1], 8
  s_load_dwordx2 s[12:13], s[0:1], 16
  s_load_dwordx2 s[24:25], s[0:1], 48
  s_load_dwordx2 s[32:33], s[0:1], 64
  s_load_dwordx2 s[36:37], s[0:1], 72
  s_load_dwordx2 s[40:41], s[0:1], 80
  s_cmp_ge_u32 s2, 256
  s_cbranch_scc1 L_end
  v_lshrrev_b32 v1, 6, v0
  v_and_b32 v0, 63, v0
  v_readfirstlane_b32 s48, v1
  s_lshr_b32 s54, s2, 3
  s_and_b32 s56, s2, 1
  s_bfe_u32 s51, s2, 0x20001
  s_lshl_b32 s49, s56, 2
  s_and_b32 s53, s54, 3
  s_add_u32 s49, s49, s53
  s_lshr_b32 s57, s54, 2
  s_lshl_b32 s50, s51, 3
  s_add_u32 s50, s50, s57
  s_lshl_b32 s52, s56, 3
  s_add_u32 s52, s52, s57
  s_lshl_b32 s60, s48, 13
  s_lshl_b32 s63, s48, 10
  s_lshr_b32 s57, s57, 1
  s_mul_i32 s57, s57, 1
  s_mul_i32 s58, s53, 3
  s_add_u32 s57, s57, s58
  s_mul_i32 s56, s56, 1
  s_add_u32 s56, s56, s57
  s_mul_i32 s58, s56, 57
  s_lshr_b32 s58, s58, 9
  s_mul_i32 s58, s58, 9
  s_sub_u32 s86, s56, s58
  s_lshl_b32 s59, s86, 7
  s_lshr_b32 s91, s50, 2
  s_mul_i32 s91, s91, 1152
  s_and_b32 s58, s50, 3
  s_lshl_b32 s90, s58, 8
  s_add_u32 s90, s90, s91
  v_lshrrev_b32 v44, 3, v0
  v_lshrrev_b32 v45, 4, v0
  v_and_b32 v25, 7, v0
  s_lshl_b32 s56, s48, 3
  v_add_u32 v24, s56, v44
  v_mul_u32_u24 v24, 9216, v24
  v_add_u32 v24, s90, v24
  s_and_b32 s56, s48, 1
  s_lshl_b32 s56, s56, 1
  v_and_b32 v26, 1, v45
  v_or_b32 v26, s56, v26
  v_lshrrev_b32 v27, 1, v25
  v_xor_b32 v26, v26, v27
  v_lshl_add_u32 v24, v26, 5, v24
  v_and_b32 v28, 1, v0
  v_lshl_add_u32 v3, v28, 4, v24
  v_add_u32 v20, 294912, v3
  s_lshl_b32 s56, s49, 8
  s_lshl_b32 s57, s48, 6
  s_add_u32 s56, s56, s57
  v_add_u32 v24, s56, v44
  v_mul_u32_u24 v24, 1152, v24
  v_xor_b32 v26, v25, v45
  v_lshl_add_u32 v21, v26, 4, v24
  v_add_u32 v1, s59, v21
  v_xor_b32 v2, 64, v1
  s_mov_b32 s18, 5308416
  s_mov_b32 s19, 0x20000
  s_mov_b32 s22, 5308416
  s_mov_b32 s23, 0x20000
  s_mov_b32 s6, 2359296
  s_mov_b32 s7, 0x20000
  s_mov_b32 s65, 9216
  s_mov_b32 s66, 18432
  s_mov_b32 s67, 27648
  s_mov_b32 s68, 36864
  s_mov_b32 s69, 46080
  s_mov_b32 s70, 55296
  s_mov_b32 s71, 64512
  s_waitcnt lgkmcnt(0)
  s_add_u32 m0, s63, 98304
  s_mul_i32 s56, s86, 589824
  buffer_load_dwordx4 v3, s[16:19], s56 offen lds
  s_add_u32 m0, s63, 106496
  s_nop 0
  buffer_load_dwordx4 v3, s[20:23], s56 offen lds
  s_add_u32 m0, s63, 102400
  s_nop 0
  buffer_load_dwordx4 v20, s[16:19], s56 offen lds
  s_add_u32 m0, s63, 110592
  s_nop 0
  buffer_load_dwordx4 v20, s[20:23], s56 offen lds
  s_mov_b32 s30, 1152
  s_mov_b32 s31, 0x20000
  s_mov_b32 s10, 1990656
  s_mov_b32 s11, 0x20000
  s_mov_b32 s14, 681984
  s_mov_b32 s15, 0x20000
  s_mov_b32 s26, 5308416
  s_mov_b32 s27, 0x20000
  s_mov_b32 s34, 2359296
  s_mov_b32 s35, 0x20000
  s_mov_b32 s38, 256
  s_mov_b32 s39, 0x20000
  s_mov_b32 s42, 42991616
  s_mov_b32 s43, 0x20000
  s_add_u32 s87, s86, 1
  s_cmp_eq_u32 s87, 9
  s_cselect_b32 s87, 0, s87
  v_lshlrev_b32 v24, 4, v0
  v_add_u32 v24, s63, v24
  v_add_u32 v25, s59, v24
  v_subrev_u32 v26, 1152, v25
  v_min_u32 v25, v25, v26
  v_cmp_gt_u32 vcc, 1152, v24
  v_bfe_u32 v46, v0, 2, 2
  v_and_b32 v47, 3, v0
  s_add_u32 m0, s60, 0
  v_cndmask_b32 v24, v24, v25, vcc
  buffer_load_dwordx4 v1, s[4:7], 0 offen lds
  s_bitcmp1_b32 s48, 0
  s_cselect_b32 s44, s20, s16
  s_cselect_b32 s45, s21, s17
  s_mov_b32 s46, 5308416
  s_mov_b32 s47, 0x20000
  s_sub_u32 s12, s12, 18432
  s_subb_u32 s13, s13, 0
  s_add_u32 s3, s87, 1
  s_cmp_eq_u32 s3, 9
  s_cselect_b32 s3, 0, s3
  s_add_u32 s100, s3, 1
  s_cmp_eq_u32 s100, 9
  s_cselect_b32 s100, 0, s100
  s_add_u32 s101, s100, 1
  s_cmp_eq_u32 s101, 9
  s_cselect_b32 s101, 0, s101
  s_add_u32 m0, s60, 1024
  s_nop 0
  buffer_load_dwordx4 v2, s[4:7], s65 offen lds
  s_add_u32 s97, s101, 1
  s_cmp_eq_u32 s97, 9
  s_cselect_b32 s97, 0, s97
  s_add_u32 s88, s97, 1
  s_cmp_eq_u32 s88, 9
  s_cselect_b32 s88, 0, s88
  s_add_u32 s89, s88, 1
  s_cmp_eq_u32 s89, 9
  s_cselect_b32 s89, 0, s89
  s_add_u32 s1, s89, 1
  s_cmp_eq_u32 s1, 9
  s_cselect_b32 s1, 0, s1
  s_lshl_b32 s62, s48, 8
  s_and_b32 s83, s48, 1
  s_lshl_b32 s83, s83, 11
  s_add_u32 m0, s60, 2048
  s_nop 0
  buffer_load_dwordx4 v1, s[4:7], s66 offen lds
  s_lshr_b32 s84, s48, 1
  s_lshl_b32 s84, s84, 10
  s_add_u32 s61, s83, s84
  s_and_b32 s83, s50, 3
  s_lshl_b32 s83, s83, 5
  s_add_u32 s91, s91, s83
  s_add_u32 s91, s91, 1024
  s_add_u32 m0, s60, 3072
  s_nop 0
  buffer_load_dwordx4 v2, s[4:7], s67 offen lds
  s_lshl_b32 s55, s49, 5
  s_add_u32 s55, s55, s50
  s_lshl_b32 s55, s55, 7
  s_add_u32 s55, s55, 22544384
  v_lshl_add_u32 v29, v45, 3, v46
  v_lshlrev_b32 v30, 7, v29
  s_add_u32 m0, s60, 4096
  v_lshl_add_u32 v30, v47, 3, v30
  buffer_load_dwordx4 v1, s[4:7], s68 offen lds
  v_add_u32 v30, 98304, v30
  v_lshrrev_b32 v31, 1, v46
  v_and_b32 v32, 1, v45
  v_lshl_or_b32 v31, v32, 1, v31
  v_xor_b32 v33, 0, v31
  v_lshl_add_u32 v4, v33, 5, v30
  s_add_u32 m0, s60, 5120
  v_xor_b32 v33, 1, v31
  buffer_load_dwordx4 v2, s[4:7], s69 offen lds
  v_lshl_add_u32 v5, v33, 5, v30
  v_xor_b32 v33, 2, v31
  v_lshl_add_u32 v6, v33, 5, v30
  v_xor_b32 v33, 3, v31
  v_lshl_add_u32 v7, v33, 5, v30
  v_and_b32 v33, 15, v0
  s_add_u32 m0, s60, 6144
  v_lshrrev_b32 v34, 1, v33
  buffer_load_dwordx4 v1, s[4:7], s70 offen lds
  v_xor_b32 v34, v34, v45
  v_lshlrev_b32 v35, 7, v33
  v_add_u32 v35, s60, v35
  v_lshl_add_u32 v8, v34, 4, v35
  v_xor_b32 v9, 64, v8
  v_lshlrev_b32 v10, 4, v45
  s_add_u32 m0, s60, 7168
  v_add_u32 v10, 147456, v10
  buffer_load_dwordx4 v2, s[4:7], s71 offen lds
  s_lshl_b32 s83, s51, 7
  s_lshl_b32 s84, s49, 4
  s_add_u32 s83, s83, s84
  s_lshl_b32 s84, s48, 2
  s_add_u32 s83, s83, s84
  s_mul_i32 s83, s83, 40960
  s_and_b32 s77, s50, 7
  v_lshl_add_u32 v1, s87, 7, v21
  v_xor_b32 v2, 64, v1
  s_lshl_b32 s77, s77, 10
  s_add_u32 s83, s83, s77
  v_lshl_add_u32 v11, v0, 4, s83
  s_xor_b32 s0, s50, 0
  s_mul_i32 s84, s50, 36
  s_mul_i32 s83, s0, 36
  s_add_u32 m0, s63, 147456
  v_mov_b32 v38, s83
  buffer_load_dwordx4 v24, s[28:31], 0 offen lds
  v_mov_b32 v39, s84
  s_lshl_b32 s83, s48, 6
  s_add_u32 s83, s83, 0
  v_add_u32 v33, s83, v0
  v_mul_u32_u24 v34, 7282, v33
  v_lshrrev_b32 v34, 16, v34
  s_add_u32 m0, s60, 32768
  v_mul_u32_u24 v35, 9, v34
  buffer_load_dwordx4 v1, s[4:7], 0 offen lds
  v_sub_u32 v35, v33, v35
  v_mul_u32_u24 v36, 21846, v35
  v_lshrrev_b32 v36, 16, v36
  v_cmp_gt_u32 vcc, 3, v35
  v_mul_u32_u24 v37, 3, v36
  v_sub_u32 v37, v35, v37
  s_add_u32 m0, s60, 33792
  v_cndmask_b32 v35, v39, v38, vcc
  buffer_load_dwordx4 v2, s[4:7], s65 offen lds
  v_mul_u32_u24 v34, 3456, v34
  v_mul_u32_u24 v36, 1152, v36
  v_lshl_add_u32 v37, v37, 4, v35
  v_add3_u32 v12, v34, v36, v37
  s_lshl_b32 s83, s48, 6
  s_add_u32 s83, s83, 256
  s_add_u32 m0, s60, 34816
  v_add_u32 v33, s83, v0
  buffer_load_dwordx4 v1, s[4:7], s66 offen lds
  v_mul_u32_u24 v34, 7282, v33
  v_lshrrev_b32 v34, 16, v34
  v_mul_u32_u24 v35, 9, v34
  v_sub_u32 v35, v33, v35
  v_mul_u32_u24 v36, 21846, v35
  v_lshrrev_b32 v36, 16, v36
  s_add_u32 m0, s60, 35840
  v_cmp_gt_u32 vcc, 3, v35
  buffer_load_dwordx4 v2, s[4:7], s67 offen lds
  v_mul_u32_u24 v37, 3, v36
  v_sub_u32 v37, v35, v37
  v_cndmask_b32 v35, v39, v38, vcc
  v_mul_u32_u24 v34, 3456, v34
  v_mul_u32_u24 v36, 1152, v36
  v_lshl_add_u32 v37, v37, 4, v35
  s_add_u32 m0, s60, 36864
  v_add3_u32 v22, v34, v36, v37
  buffer_load_dwordx4 v1, s[4:7], s68 offen lds
  s_lshl_b32 s83, s48, 4
  s_add_u32 s83, s83, 512
  v_add_u32 v33, s83, v0
  v_mul_u32_u24 v34, 7282, v33
  v_lshrrev_b32 v34, 16, v34
  v_mul_u32_u24 v35, 9, v34
  s_add_u32 m0, s60, 37888
  v_sub_u32 v35, v33, v35
  buffer_load_dwordx4 v2, s[4:7], s69 offen lds
  v_mul_u32_u24 v36, 21846, v35
  v_lshrrev_b32 v36, 16, v36
  v_cmp_gt_u32 vcc, 3, v35
  v_mul_u32_u24 v37, 3, v36
  v_sub_u32 v37, v35, v37
  v_cndmask_b32 v35, v39, v38, vcc
  s_add_u32 m0, s60, 38912
  v_mul_u32_u24 v34, 3456, v34
  buffer_load_dwordx4 v1, s[4:7], s70 offen lds
  v_mul_u32_u24 v36, 1152, v36
  v_lshl_add_u32 v37, v37, 4, v35
  v_add3_u32 v23, v34, v36, v37
  v_lshrrev_b32 v34, 5, v0
  v_bfe_u32 v35, v0, 3, 2
  v_bfe_u32 v36, v0, 1, 2
  s_add_u32 m0, s60, 39936
  v_lshl_add_u32 v36, v34, 2, v36
  buffer_load_dwordx4 v2, s[4:7], s71 offen lds
  v_lshl_add_u32 v36, v35, 3, v36
  s_lshr_b32 s83, s48, 1
  s_lshl_b32 s83, s83, 5
  v_add_u32 v36, s83, v36
  v_mul_u32_u24 v36, 9216, v36
  v_add_u32 v36, s91, v36
  v_and_b32 v37, 1, v0
  v_lshl_add_u32 v1, s3, 7, v21
  v_xor_b32 v2, 64, v1
  v_lshl_add_u32 v13, v37, 4, v36
  v_mul_u32_u24 v34, 144, v29
  v_add_u32 v34, 65536, v34
  v_lshl_add_u32 v14, v47, 3, v34
  v_mul_u32_u24 v35, 48, v47
  v_add_u32 v35, 80, v35
  v_cmp_gt_u32 vcc, 2, v47
  s_add_u32 m0, s63, 114688
  s_mul_i32 s56, s87, 589824
  buffer_load_dwordx4 v3, s[16:19], s56 offen lds
  v_mov_b32 v36, 32
  v_lshlrev_b32 v16, 3, v0
  v_cndmask_b32 v35, v36, v35, vcc
  v_add_u32 v15, v34, v35
  v_add_u32 v16, 122880, v16
  s_lshr_b32 s83, s48, 1
  s_lshl_b32 s83, s83, 2
  s_add_u32 m0, s63, 122880
  s_mul_i32 s56, s87, 589824
  buffer_load_dwordx4 v3, s[20:23], s56 offen lds
  v_add_u32 v34, s83, v29
  v_mul_u32_u24 v34, 9216, v34
  s_add_u32 s83, s90, 128
  v_add_u32 v34, s83, v34
  v_lshrrev_b32 v35, 1, v47
  v_xor_b32 v35, v35, v32
  v_lshl_add_u32 v34, v35, 5, v34
  s_add_u32 m0, s63, 118784
  s_mul_i32 s56, s87, 589824
  buffer_load_dwordx4 v20, s[16:19], s56 offen lds
  v_lshl_add_u32 v17, v37, 4, v34
  v_lshrrev_b32 v34, 2, v0
  v_lshlrev_b32 v34, 6, v34
  v_lshl_add_u32 v34, v47, 3, v34
  v_add_u32 v34, 122880, v34
  v_lshl_add_u32 v18, v32, 5, v34
  v_xor_b32 v19, 32, v18
  s_add_u32 m0, s63, 126976
  s_mul_i32 s56, s87, 589824
  buffer_load_dwordx4 v20, s[20:23], s56 offen lds
  v_cmp_eq_u32 s[78:79], 2, v47
  s_mul_i32 s64, s48, 9216
  v_add_u32 v63, 294912, v17
  v_lshlrev_b32 v59, 10, v0
  s_getpc_b64 s[58:59]
L_pc:
  s_lshl_b32 s83, s54, 2
  s_add_u32 s83, s83, s48
  s_lshl_b32 s83, s83, 2
  v_and_b32 v25, 3, v0
  v_add_lshl_u32 v25, v25, s83, 7
  v_min_u32 v25, L_end-L_pc, v25
  global_load_dword v224, v25, s[58:59]
  s_or_b32 s83, s2, s48
  s_cbranch_scc1 L_n0_1
  v_lshlrev_b32 v196, 7, v0
  s_mov_b32 s83, 22544384
  buffer_load_dwordx4 v[208:211], v196, s[40:43], s83 offen sc1
  s_add_u32 s83, s83, 8192
  buffer_load_dwordx4 v[212:215], v196, s[40:43], s83 offen sc1
  s_add_u32 s83, s83, 8192
  buffer_load_dwordx4 v[216:219], v196, s[40:43], s83 offen sc1
  s_add_u32 s83, s83, 8192
  buffer_load_dwordx4 v[220:223], v196, s[40:43], s83 offen sc1
L_n0_1:
  s_waitcnt vmcnt(14)
  ds_read_b128 a[0:3], v8 offset:0
  ds_read_b128 a[4:7], v8 offset:2048
  ds_read_b128 a[8:11], v8 offset:4096
  ds_read_b128 a[12:15], v8 offset:6144
  ds_read_b128 a[16:19], v9 offset:0
  ds_read_b128 a[20:23], v9 offset:2048
  ds_read_b128 a[24:27], v9 offset:4096
  ds_read_b128 a[28:31], v9 offset:6144
  v_add_u32 v8, 32768, v8
  v_add_u32 v9, 32768, v9
  s_waitcnt vmcnt(13)
  s_barrier
  ds_read_b64_tr_b16 v[24:25], v4 offset:0
  ds_read_b64_tr_b16 v[26:27], v4 offset:512
  ds_read_b64_tr_b16 v[28:29], v4 offset:4096
  ds_read_b64_tr_b16 v[30:31], v4 offset:4608
  ds_read_b64_tr_b16 v[32:33], v4 offset:8192
  ds_read_b64_tr_b16 v[34:35], v4 offset:8704
  ds_read_b64_tr_b16 v[36:37], v4 offset:12288
  ds_read_b64_tr_b16 v[38:39], v4 offset:12800
  s_waitcnt lgkmcnt(4)
  v_mfma_f32_16x16x32_bf16 v[64:67], v[24:27], a[0:3], 0
  s_add_u32 m0, s60, 0
  ds_read_b64_tr_b16 v[40:41], v5 offset:0
  v_mfma_f32_16x16x32_bf16 v[64:67], v[28:31], a[16:19], v[64:67]
  buffer_load_dwordx4 v1, s[4:7], 0 offen lds
  v_mfma_f32_16x16x32_bf16 v[68:71], v[24:27], a[4:7], 0
  s_add_u32 m0, s60, 1024
  ds_read_b64_tr_b16 v[42:43], v5 offset:512
  v_mfma_f32_16x16x32_bf16 v[68:71], v[28:31], a[20:23], v[68:71]
  buffer_load_dwordx4 v2, s[4:7], s65 offen lds
  v_mfma_f32_16x16x32_bf16 v[72:75], v[24:27], a[8:11], 0
  s_add_u32 m0, s60, 2048
  ds_read_b64_tr_b16 v[44:45], v5 offset:4096
  v_mfma_f32_16x16x32_bf16 v[72:75], v[28:31], a[24:27], v[72:75]
  buffer_load_dwordx4 v1, s[4:7], s66 offen lds
  v_mfma_f32_16x16x32_bf16 v[76:79], v[24:27], a[12:15], 0
  s_add_u32 m0, s60, 3072
  ds_read_b64_tr_b16 v[46:47], v5 offset:4608
  v_mfma_f32_16x16x32_bf16 v[76:79], v[28:31], a[28:31], v[76:79]
  s_waitcnt lgkmcnt(4)
  v_mfma_f32_16x16x32_bf16 v[80:83], v[32:35], a[0:3], 0
  ds_read_b64_tr_b16 v[24:25], v5 offset:8192
  v_mfma_f32_16x16x32_bf16 v[80:83], v[36:39], a[16:19], v[80:83]
  ds_read_b64_tr_b16 v[26:27], v5 offset:8704
  v_mfma_f32_16x16x32_bf16 v[84:87], v[32:35], a[4:7], 0
  buffer_load_dwordx4 v2, s[4:7], s67 offen lds
  v_mfma_f32_16x16x32_bf16 v[84:87], v[36:39], a[20:23], v[84:87]
  s_add_u32 m0, s60, 4096
  ds_read_b64_tr_b16 v[28:29], v5 offset:12288
  v_mfma_f32_16x16x32_bf16 v[88:91], v[32:35], a[8:11], 0
  ds_read_b64_tr_b16 v[30:31], v5 offset:12800
  v_mfma_f32_16x16x32_bf16 v[88:91], v[36:39], a[24:27], v[88:91]
  v_mfma_f32_16x16x32_bf16 v[92:95], v[32:35], a[12:15], 0
  v_mfma_f32_16x16x32_bf16 v[92:95], v[36:39], a[28:31], v[92:95]
  s_waitcnt lgkmcnt(4)
  v_mfma_f32_16x16x32_bf16 v[96:99], v[40:43], a[0:3], 0
  buffer_load_dwordx4 v1, s[4:7], s68 offen lds
  v_mfma_f32_16x16x32_bf16 v[96:99], v[44:47], a[16:19], v[96:99]
  s_add_u32 m0, s60, 5120
  ds_read_b64_tr_b16 v[32:33], v6 offset:0
  v_mfma_f32_16x16x32_bf16 v[100:103], v[40:43], a[4:7], 0
  ds_read_b64_tr_b16 v[34:35], v6 offset:512
  v_mfma_f32_16x16x32_bf16 v[100:103], v[44:47], a[20:23], v[100:103]
  buffer_load_dwordx4 v2, s[4:7], s69 offen lds
  v_mfma_f32_16x16x32_bf16 v[104:107], v[40:43], a[8:11], 0
  s_add_u32 m0, s60, 6144
  ds_read_b64_tr_b16 v[36:37], v6 offset:4096
  v_mfma_f32_16x16x32_bf16 v[104:107], v[44:47], a[24:27], v[104:107]
  ds_read_b64_tr_b16 v[38:39], v6 offset:4608
  v_mfma_f32_16x16x32_bf16 v[108:111], v[40:43], a[12:15], 0
  v_mfma_f32_16x16x32_bf16 v[108:111], v[44:47], a[28:31], v[108:111]
  s_waitcnt lgkmcnt(4)
  v_mfma_f32_16x16x32_bf16 v[112:115], v[24:27], a[0:3], 0
  buffer_load_dwordx4 v1, s[4:7], s70 offen lds
  v_mfma_f32_16x16x32_bf16 v[112:115], v[28:31], a[16:19], v[112:115]
  s_add_u32 m0, s60, 7168
  ds_read_b64_tr_b16 v[40:41], v6 offset:8192
  v_lshl_add_u32 v1, s100, 7, v21
  v_mfma_f32_16x16x32_bf16 v[116:119], v[24:27], a[4:7], 0
  ds_read_b64_tr_b16 v[42:43], v6 offset:8704
  v_mfma_f32_16x16x32_bf16 v[116:119], v[28:31], a[20:23], v[116:119]
  ds_read_b64_tr_b16 v[44:45], v6 offset:12288
  v_mfma_f32_16x16x32_bf16 v[120:123], v[24:27], a[8:11], 0
  ds_read_b64_tr_b16 v[46:47], v6 offset:12800
  v_mfma_f32_16x16x32_bf16 v[120:123], v[28:31], a[24:27], v[120:123]
  buffer_load_dwordx4 v2, s[4:7], s71 offen lds
  v_mfma_f32_16x16x32_bf16 v[124:127], v[24:27], a[12:15], 0
  s_add_u32 m0, s63, 131072
  s_mul_i32 s56, s3, 589824
  v_xor_b32 v2, 64, v1
  v_mfma_f32_16x16x32_bf16 v[124:127], v[28:31], a[28:31], v[124:127]
  s_waitcnt lgkmcnt(4)
  v_mfma_f32_16x16x32_bf16 v[128:131], v[32:35], a[0:3], 0
  ds_read_b64_tr_b16 v[24:25], v7 offset:0
  v_mfma_f32_16x16x32_bf16 v[128:131], v[36:39], a[16:19], v[128:131]
  ds_read_b64_tr_b16 v[26:27], v7 offset:512
  buffer_load_dwordx4 v3, s[16:19], s56 offen lds
  v_mfma_f32_16x16x32_bf16 v[132:135], v[32:35], a[4:7], 0
  s_add_u32 m0, s63, 139264
  ds_read_b64_tr_b16 v[28:29], v7 offset:4096
  v_mfma_f32_16x16x32_bf16 v[132:135], v[36:39], a[20:23], v[132:135]
  s_waitcnt vmcnt(14)
  ds_read_b64_tr_b16 v[30:31], v7 offset:4608
  v_mfma_f32_16x16x32_bf16 v[136:139], v[32:35], a[8:11], 0
  ds_read_b128 a[32:35], v8 offset:0
  v_mfma_f32_16x16x32_bf16 v[136:139], v[36:39], a[24:27], v[136:139]
  ds_read_b128 a[36:39], v8 offset:2048
  v_mfma_f32_16x16x32_bf16 v[140:143], v[32:35], a[12:15], 0
  ds_read_b128 a[40:43], v8 offset:4096
  buffer_load_dwordx4 v3, s[20:23], s56 offen lds
  v_mfma_f32_16x16x32_bf16 v[140:143], v[36:39], a[28:31], v[140:143]
  s_waitcnt lgkmcnt(7)
  s_add_u32 m0, s63, 135168
  v_mfma_f32_16x16x32_bf16 v[144:147], v[40:43], a[0:3], 0
  ds_read_b128 a[44:47], v8 offset:6144
  v_subrev_u32 v8, 32768, v8
  v_mfma_f32_16x16x32_bf16 v[144:147], v[44:47], a[16:19], v[144:147]
  ds_read_b128 a[48:51], v9 offset:0
  v_mfma_f32_16x16x32_bf16 v[148:151], v[40:43], a[4:7], 0
  ds_read_b128 a[52:55], v9 offset:2048
  buffer_load_dwordx4 v20, s[16:19], s56 offen lds
  v_mfma_f32_16x16x32_bf16 v[148:151], v[44:47], a[20:23], v[148:151]
  s_add_u32 m0, s63, 143360
  ds_read_b128 a[56:59], v9 offset:4096
  v_mfma_f32_16x16x32_bf16 v[152:155], v[40:43], a[8:11], 0
  ds_read_b128 a[60:63], v9 offset:6144
  v_subrev_u32 v9, 32768, v9
  v_mfma_f32_16x16x32_bf16 v[152:155], v[44:47], a[24:27], v[152:155]
  ds_read_b64_tr_b16 v[32:33], v7 offset:8192
  v_mfma_f32_16x16x32_bf16 v[156:159], v[40:43], a[12:15], 0
  ds_read_b64_tr_b16 v[34:35], v7 offset:8704
  v_mfma_f32_16x16x32_bf16 v[156:159], v[44:47], a[28:31], v[156:159]
  ds_read_b64_tr_b16 v[36:37], v7 offset:12288
  ds_read_b64_tr_b16 v[38:39], v7 offset:12800
  s_waitcnt lgkmcnt(12)
  s_waitcnt lgkmcnt(0) vmcnt(12)
  s_barrier
  v_mfma_f32_16x16x32_bf16 v[160:163], v[24:27], a[0:3], 0
  buffer_load_dwordx4 v20, s[20:23], s56 offen lds
  v_mfma_f32_16x16x32_bf16 v[160:163], v[28:31], a[16:19], v[160:163]
  s_add_u32 m0, s60, 32768
  ds_read_b64_tr_b16 v[40:41], v4 offset:16384
  v_mfma_f32_16x16x32_bf16 v[164:167], v[24:27], a[4:7], 0
  ds_read_b64_tr_b16 v[42:43], v4 offset:16896
  v_mfma_f32_16x16x32_bf16 v[164:167], v[28:31], a[20:23], v[164:167]
  buffer_load_dwordx4 v1, s[4:7], 0 offen lds
  v_mfma_f32_16x16x32_bf16 v[168:171], v[24:27], a[8:11], 0
  s_add_u32 m0, s60, 33792
  ds_read_b64_tr_b16 v[44:45], v4 offset:20480
  v_mfma_f32_16x16x32_bf16 v[168:171], v[28:31], a[24:27], v[168:171]
  ds_read_b64_tr_b16 v[46:47], v4 offset:20992
  v_mfma_f32_16x16x32_bf16 v[172:175], v[24:27], a[12:15], 0
  v_mfma_f32_16x16x32_bf16 v[172:175], v[28:31], a[28:31], v[172:175]
  s_waitcnt lgkmcnt(4)
  v_mfma_f32_16x16x32_bf16 v[176:179], v[32:35], a[0:3], 0
  buffer_load_dwordx4 v2, s[4:7], s65 offen lds
  v_mfma_f32_16x16x32_bf16 v[176:179], v[36:39], a[16:19], v[176:179]
  s_add_u32 m0, s60, 34816
  ds_read_b64_tr_b16 v[24:25], v4 offset:24576
  v_mfma_f32_16x16x32_bf16 v[180:183], v[32:35], a[4:7], 0
  ds_read_b64_tr_b16 v[26:27], v4 offset:25088
  v_mfma_f32_16x16x32_bf16 v[180:183], v[36:39], a[20:23], v[180:183]
  ds_read_b64_tr_b16 v[28:29], v4 offset:28672
  v_mfma_f32_16x16x32_bf16 v[184:187], v[32:35], a[8:11], 0
  buffer_load_dwordx4 v1, s[4:7], s66 offen lds
  v_mfma_f32_16x16x32_bf16 v[184:187], v[36:39], a[24:27], v[184:187]
  s_add_u32 m0, s60, 35840
  ds_read_b64_tr_b16 v[30:31], v4 offset:29184
  v_mfma_f32_16x16x32_bf16 v[188:191], v[32:35], a[12:15], 0
  v_mfma_f32_16x16x32_bf16 v[188:191], v[36:39], a[28:31], v[188:191]
  s_waitcnt lgkmcnt(4)
  v_mfma_f32_16x16x32_bf16 v[64:67], v[40:43], a[32:35], v[64:67]
  ds_read_b64_tr_b16 v[32:33], v5 offset:16384
  v_mfma_f32_16x16x32_bf16 v[64:67], v[44:47], a[48:51], v[64:67]
  buffer_load_dwordx4 v2, s[4:7], s67 offen lds
  v_mfma_f32_16x16x32_bf16 v[68:71], v[40:43], a[36:39], v[68:71]
  s_add_u32 m0, s60, 36864
  ds_read_b64_tr_b16 v[34:35], v5 offset:16896
  v_mfma_f32_16x16x32_bf16 v[68:71], v[44:47], a[52:55], v[68:71]
  ds_read_b64_tr_b16 v[36:37], v5 offset:20480
  v_mfma_f32_16x16x32_bf16 v[72:75], v[40:43], a[40:43], v[72:75]
  ds_read_b64_tr_b16 v[38:39], v5 offset:20992
  v_mfma_f32_16x16x32_bf16 v[72:75], v[44:47], a[56:59], v[72:75]
  buffer_load_dwordx4 v1, s[4:7], s68 offen lds
  v_mfma_f32_16x16x32_bf16 v[76:79], v[40:43], a[44:47], v[76:79]
  s_add_u32 m0, s60, 37888
  v_mfma_f32_16x16x32_bf16 v[76:79], v[44:47], a[60:63], v[76:79]
  s_waitcnt lgkmcnt(4)
  v_mfma_f32_16x16x32_bf16 v[80:83], v[24:27], a[32:35], v[80:83]
  ds_read_b64_tr_b16 v[40:41], v5 offset:24576
  v_mfma_f32_16x16x32_bf16 v[80:83], v[28:31], a[48:51], v[80:83]
  ds_read_b64_tr_b16 v[42:43], v5 offset:25088
  v_mfma_f32_16x16x32_bf16 v[84:87], v[24:27], a[36:39], v[84:87]
  buffer_load_dwordx4 v2, s[4:7], s69 offen lds
  v_mfma_f32_16x16x32_bf16 v[84:87], v[28:31], a[52:55], v[84:87]
  s_add_u32 m0, s60, 38912
  ds_read_b64_tr_b16 v[44:45], v5 offset:28672
  v_mfma_f32_16x16x32_bf16 v[88:91], v[24:27], a[40:43], v[88:91]
  ds_read_b64_tr_b16 v[46:47], v5 offset:29184
  v_mfma_f32_16x16x32_bf16 v[88:91], v[28:31], a[56:59], v[88:91]
  v_mfma_f32_16x16x32_bf16 v[92:95], v[24:27], a[44:47], v[92:95]
  v_mfma_f32_16x16x32_bf16 v[92:95], v[28:31], a[60:63], v[92:95]
  s_waitcnt lgkmcnt(4) vmcnt(10)
  v_mfma_f32_16x16x32_bf16 v[96:99], v[32:35], a[32:35], v[96:99]
  buffer_load_dwordx4 v1, s[4:7], s70 offen lds
  v_mfma_f32_16x16x32_bf16 v[96:99], v[36:39], a[48:51], v[96:99]
  s_add_u32 m0, s60, 39936
  ds_read_b64_tr_b16 v[24:25], v6 offset:16384
  v_lshl_add_u32 v1, s101, 7, v21
  v_mfma_f32_16x16x32_bf16 v[100:103], v[32:35], a[36:39], v[100:103]
  ds_read_b64_tr_b16 v[26:27], v6 offset:16896
  v_mfma_f32_16x16x32_bf16 v[100:103], v[36:39], a[52:55], v[100:103]
  ds_read_b64_tr_b16 v[28:29], v6 offset:20480
  v_mfma_f32_16x16x32_bf16 v[104:107], v[32:35], a[40:43], v[104:107]
  buffer_load_dwordx4 v2, s[4:7], s71 offen lds
  v_mfma_f32_16x16x32_bf16 v[104:107], v[36:39], a[56:59], v[104:107]
  s_add_u32 m0, s63, 98304
  s_mul_i32 s56, s100, 589824
  v_xor_b32 v2, 64, v1
  v_mfma_f32_16x16x32_bf16 v[108:111], v[32:35], a[44:47], v[108:111]
  ds_read_b64_tr_b16 v[30:31], v6 offset:20992
  v_mfma_f32_16x16x32_bf16 v[108:111], v[36:39], a[60:63], v[108:111]
  s_waitcnt lgkmcnt(4)
  ds_read_b128 a[64:67], v8 offset:0
  v_mfma_f32_16x16x32_bf16 v[112:115], v[40:43], a[32:35], v[112:115]
  buffer_load_dwordx4 v3, s[16:19], s56 offen lds
  v_mfma_f32_16x16x32_bf16 v[112:115], v[44:47], a[48:51], v[112:115]
  s_add_u32 m0, s63, 106496
  ds_read_b128 a[68:71], v8 offset:2048
  v_mfma_f32_16x16x32_bf16 v[116:119], v[40:43], a[36:39], v[116:119]
  ds_read_b128 a[72:75], v8 offset:4096
  v_mfma_f32_16x16x32_bf16 v[116:119], v[44:47], a[52:55], v[116:119]
  ds_read_b64_tr_b16 v[32:33], v6 offset:24576
  v_mfma_f32_16x16x32_bf16 v[120:123], v[40:43], a[40:43], v[120:123]
  ds_read_b64_tr_b16 v[34:35], v6 offset:25088
  v_mfma_f32_16x16x32_bf16 v[120:123], v[44:47], a[56:59], v[120:123]
  buffer_load_dwordx4 v3, s[20:23], s56 offen lds
  v_mfma_f32_16x16x32_bf16 v[124:127], v[40:43], a[44:47], v[124:127]
  s_add_u32 m0, s63, 102400
  ds_read_b64_tr_b16 v[36:37], v6 offset:28672
  v_mfma_f32_16x16x32_bf16 v[124:127], v[44:47], a[60:63], v[124:127]
  s_waitcnt lgkmcnt(6)
  ds_read_b64_tr_b16 v[38:39], v6 offset:29184
  v_mfma_f32_16x16x32_bf16 v[128:131], v[24:27], a[32:35], v[128:131]
  ds_read_b128 a[76:79], v8 offset:6144
  v_mfma_f32_16x16x32_bf16 v[128:131], v[28:31], a[48:51], v[128:131]
  ds_read_b128 a[80:83], v9 offset:0
  v_mfma_f32_16x16x32_bf16 v[132:135], v[24:27], a[36:39], v[132:135]
  ds_read_b128 a[84:87], v9 offset:2048
  buffer_load_dwordx4 v20, s[16:19], s56 offen lds
  v_mfma_f32_16x16x32_bf16 v[132:135], v[28:31], a[52:55], v[132:135]
  s_add_u32 m0, s63, 110592
  ds_read_b128 a[88:91], v9 offset:4096
  v_mfma_f32_16x16x32_bf16 v[136:139], v[24:27], a[40:43], v[136:139]
  ds_read_b64_tr_b16 v[40:41], v7 offset:16384
  v_add_u32 v8, 32768, v8
  v_mfma_f32_16x16x32_bf16 v[136:139], v[28:31], a[56:59], v[136:139]
  ds_read_b64_tr_b16 v[42:43], v7 offset:16896
  v_mfma_f32_16x16x32_bf16 v[140:143], v[24:27], a[44:47], v[140:143]
  ds_read_b64_tr_b16 v[44:45], v7 offset:20480
  buffer_load_dwordx4 v20, s[20:23], s56 offen lds
  v_mfma_f32_16x16x32_bf16 v[140:143], v[28:31], a[60:63], v[140:143]
  s_waitcnt lgkmcnt(7)
  ds_read_b64_tr_b16 v[46:47], v7 offset:20992
  v_mfma_f32_16x16x32_bf16 v[144:147], v[32:35], a[32:35], v[144:147]
  s_add_u32 m0, s63, 65536
  s_mul_i32 s57, s86, 221184
  v_mfma_f32_16x16x32_bf16 v[144:147], v[36:39], a[48:51], v[144:147]
  ds_read_b128 a[92:95], v9 offset:6144
  v_add_u32 v9, 32768, v9
  v_mfma_f32_16x16x32_bf16 v[148:151], v[32:35], a[36:39], v[148:151]
  ds_read_b64_tr_b16 v[24:25], v7 offset:24576
  v_mfma_f32_16x16x32_bf16 v[148:151], v[36:39], a[52:55], v[148:151]
  buffer_load_dwordx4 v12, s[8:11], s57 offen lds
  v_mfma_f32_16x16x32_bf16 v[152:155], v[32:35], a[40:43], v[152:155]
  s_add_u32 m0, s63, 69632
  ds_read_b64_tr_b16 v[26:27], v7 offset:25088
  v_mfma_f32_16x16x32_bf16 v[152:155], v[36:39], a[56:59], v[152:155]
  ds_read_b64_tr_b16 v[28:29], v7 offset:28672
  v_mfma_f32_16x16x32_bf16 v[156:159], v[32:35], a[44:47], v[156:159]
  ds_read_b64_tr_b16 v[30:31], v7 offset:29184
  v_mfma_f32_16x16x32_bf16 v[156:159], v[36:39], a[60:63], v[156:159]
  s_waitcnt lgkmcnt(5)
  s_waitcnt lgkmcnt(0) vmcnt(13)
  s_barrier
  v_mfma_f32_16x16x32_bf16 v[160:163], v[40:43], a[32:35], v[160:163]
  s_or_b32 s83, s2, s48
  s_cbranch_scc1 L_n1_2
  s_waitcnt vmcnt(25)
  v_lshrrev_b32 v208, 3, v208
  v_lshrrev_b32 v209, 3, v209
  v_lshrrev_b32 v210, 3, v210
  v_lshrrev_b32 v211, 3, v211
  v_lshrrev_b32 v212, 3, v212
  v_lshrrev_b32 v213, 3, v213
  v_lshrrev_b32 v214, 3, v214
  v_lshrrev_b32 v215, 3, v215
  v_lshrrev_b32 v216, 3, v216
  v_lshrrev_b32 v217, 3, v217
  v_lshrrev_b32 v218, 3, v218
  v_lshrrev_b32 v219, 3, v219
  v_lshrrev_b32 v220, 3, v220
  v_lshrrev_b32 v221, 3, v221
  v_lshrrev_b32 v222, 3, v222
  v_lshrrev_b32 v223, 3, v223
  s_mov_b32 s83, 0
L_n2_3:
  s_add_u32 s83, s83, 1
  v_cmp_eq_u32 vcc, s83, v208
  v_cmp_eq_u32 s[58:59], s83, v209
  s_nop 1
  s_or_b64 vcc, vcc, s[58:59]
  v_cmp_eq_u32 s[58:59], s83, v210
  s_nop 1
  s_or_b64 vcc, vcc, s[58:59]
  v_cmp_eq_u32 s[58:59], s83, v211
  s_nop 1
  s_or_b64 vcc, vcc, s[58:59]
  v_cmp_eq_u32 s[58:59], s83, v212
  s_nop 1
  s_or_b64 vcc, vcc, s[58:59]
  v_cmp_eq_u32 s[58:59], s83, v213
  s_nop 1
  s_or_b64 vcc, vcc, s[58:59]
  v_cmp_eq_u32 s[58:59], s83, v214
  s_nop 1
  s_or_b64 vcc, vcc, s[58:59]
  v_cmp_eq_u32 s[58:59], s83, v215
  s_nop 1
  s_or_b64 vcc, vcc, s[58:59]
  v_cmp_eq_u32 s[58:59], s83, v216
  s_nop 1
  s_or_b64 vcc, vcc, s[58:59]
  v_cmp_eq_u32 s[58:59], s83, v217
  s_nop 1
  s_or_b64 vcc, vcc, s[58:59]
  v_cmp_eq_u32 s[58:59], s83, v218
  s_nop 1
  s_or_b64 vcc, vcc, s[58:59]
  v_cmp_eq_u32 s[58:59], s83, v219
  s_nop 1
  s_or_b64 vcc, vcc, s[58:59]
  v_cmp_eq_u32 s[58:59], s83, v220
  s_nop 1
  s_or_b64 vcc, vcc, s[58:59]
  v_cmp_eq_u32 s[58:59], s83, v221
  s_nop 1
  s_or_b64 vcc, vcc, s[58:59]
  v_cmp_eq_u32 s[58:59], s83, v222
  s_nop 1
  s_or_b64 vcc, vcc, s[58:59]
  v_cmp_eq_u32 s[58:59], s83, v223
  s_nop 1
  s_or_b64 vcc, vcc, s[58:59]
  s_cbranch_scc1 L_n2_3
  s_lshl_b32 s83, s83, 3
  v_mov_b32 v208, s83
  s_mov_b64 exec, 1
  buffer_store_dword v208, off, s[36:39], 0 sc1
  s_mov_b64 exec, -1
L_n1_2:
  v_mfma_f32_16x16x32_bf16 v[160:163], v[44:47], a[48:51], v[160:163]
  s_add_u32 m0, s60, 0
  ds_read_b64_tr_b16 v[32:33], v4 offset:32768
  v_mfma_f32_16x16x32_bf16 v[164:167], v[40:43], a[36:39], v[164:167]
  ds_read_b64_tr_b16 v[34:35], v4 offset:33280
  v_mfma_f32_16x16x32_bf16 v[164:167], v[44:47], a[52:55], v[164:167]
  ds_read_b64_tr_b16 v[36:37], v4 offset:36864
  v_mfma_f32_16x16x32_bf16 v[168:171], v[40:43], a[40:43], v[168:171]
  buffer_load_dwordx4 v1, s[4:7], 0 offen lds
  v_mfma_f32_16x16x32_bf16 v[168:171], v[44:47], a[56:59], v[168:171]
  s_add_u32 m0, s60, 1024
  ds_read_b64_tr_b16 v[38:39], v4 offset:37376
  v_mfma_f32_16x16x32_bf16 v[172:175], v[40:43], a[44:47], v[172:175]
  v_mfma_f32_16x16x32_bf16 v[172:175], v[44:47], a[60:63], v[172:175]
  s_waitcnt lgkmcnt(4)
  v_mfma_f32_16x16x32_bf16 v[176:179], v[24:27], a[32:35], v[176:179]
  ds_read_b64_tr_b16 v[40:41], v4 offset:40960
  v_mfma_f32_16x16x32_bf16 v[176:179], v[28:31], a[48:51], v[176:179]
  buffer_load_dwordx4 v2, s[4:7], s65 offen lds
  v_mfma_f32_16x16x32_bf16 v[180:183], v[24:27], a[36:39], v[180:183]
  s_add_u32 m0, s60, 2048
  ds_read_b64_tr_b16 v[42:43], v4 offset:41472
  v_mfma_f32_16x16x32_bf16 v[180:183], v[28:31], a[52:55], v[180:183]
  ds_read_b64_tr_b16 v[44:45], v4 offset:45056
  v_mfma_f32_16x16x32_bf16 v[184:187], v[24:27], a[40:43], v[184:187]
  ds_read_b64_tr_b16 v[46:47], v4 offset:45568
  v_mfma_f32_16x16x32_bf16 v[184:187], v[28:31], a[56:59], v[184:187]
  v_mfma_f32_16x16x32_bf16 v[188:191], v[24:27], a[44:47], v[188:191]
  buffer_load_dwordx4 v1, s[4:7], s66 offen lds
  v_mfma_f32_16x16x32_bf16 v[188:191], v[28:31], a[60:63], v[188:191]
  s_waitcnt lgkmcnt(4)
  s_add_u32 m0, s60, 3072
  v_mfma_f32_16x16x32_bf16 v[64:67], v[32:35], a[64:67], v[64:67]
  ds_read_b64_tr_b16 v[24:25], v5 offset:32768
  v_mfma_f32_16x16x32_bf16 v[64:67], v[36:39], a[80:83], v[64:67]
  ds_read_b64_tr_b16 v[26:27], v5 offset:33280
  v_mfma_f32_16x16x32_bf16 v[68:71], v[32:35], a[68:71], v[68:71]
  ds_read_b64_tr_b16 v[28:29], v5 offset:36864
  v_mfma_f32_16x16x32_bf16 v[68:71], v[36:39], a[84:87], v[68:71]
  buffer_load_dwordx4 v2, s[4:7], s67 offen lds
  v_mfma_f32_16x16x32_bf16 v[72:75], v[32:35], a[72:75], v[72:75]
  s_add_u32 m0, s60, 4096
  ds_read_b64_tr_b16 v[30:31], v5 offset:37376
  v_mfma_f32_16x16x32_bf16 v[72:75], v[36:39], a[88:91], v[72:75]
  v_mfma_f32_16x16x32_bf16 v[76:79], v[32:35], a[76:79], v[76:79]
  v_mfma_f32_16x16x32_bf16 v[76:79], v[36:39], a[92:95], v[76:79]
  s_waitcnt lgkmcnt(4)
  v_mfma_f32_16x16x32_bf16 v[80:83], v[40:43], a[64:67], v[80:83]
  buffer_load_dwordx4 v1, s[4:7], s68 offen lds
  v_mfma_f32_16x16x32_bf16 v[80:83], v[44:47], a[80:83], v[80:83]
  s_add_u32 m0, s60, 5120
  ds_read_b64_tr_b16 v[32:33], v5 offset:40960
  v_mfma_f32_16x16x32_bf16 v[84:87], v[40:43], a[68:71], v[84:87]
  ds_read_b64_tr_b16 v[34:35], v5 offset:41472
  v_mfma_f32_16x16x32_bf16 v[84:87], v[44:47], a[84:87], v[84:87]
  ds_read_b64_tr_b16 v[36:37], v5 offset:45056
  v_mfma_f32_16x16x32_bf16 v[88:91], v[40:43], a[72:75], v[88:91]
  buffer_load_dwordx4 v2, s[4:7], s69 offen lds
  v_mfma_f32_16x16x32_bf16 v[88:91], v[44:47], a[88:91], v[88:91]
  s_add_u32 m0, s60, 6144
  ds_read_b64_tr_b16 v[38:39], v5 offset:45568
  v_mfma_f32_16x16x32_bf16 v[92:95], v[40:43], a[76:79], v[92:95]
  v_mfma_f32_16x16x32_bf16 v[92:95], v[44:47], a[92:95], v[92:95]
  s_waitcnt lgkmcnt(4) vmcnt(11)
  v_mfma_f32_16x16x32_bf16 v[96:99], v[24:27], a[64:67], v[96:99]
  ds_read_b64_tr_b16 v[40:41], v6 offset:32768
  v_mfma_f32_16x16x32_bf16 v[96:99], v[28:31], a[80:83], v[96:99]
  buffer_load_dwordx4 v1, s[4:7], s70 offen lds
  v_mfma_f32_16x16x32_bf16 v[100:103], v[24:27], a[68:71], v[100:103]
  s_add_u32 m0, s60, 7168
  ds_read_b64_tr_b16 v[42:43], v6 offset:33280
  v_lshl_add_u32 v1, s97, 7, v21
  v_mfma_f32_16x16x32_bf16 v[100:103], v[28:31], a[84:87], v[100:103]
  ds_read_b64_tr_b16 v[44:45], v6 offset:36864
  v_mfma_f32_16x16x32_bf16 v[104:107], v[24:27], a[72:75], v[104:107]
  ds_read_b64_tr_b16 v[46:47], v6 offset:37376
  v_mfma_f32_16x16x32_bf16 v[104:107], v[28:31], a[88:91], v[104:107]
  buffer_load_dwordx4 v2, s[4:7], s71 offen lds
  v_mfma_f32_16x16x32_bf16 v[108:111], v[24:27], a[76:79], v[108:111]
  s_add_u32 m0, s63, 114688
  s_mul_i32 s56, s101, 589824
  v_xor_b32 v2, 64, v1
  v_mfma_f32_16x16x32_bf16 v[108:111], v[28:31], a[92:95], v[108:111]
  s_waitcnt lgkmcnt(4)
  ds_read_b128 a[96:99], v8 offset:0
  v_mfma_f32_16x16x32_bf16 v[112:115], v[32:35], a[64:67], v[112:115]
  ds_read_b128 a[100:103], v8 offset:2048
  v_mfma_f32_16x16x32_bf16 v[112:115], v[36:39], a[80:83], v[112:115]
  ds_read_b128 a[104:107], v8 offset:4096
  v_mfma_f32_16x16x32_bf16 v[116:119], v[32:35], a[68:71], v[116:119]
  buffer_load_dwordx4 v3, s[16:19], s56 offen lds
  v_mfma_f32_16x16x32_bf16 v[116:119], v[36:39], a[84:87], v[116:119]
  s_add_u32 m0, s63, 122880
  ds_read_b64_tr_b16 v[24:25], v6 offset:40960
  v_mfma_f32_16x16x32_bf16 v[120:123], v[32:35], a[72:75], v[120:123]
  ds_read_b64_tr_b16 v[26:27], v6 offset:41472
  v_mfma_f32_16x16x32_bf16 v[120:123], v[36:39], a[88:91], v[120:123]
  ds_read_b64_tr_b16 v[28:29], v6 offset:45056
  v_mfma_f32_16x16x32_bf16 v[124:127], v[32:35], a[76:79], v[124:127]
  ds_read_b64_tr_b16 v[30:31], v6 offset:45568
  v_mfma_f32_16x16x32_bf16 v[124:127], v[36:39], a[92:95], v[124:127]
  s_waitcnt lgkmcnt(7)
  ds_read_b128 a[108:111], v8 offset:6144
  v_mfma_f32_16x16x32_bf16 v[128:131], v[40:43], a[64:67], v[128:131]
  buffer_load_dwordx4 v3, s[20:23], s56 offen lds
  v_mfma_f32_16x16x32_bf16 v[128:131], v[44:47], a[80:83], v[128:131]
  s_add_u32 m0, s63, 118784
  ds_read_b128 a[112:115], v9 offset:0
  v_mfma_f32_16x16x32_bf16 v[132:135], v[40:43], a[68:71], v[132:135]
  ds_read_b128 a[116:119], v9 offset:2048
  v_mfma_f32_16x16x32_bf16 v[132:135], v[44:47], a[84:87], v[132:135]
  ds_read_b128 a[120:123], v9 offset:4096
  v_mfma_f32_16x16x32_bf16 v[136:139], v[40:43], a[72:75], v[136:139]
  ds_read_b64_tr_b16 v[32:33], v7 offset:32768
  buffer_load_dwordx4 v20, s[16:19], s56 offen lds
  v_mfma_f32_16x16x32_bf16 v[136:139], v[44:47], a[88:91], v[136:139]
  s_add_u32 m0, s63, 126976
  ds_read_b64_tr_b16 v[34:35], v7 offset:33280
  v_subrev_u32 v8, 32768, v8
  v_mfma_f32_16x16x32_bf16 v[140:143], v[40:43], a[76:79], v[140:143]
  ds_read_b64_tr_b16 v[36:37], v7 offset:36864
  v_mfma_f32_16x16x32_bf16 v[140:143], v[44:47], a[92:95], v[140:143]
  s_waitcnt lgkmcnt(7)
  ds_read_b64_tr_b16 v[38:39], v7 offset:37376
  v_mfma_f32_16x16x32_bf16 v[144:147], v[24:27], a[64:67], v[144:147]
  buffer_load_dwordx4 v20, s[20:23], s56 offen lds
  v_mfma_f32_16x16x32_bf16 v[144:147], v[28:31], a[80:83], v[144:147]
  s_add_u32 m0, s63, 69632
  ds_read_b128 a[124:127], v9 offset:6144
  v_subrev_u32 v9, 32768, v9
  v_mfma_f32_16x16x32_bf16 v[148:151], v[24:27], a[68:71], v[148:151]
  ds_read_b64_tr_b16 v[40:41], v7 offset:40960
  v_mfma_f32_16x16x32_bf16 v[148:151], v[28:31], a[84:87], v[148:151]
  ds_read_b64_tr_b16 v[42:43], v7 offset:41472
  v_mfma_f32_16x16x32_bf16 v[152:155], v[24:27], a[72:75], v[152:155]
  ds_read_b64_tr_b16 v[44:45], v7 offset:45056
  v_mfma_f32_16x16x32_bf16 v[152:155], v[28:31], a[88:91], v[152:155]
  buffer_load_dwordx4 v22, s[8:11], s57 offen lds
  v_mfma_f32_16x16x32_bf16 v[156:159], v[24:27], a[76:79], v[156:159]
  s_add_u32 m0, s62, 73728
  ds_read_b64_tr_b16 v[46:47], v7 offset:45568
  v_mfma_f32_16x16x32_bf16 v[156:159], v[28:31], a[92:95], v[156:159]
  s_waitcnt lgkmcnt(5)
  s_waitcnt lgkmcnt(0) vmcnt(14)
  s_barrier
  v_mfma_f32_16x16x32_bf16 v[160:163], v[32:35], a[64:67], v[160:163]
  s_add_u32 m0, s60, 32768
  ds_read_b64_tr_b16 v[24:25], v4 offset:0
  v_mfma_f32_16x16x32_bf16 v[160:163], v[36:39], a[80:83], v[160:163]
  ds_read_b64_tr_b16 v[26:27], v4 offset:512
  v_mfma_f32_16x16x32_bf16 v[164:167], v[32:35], a[68:71], v[164:167]
  ds_read_b64_tr_b16 v[28:29], v4 offset:4096
  v_mfma_f32_16x16x32_bf16 v[164:167], v[36:39], a[84:87], v[164:167]
  ds_read_b64_tr_b16 v[30:31], v4 offset:4608
  v_mfma_f32_16x16x32_bf16 v[168:171], v[32:35], a[72:75], v[168:171]
  v_mfma_f32_16x16x32_bf16 v[168:171], v[36:39], a[88:91], v[168:171]
  v_mfma_f32_16x16x32_bf16 v[172:175], v[32:35], a[76:79], v[172:175]
  v_mfma_f32_16x16x32_bf16 v[172:175], v[36:39], a[92:95], v[172:175]
  s_waitcnt lgkmcnt(4)
  v_mfma_f32_16x16x32_bf16 v[176:179], v[40:43], a[64:67], v[176:179]
  buffer_load_dwordx4 v1, s[4:7], 0 offen lds
  v_mfma_f32_16x16x32_bf16 v[176:179], v[44:47], a[80:83], v[176:179]
  s_add_u32 m0, s60, 33792
  ds_read_b64_tr_b16 v[32:33], v4 offset:8192
  v_mfma_f32_16x16x32_bf16 v[180:183], v[40:43], a[68:71], v[180:183]
  ds_read_b64_tr_b16 v[34:35], v4 offset:8704
  v_mfma_f32_16x16x32_bf16 v[180:183], v[44:47], a[84:87], v[180:183]
  buffer_load_dwordx4 v2, s[4:7], s65 offen lds
  v_mfma_f32_16x16x32_bf16 v[184:187], v[40:43], a[72:75], v[184:187]
  s_add_u32 m0, s60, 34816
  ds_read_b64_tr_b16 v[36:37], v4 offset:12288
  v_mfma_f32_16x16x32_bf16 v[184:187], v[44:47], a[88:91], v[184:187]
  ds_read_b64_tr_b16 v[38:39], v4 offset:12800
  v_mfma_f32_16x16x32_bf16 v[188:191], v[40:43], a[76:79], v[188:191]
  v_mfma_f32_16x16x32_bf16 v[188:191], v[44:47], a[92:95], v[188:191]
  s_waitcnt lgkmcnt(4)
  v_mfma_f32_16x16x32_bf16 v[64:67], v[24:27], a[96:99], v[64:67]
  buffer_load_dwordx4 v1, s[4:7], s66 offen lds
  v_mfma_f32_16x16x32_bf16 v[64:67], v[28:31], a[112:115], v[64:67]
  s_add_u32 m0, s60, 35840
  ds_read_b64_tr_b16 v[40:41], v5 offset:0
  v_mfma_f32_16x16x32_bf16 v[68:71], v[24:27], a[100:103], v[68:71]
  ds_read_b64_tr_b16 v[42:43], v5 offset:512
  v_mfma_f32_16x16x32_bf16 v[68:71], v[28:31], a[116:119], v[68:71]
  ds_read_b64_tr_b16 v[44:45], v5 offset:4096
  v_mfma_f32_16x16x32_bf16 v[72:75], v[24:27], a[104:107], v[72:75]
  ds_read_b64_tr_b16 v[46:47], v5 offset:4608
  v_mfma_f32_16x16x32_bf16 v[72:75], v[28:31], a[120:123], v[72:75]
  buffer_load_dwordx4 v2, s[4:7], s67 offen lds
  v_mfma_f32_16x16x32_bf16 v[76:79], v[24:27], a[108:111], v[76:79]
  s_add_u32 m0, s60, 36864
  v_mfma_f32_16x16x32_bf16 v[76:79], v[28:31], a[124:127], v[76:79]
  s_waitcnt lgkmcnt(4)
  v_mfma_f32_16x16x32_bf16 v[80:83], v[32:35], a[96:99], v[80:83]
  ds_read_b64_tr_b16 v[24:25], v5 offset:8192
  v_mfma_f32_16x16x32_bf16 v[80:83], v[36:39], a[112:115], v[80:83]
  buffer_load_dwordx4 v1, s[4:7], s68 offen lds
  v_mfma_f32_16x16x32_bf16 v[84:87], v[32:35], a[100:103], v[84:87]
  s_add_u32 m0, s60, 37888
  ds_read_b64_tr_b16 v[26:27], v5 offset:8704
  v_mfma_f32_16x16x32_bf16 v[84:87], v[36:39], a[116:119], v[84:87]
  ds_read_b64_tr_b16 v[28:29], v5 offset:12288
  v_mfma_f32_16x16x32_bf16 v[88:91], v[32:35], a[104:107], v[88:91]
  ds_read_b64_tr_b16 v[30:31], v5 offset:12800
  v_mfma_f32_16x16x32_bf16 v[88:91], v[36:39], a[120:123], v[88:91]
  v_mfma_f32_16x16x32_bf16 v[92:95], v[32:35], a[108:111], v[92:95]
  buffer_load_dwordx4 v2, s[4:7], s69 offen lds
  v_mfma_f32_16x16x32_bf16 v[92:95], v[36:39], a[124:127], v[92:95]
  s_waitcnt lgkmcnt(4)
  s_add_u32 m0, s60, 38912
  s_waitcnt vmcnt(11)
  v_mfma_f32_16x16x32_bf16 v[96:99], v[40:43], a[96:99], v[96:99]
  ds_read_b64_tr_b16 v[32:33], v6 offset:0
  v_mfma_f32_16x16x32_bf16 v[96:99], v[44:47], a[112:115], v[96:99]
  ds_read_b64_tr_b16 v[34:35], v6 offset:512
  v_mfma_f32_16x16x32_bf16 v[100:103], v[40:43], a[100:103], v[100:103]
  ds_read_b64_tr_b16 v[36:37], v6 offset:4096
  v_mfma_f32_16x16x32_bf16 v[100:103], v[44:47], a[116:119], v[100:103]
  buffer_load_dwordx4 v1, s[4:7], s70 offen lds
  v_mfma_f32_16x16x32_bf16 v[104:107], v[40:43], a[104:107], v[104:107]
  s_add_u32 m0, s60, 39936
  ds_read_b64_tr_b16 v[38:39], v6 offset:4608
  v_lshl_add_u32 v1, s88, 7, v21
  v_mfma_f32_16x16x32_bf16 v[104:107], v[44:47], a[120:123], v[104:107]
  ds_read_b128 a[128:131], v8 offset:0
  v_mfma_f32_16x16x32_bf16 v[108:111], v[40:43], a[108:111], v[108:111]
  ds_read_b128 a[132:135], v8 offset:2048
  v_mfma_f32_16x16x32_bf16 v[108:111], v[44:47], a[124:127], v[108:111]
  s_waitcnt lgkmcnt(6)
  ds_read_b128 a[136:139], v8 offset:4096
  v_mfma_f32_16x16x32_bf16 v[112:115], v[24:27], a[96:99], v[112:115]
  buffer_load_dwordx4 v2, s[4:7], s71 offen lds
  v_mfma_f32_16x16x32_bf16 v[112:115], v[28:31], a[112:115], v[112:115]
  s_add_u32 m0, s63, 131072
  s_mul_i32 s56, s97, 589824
  v_xor_b32 v2, 64, v1
  v_mfma_f32_16x16x32_bf16 v[116:119], v[24:27], a[100:103], v[116:119]
  ds_read_b64_tr_b16 v[40:41], v6 offset:8192
  v_mfma_f32_16x16x32_bf16 v[116:119], v[28:31], a[116:119], v[116:119]
  ds_read_b64_tr_b16 v[42:43], v6 offset:8704
  v_mfma_f32_16x16x32_bf16 v[120:123], v[24:27], a[104:107], v[120:123]
  buffer_load_dwordx4 v3, s[16:19], s56 offen lds
  v_mfma_f32_16x16x32_bf16 v[120:123], v[28:31], a[120:123], v[120:123]
  s_add_u32 m0, s63, 139264
  ds_read_b64_tr_b16 v[44:45], v6 offset:12288
  v_mfma_f32_16x16x32_bf16 v[124:127], v[24:27], a[108:111], v[124:127]
  ds_read_b64_tr_b16 v[46:47], v6 offset:12800
  v_mfma_f32_16x16x32_bf16 v[124:127], v[28:31], a[124:127], v[124:127]
  s_waitcnt lgkmcnt(7)
  ds_read_b128 a[140:143], v8 offset:6144
  v_mfma_f32_16x16x32_bf16 v[128:131], v[32:35], a[96:99], v[128:131]
  ds_read_b128 a[144:147], v9 offset:0
  v_mfma_f32_16x16x32_bf16 v[128:131], v[36:39], a[112:115], v[128:131]
  buffer_load_dwordx4 v3, s[20:23], s56 offen lds
  v_mfma_f32_16x16x32_bf16 v[132:135], v[32:35], a[100:103], v[132:135]
  s_add_u32 m0, s63, 135168
  ds_read_b128 a[148:151], v9 offset:2048
  v_mfma_f32_16x16x32_bf16 v[132:135], v[36:39], a[116:119], v[132:135]
  ds_read_b128 a[152:155], v9 offset:4096
  v_mfma_f32_16x16x32_bf16 v[136:139], v[32:35], a[104:107], v[136:139]
  ds_read_b64_tr_b16 v[24:25], v7 offset:0
  v_add_u32 v8, 32768, v8
  v_mfma_f32_16x16x32_bf16 v[136:139], v[36:39], a[120:123], v[136:139]
  ds_read_b64_tr_b16 v[26:27], v7 offset:512
  v_mfma_f32_16x16x32_bf16 v[140:143], v[32:35], a[108:111], v[140:143]
  ds_read_b64_tr_b16 v[28:29], v7 offset:4096
  buffer_load_dwordx4 v20, s[16:19], s56 offen lds
  v_mfma_f32_16x16x32_bf16 v[140:143], v[36:39], a[124:127], v[140:143]
  s_waitcnt lgkmcnt(7)
  ds_read_b64_tr_b16 v[30:31], v7 offset:4608
  v_mfma_f32_16x16x32_bf16 v[144:147], v[40:43], a[96:99], v[144:147]
  s_add_u32 m0, s63, 143360
  ds_read_b128 a[156:159], v9 offset:6144
  v_add_u32 v9, 32768, v9
  v_mfma_f32_16x16x32_bf16 v[144:147], v[44:47], a[112:115], v[144:147]
  ds_read_b64_tr_b16 v[32:33], v7 offset:8192
  v_mfma_f32_16x16x32_bf16 v[148:151], v[40:43], a[100:103], v[148:151]
  buffer_load_dwordx4 v20, s[20:23], s56 offen lds
  v_mfma_f32_16x16x32_bf16 v[148:151], v[44:47], a[116:119], v[148:151]
  s_add_u32 m0, s62, 73728
  ds_read_b64_tr_b16 v[34:35], v7 offset:8704
  v_mfma_f32_16x16x32_bf16 v[152:155], v[40:43], a[104:107], v[152:155]
  ds_read_b64_tr_b16 v[36:37], v7 offset:12288
  v_mfma_f32_16x16x32_bf16 v[152:155], v[44:47], a[120:123], v[152:155]
  ds_read_b64_tr_b16 v[38:39], v7 offset:12800
  v_mfma_f32_16x16x32_bf16 v[156:159], v[40:43], a[108:111], v[156:159]
  v_mfma_f32_16x16x32_bf16 v[156:159], v[44:47], a[124:127], v[156:159]
  s_waitcnt lgkmcnt(5)
  s_waitcnt lgkmcnt(0) vmcnt(13)
  s_barrier
  v_mfma_f32_16x16x32_bf16 v[160:163], v[24:27], a[96:99], v[160:163]
  s_add_u32 m0, s60, 0
  ds_read_b64_tr_b16 v[40:41], v4 offset:16384
  v_mfma_f32_16x16x32_bf16 v[160:163], v[28:31], a[112:115], v[160:163]
  buffer_load_dwordx4 v1, s[4:7], 0 offen lds
  v_mfma_f32_16x16x32_bf16 v[164:167], v[24:27], a[100:103], v[164:167]
  s_add_u32 m0, s60, 1024
  ds_read_b64_tr_b16 v[42:43], v4 offset:16896
  v_mfma_f32_16x16x32_bf16 v[164:167], v[28:31], a[116:119], v[164:167]
  buffer_load_dwordx4 v2, s[4:7], s65 offen lds
  v_mfma_f32_16x16x32_bf16 v[168:171], v[24:27], a[104:107], v[168:171]
  s_add_u32 m0, s60, 2048
  ds_read_b64_tr_b16 v[44:45], v4 offset:20480
  v_mfma_f32_16x16x32_bf16 v[168:171], v[28:31], a[120:123], v[168:171]
  ds_read_b64_tr_b16 v[46:47], v4 offset:20992
  v_mfma_f32_16x16x32_bf16 v[172:175], v[24:27], a[108:111], v[172:175]
  v_mfma_f32_16x16x32_bf16 v[172:175], v[28:31], a[124:127], v[172:175]
  s_waitcnt lgkmcnt(4)
  v_mfma_f32_16x16x32_bf16 v[176:179], v[32:35], a[96:99], v[176:179]
  buffer_load_dwordx4 v1, s[4:7], s66 offen lds
  v_mfma_f32_16x16x32_bf16 v[176:179], v[36:39], a[112:115], v[176:179]
  s_add_u32 m0, s60, 3072
  ds_read_b64_tr_b16 v[24:25], v4 offset:24576
  v_mfma_f32_16x16x32_bf16 v[180:183], v[32:35], a[100:103], v[180:183]
  ds_read_b64_tr_b16 v[26:27], v4 offset:25088
  v_mfma_f32_16x16x32_bf16 v[180:183], v[36:39], a[116:119], v[180:183]
  ds_read_b64_tr_b16 v[28:29], v4 offset:28672
  v_mfma_f32_16x16x32_bf16 v[184:187], v[32:35], a[104:107], v[184:187]
  ds_read_b64_tr_b16 v[30:31], v4 offset:29184
  v_mfma_f32_16x16x32_bf16 v[184:187], v[36:39], a[120:123], v[184:187]
  buffer_load_dwordx4 v2, s[4:7], s67 offen lds
  v_mfma_f32_16x16x32_bf16 v[188:191], v[32:35], a[108:111], v[188:191]
  s_add_u32 m0, s60, 4096
  v_mfma_f32_16x16x32_bf16 v[188:191], v[36:39], a[124:127], v[188:191]
  s_waitcnt lgkmcnt(4)
  v_mfma_f32_16x16x32_bf16 v[64:67], v[40:43], a[128:131], v[64:67]
  ds_read_b64_tr_b16 v[32:33], v5 offset:16384
  v_mfma_f32_16x16x32_bf16 v[64:67], v[44:47], a[144:147], v[64:67]
  buffer_load_dwordx4 v1, s[4:7], s68 offen lds
  v_mfma_f32_16x16x32_bf16 v[68:71], v[40:43], a[132:135], v[68:71]
  s_add_u32 m0, s60, 5120
  ds_read_b64_tr_b16 v[34:35], v5 offset:16896
  v_mfma_f32_16x16x32_bf16 v[68:71], v[44:47], a[148:151], v[68:71]
  ds_read_b64_tr_b16 v[36:37], v5 offset:20480
  v_mfma_f32_16x16x32_bf16 v[72:75], v[40:43], a[136:139], v[72:75]
  ds_read_b64_tr_b16 v[38:39], v5 offset:20992
  v_mfma_f32_16x16x32_bf16 v[72:75], v[44:47], a[152:155], v[72:75]
  v_mfma_f32_16x16x32_bf16 v[76:79], v[40:43], a[140:143], v[76:79]
  buffer_load_dwordx4 v2, s[4:7], s69 offen lds
  v_mfma_f32_16x16x32_bf16 v[76:79], v[44:47], a[156:159], v[76:79]
  s_waitcnt lgkmcnt(4)
  s_add_u32 m0, s60, 6144
  v_mfma_f32_16x16x32_bf16 v[80:83], v[24:27], a[128:131], v[80:83]
  ds_read_b64_tr_b16 v[40:41], v5 offset:24576
  v_mfma_f32_16x16x32_bf16 v[80:83], v[28:31], a[144:147], v[80:83]
  ds_read_b64_tr_b16 v[42:43], v5 offset:25088
  v_mfma_f32_16x16x32_bf16 v[84:87], v[24:27], a[132:135], v[84:87]
  ds_read_b64_tr_b16 v[44:45], v5 offset:28672
  v_mfma_f32_16x16x32_bf16 v[84:87], v[28:31], a[148:151], v[84:87]
  buffer_load_dwordx4 v1, s[4:7], s70 offen lds
  v_mfma_f32_16x16x32_bf16 v[88:91], v[24:27], a[136:139], v[88:91]
  s_add_u32 m0, s60, 7168
  ds_read_b64_tr_b16 v[46:47], v5 offset:29184
  v_lshl_add_u32 v1, s89, 7, v21
  v_mfma_f32_16x16x32_bf16 v[88:91], v[28:31], a[152:155], v[88:91]
  v_mfma_f32_16x16x32_bf16 v[92:95], v[24:27], a[140:143], v[92:95]
  v_mfma_f32_16x16x32_bf16 v[92:95], v[28:31], a[156:159], v[92:95]
  s_waitcnt lgkmcnt(4) vmcnt(11)
  v_mfma_f32_16x16x32_bf16 v[96:99], v[32:35], a[128:131], v[96:99]
  buffer_load_dwordx4 v2, s[4:7], s71 offen lds
  v_mfma_f32_16x16x32_bf16 v[96:99], v[36:39], a[144:147], v[96:99]
  s_add_u32 m0, s63, 98304
  s_mul_i32 s56, s88, 589824
  v_xor_b32 v2, 64, v1
  v_mfma_f32_16x16x32_bf16 v[100:103], v[32:35], a[132:135], v[100:103]
  ds_read_b64_tr_b16 v[24:25], v6 offset:16384
  v_mfma_f32_16x16x32_bf16 v[100:103], v[36:39], a[148:151], v[100:103]
  ds_read_b64_tr_b16 v[26:27], v6 offset:16896
  v_mfma_f32_16x16x32_bf16 v[104:107], v[32:35], a[136:139], v[104:107]
  buffer_load_dwordx4 v3, s[16:19], s56 offen lds
  v_mfma_f32_16x16x32_bf16 v[104:107], v[36:39], a[152:155], v[104:107]
  s_add_u32 m0, s63, 106496
  ds_read_b64_tr_b16 v[28:29], v6 offset:20480
  v_mfma_f32_16x16x32_bf16 v[108:111], v[32:35], a[140:143], v[108:111]
  ds_read_b64_tr_b16 v[30:31], v6 offset:20992
  v_mfma_f32_16x16x32_bf16 v[108:111], v[36:39], a[156:159], v[108:111]
  s_waitcnt lgkmcnt(4)
  ds_read_b128 a[160:163], v8 offset:0
  v_mfma_f32_16x16x32_bf16 v[112:115], v[40:43], a[128:131], v[112:115]
  ds_read_b128 a[164:167], v8 offset:2048
  v_mfma_f32_16x16x32_bf16 v[112:115], v[44:47], a[144:147], v[112:115]
  buffer_load_dwordx4 v3, s[20:23], s56 offen lds
  v_mfma_f32_16x16x32_bf16 v[116:119], v[40:43], a[132:135], v[116:119]
  s_add_u32 m0, s63, 102400
  ds_read_b128 a[168:171], v8 offset:4096
  v_mfma_f32_16x16x32_bf16 v[116:119], v[44:47], a[148:151], v[116:119]
  ds_read_b64_tr_b16 v[32:33], v6 offset:24576
  v_mfma_f32_16x16x32_bf16 v[120:123], v[40:43], a[136:139], v[120:123]
  ds_read_b64_tr_b16 v[34:35], v6 offset:25088
  v_mfma_f32_16x16x32_bf16 v[120:123], v[44:47], a[152:155], v[120:123]
  ds_read_b64_tr_b16 v[36:37], v6 offset:28672
  v_mfma_f32_16x16x32_bf16 v[124:127], v[40:43], a[140:143], v[124:127]
  buffer_load_dwordx4 v20, s[16:19], s56 offen lds
  v_mfma_f32_16x16x32_bf16 v[124:127], v[44:47], a[156:159], v[124:127]
  s_waitcnt lgkmcnt(6)
  ds_read_b64_tr_b16 v[38:39], v6 offset:29184
  v_mfma_f32_16x16x32_bf16 v[128:131], v[24:27], a[128:131], v[128:131]
  s_add_u32 m0, s63, 110592
  ds_read_b128 a[172:175], v8 offset:6144
  v_mfma_f32_16x16x32_bf16 v[128:131], v[28:31], a[144:147], v[128:131]
  ds_read_b128 a[176:179], v9 offset:0
  v_mfma_f32_16x16x32_bf16 v[132:135], v[24:27], a[132:135], v[132:135]
  ds_read_b128 a[180:183], v9 offset:2048
  buffer_load_dwordx4 v20, s[20:23], s56 offen lds
  v_mfma_f32_16x16x32_bf16 v[132:135], v[28:31], a[148:151], v[132:135]
  s_add_u32 m0, s62, 73728
  ds_read_b128 a[184:187], v9 offset:4096
  v_mfma_f32_16x16x32_bf16 v[136:139], v[24:27], a[136:139], v[136:139]
  ds_read_b64_tr_b16 v[40:41], v7 offset:16384
  v_subrev_u32 v8, 32768, v8
  v_mfma_f32_16x16x32_bf16 v[136:139], v[28:31], a[152:155], v[136:139]
  ds_read_b64_tr_b16 v[42:43], v7 offset:16896
  v_mfma_f32_16x16x32_bf16 v[140:143], v[24:27], a[140:143], v[140:143]
  ds_read_b64_tr_b16 v[44:45], v7 offset:20480
  v_mfma_f32_16x16x32_bf16 v[140:143], v[28:31], a[156:159], v[140:143]
  s_waitcnt lgkmcnt(7)
  ds_read_b64_tr_b16 v[46:47], v7 offset:20992
  v_mfma_f32_16x16x32_bf16 v[144:147], v[32:35], a[128:131], v[144:147]
  s_mov_b64 exec, 0xffff
  buffer_load_dwordx4 v23, s[8:11], s57 offen lds
  s_mov_b64 exec, -1
  v_mfma_f32_16x16x32_bf16 v[144:147], v[36:39], a[144:147], v[144:147]
  s_add_u32 m0, s63, 74752
  s_mul_i32 s57, s87, 221184
  v_mfma_f32_16x16x32_bf16 v[148:151], v[32:35], a[132:135], v[148:151]
  buffer_load_dwordx4 v12, s[8:11], s57 offen lds
  v_mfma_f32_16x16x32_bf16 v[148:151], v[36:39], a[148:151], v[148:151]
  s_add_u32 m0, s63, 78848
  ds_read_b128 a[188:191], v9 offset:6144
  v_subrev_u32 v9, 32768, v9
  v_mfma_f32_16x16x32_bf16 v[152:155], v[32:35], a[136:139], v[152:155]
  ds_read_b64_tr_b16 v[24:25], v7 offset:24576
  v_mfma_f32_16x16x32_bf16 v[152:155], v[36:39], a[152:155], v[152:155]
  ds_read_b64_tr_b16 v[26:27], v7 offset:25088
  v_mfma_f32_16x16x32_bf16 v[156:159], v[32:35], a[140:143], v[156:159]
  ds_read_b64_tr_b16 v[28:29], v7 offset:28672
  v_mfma_f32_16x16x32_bf16 v[156:159], v[36:39], a[156:159], v[156:159]
  ds_read_b64_tr_b16 v[30:31], v7 offset:29184
  s_waitcnt lgkmcnt(5)
  s_waitcnt lgkmcnt(0) vmcnt(14)
  s_barrier
  v_mfma_f32_16x16x32_bf16 v[160:163], v[40:43], a[128:131], v[160:163]
  s_add_u32 m0, s60, 32768
  ds_read_b64_tr_b16 v[32:33], v4 offset:32768
  v_mfma_f32_16x16x32_bf16 v[160:163], v[44:47], a[144:147], v[160:163]
  ds_read_b64_tr_b16 v[34:35], v4 offset:33280
  v_mfma_f32_16x16x32_bf16 v[164:167], v[40:43], a[132:135], v[164:167]
  ds_read_b64_tr_b16 v[36:37], v4 offset:36864
  v_mfma_f32_16x16x32_bf16 v[164:167], v[44:47], a[148:151], v[164:167]
  buffer_load_dwordx4 v1, s[4:7], 0 offen lds
  v_mfma_f32_16x16x32_bf16 v[168:171], v[40:43], a[136:139], v[168:171]
  s_add_u32 m0, s60, 33792
  ds_read_b64_tr_b16 v[38:39], v4 offset:37376
  v_mfma_f32_16x16x32_bf16 v[168:171], v[44:47], a[152:155], v[168:171]
  v_mfma_f32_16x16x32_bf16 v[172:175], v[40:43], a[140:143], v[172:175]
  v_mfma_f32_16x16x32_bf16 v[172:175], v[44:47], a[156:159], v[172:175]
  s_waitcnt lgkmcnt(4)
  v_mfma_f32_16x16x32_bf16 v[176:179], v[24:27], a[128:131], v[176:179]
  buffer_load_dwordx4 v2, s[4:7], s65 offen lds
  v_mfma_f32_16x16x32_bf16 v[176:179], v[28:31], a[144:147], v[176:179]
  s_add_u32 m0, s60, 34816
  ds_read_b64_tr_b16 v[40:41], v4 offset:40960
  v_mfma_f32_16x16x32_bf16 v[180:183], v[24:27], a[132:135], v[180:183]
  ds_read_b64_tr_b16 v[42:43], v4 offset:41472
  v_mfma_f32_16x16x32_bf16 v[180:183], v[28:31], a[148:151], v[180:183]
  ds_read_b64_tr_b16 v[44:45], v4 offset:45056
  v_mfma_f32_16x16x32_bf16 v[184:187], v[24:27], a[136:139], v[184:187]
  buffer_load_dwordx4 v1, s[4:7], s66 offen lds
  v_mfma_f32_16x16x32_bf16 v[184:187], v[28:31], a[152:155], v[184:187]
  s_add_u32 m0, s60, 35840
  ds_read_b64_tr_b16 v[46:47], v4 offset:45568
  v_mfma_f32_16x16x32_bf16 v[188:191], v[24:27], a[140:143], v[188:191]
  v_mfma_f32_16x16x32_bf16 v[188:191], v[28:31], a[156:159], v[188:191]
  s_waitcnt lgkmcnt(4)
  v_mfma_f32_16x16x32_bf16 v[64:67], v[32:35], a[160:163], v[64:67]
  ds_read_b64_tr_b16 v[24:25], v5 offset:32768
  v_mfma_f32_16x16x32_bf16 v[64:67], v[36:39], a[176:179], v[64:67]
  buffer_load_dwordx4 v2, s[4:7], s67 offen lds
  v_mfma_f32_16x16x32_bf16 v[68:71], v[32:35], a[164:167], v[68:71]
  s_add_u32 m0, s60, 36864
  ds_read_b64_tr_b16 v[26:27], v5 offset:33280
  v_mfma_f32_16x16x32_bf16 v[68:71], v[36:39], a[180:183], v[68:71]
  ds_read_b64_tr_b16 v[28:29], v5 offset:36864
  v_mfma_f32_16x16x32_bf16 v[72:75], v[32:35], a[168:171], v[72:75]
  ds_read_b64_tr_b16 v[30:31], v5 offset:37376
  v_mfma_f32_16x16x32_bf16 v[72:75], v[36:39], a[184:187], v[72:75]
  v_mfma_f32_16x16x32_bf16 v[76:79], v[32:35], a[172:175], v[76:79]
  buffer_load_dwordx4 v1, s[4:7], s68 offen lds
  v_mfma_f32_16x16x32_bf16 v[76:79], v[36:39], a[188:191], v[76:79]
  s_waitcnt lgkmcnt(4)
  s_add_u32 m0, s60, 37888
  v_mfma_f32_16x16x32_bf16 v[80:83], v[40:43], a[160:163], v[80:83]
  ds_read_b64_tr_b16 v[32:33], v5 offset:40960
  v_mfma_f32_16x16x32_bf16 v[80:83], v[44:47], a[176:179], v[80:83]
  ds_read_b64_tr_b16 v[34:35], v5 offset:41472
  v_mfma_f32_16x16x32_bf16 v[84:87], v[40:43], a[164:167], v[84:87]
  buffer_load_dwordx4 v2, s[4:7], s69 offen lds
  v_mfma_f32_16x16x32_bf16 v[84:87], v[44:47], a[180:183], v[84:87]
  s_add_u32 m0, s60, 38912
  ds_read_b64_tr_b16 v[36:37], v5 offset:45056
  v_mfma_f32_16x16x32_bf16 v[88:91], v[40:43], a[168:171], v[88:91]
  ds_read_b64_tr_b16 v[38:39], v5 offset:45568
  v_mfma_f32_16x16x32_bf16 v[88:91], v[44:47], a[184:187], v[88:91]
  v_mfma_f32_16x16x32_bf16 v[92:95], v[40:43], a[172:175], v[92:95]
  v_mfma_f32_16x16x32_bf16 v[92:95], v[44:47], a[188:191], v[92:95]
  s_waitcnt lgkmcnt(4) vmcnt(12)
  v_mfma_f32_16x16x32_bf16 v[96:99], v[24:27], a[160:163], v[96:99]
  buffer_load_dwordx4 v1, s[4:7], s70 offen lds
  v_mfma_f32_16x16x32_bf16 v[96:99], v[28:31], a[176:179], v[96:99]
  s_add_u32 m0, s60, 39936
  ds_read_b64_tr_b16 v[40:41], v6 offset:32768
  v_lshl_add_u32 v1, s1, 7, v21
  v_mfma_f32_16x16x32_bf16 v[100:103], v[24:27], a[164:167], v[100:103]
  ds_read_b64_tr_b16 v[42:43], v6 offset:33280
  v_mfma_f32_16x16x32_bf16 v[100:103], v[28:31], a[180:183], v[100:103]
  ds_read_b64_tr_b16 v[44:45], v6 offset:36864
  v_mfma_f32_16x16x32_bf16 v[104:107], v[24:27], a[168:171], v[104:107]
  buffer_load_dwordx4 v2, s[4:7], s71 offen lds
  v_mfma_f32_16x16x32_bf16 v[104:107], v[28:31], a[184:187], v[104:107]
  s_add_u32 m0, s63, 114688
  s_mul_i32 s56, s89, 589824
  v_xor_b32 v2, 64, v1
  v_mfma_f32_16x16x32_bf16 v[108:111], v[24:27], a[172:175], v[108:111]
  ds_read_b64_tr_b16 v[46:47], v6 offset:37376
  v_mfma_f32_16x16x32_bf16 v[108:111], v[28:31], a[188:191], v[108:111]
  s_waitcnt lgkmcnt(4)
  ds_read_b128 a[192:195], v8 offset:0
  v_mfma_f32_16x16x32_bf16 v[112:115], v[32:35], a[160:163], v[112:115]
  ds_read_b128 a[196:199], v8 offset:2048
  v_mfma_f32_16x16x32_bf16 v[112:115], v[36:39], a[176:179], v[112:115]
  buffer_load_dwordx4 v3, s[16:19], s56 offen lds
  v_mfma_f32_16x16x32_bf16 v[116:119], v[32:35], a[164:167], v[116:119]
  s_add_u32 m0, s63, 122880
  ds_read_b128 a[200:203], v8 offset:4096
  v_mfma_f32_16x16x32_bf16 v[116:119], v[36:39], a[180:183], v[116:119]
  ds_read_b64_tr_b16 v[24:25], v6 offset:40960
  v_mfma_f32_16x16x32_bf16 v[120:123], v[32:35], a[168:171], v[120:123]
  ds_read_b64_tr_b16 v[26:27], v6 offset:41472
  v_mfma_f32_16x16x32_bf16 v[120:123], v[36:39], a[184:187], v[120:123]
  buffer_load_dwordx4 v3, s[20:23], s56 offen lds
  v_mfma_f32_16x16x32_bf16 v[124:127], v[32:35], a[172:175], v[124:127]
  s_add_u32 m0, s63, 118784
  ds_read_b64_tr_b16 v[28:29], v6 offset:45056
  v_mfma_f32_16x16x32_bf16 v[124:127], v[36:39], a[188:191], v[124:127]
  s_waitcnt lgkmcnt(6)
  ds_read_b64_tr_b16 v[30:31], v6 offset:45568
  v_mfma_f32_16x16x32_bf16 v[128:131], v[40:43], a[160:163], v[128:131]
  ds_read_b128 a[204:207], v8 offset:6144
  v_mfma_f32_16x16x32_bf16 v[128:131], v[44:47], a[176:179], v[128:131]
  ds_read_b128 a[208:211], v9 offset:0
  v_mfma_f32_16x16x32_bf16 v[132:135], v[40:43], a[164:167], v[132:135]
  ds_read_b128 a[212:215], v9 offset:2048
  buffer_load_dwordx4 v20, s[16:19], s56 offen lds
  v_mfma_f32_16x16x32_bf16 v[132:135], v[44:47], a[180:183], v[132:135]
  s_add_u32 m0, s63, 126976
  ds_read_b128 a[216:219], v9 offset:4096
  v_mfma_f32_16x16x32_bf16 v[136:139], v[40:43], a[168:171], v[136:139]
  ds_read_b64_tr_b16 v[32:33], v7 offset:32768
  v_add_u32 v8, 32768, v8
  v_mfma_f32_16x16x32_bf16 v[136:139], v[44:47], a[184:187], v[136:139]
  ds_read_b64_tr_b16 v[34:35], v7 offset:33280
  v_mfma_f32_16x16x32_bf16 v[140:143], v[40:43], a[172:175], v[140:143]
  ds_read_b64_tr_b16 v[36:37], v7 offset:36864
  buffer_load_dwordx4 v20, s[20:23], s56 offen lds
  v_mfma_f32_16x16x32_bf16 v[140:143], v[44:47], a[188:191], v[140:143]
  s_waitcnt lgkmcnt(7)
  ds_read_b64_tr_b16 v[38:39], v7 offset:37376
  v_mfma_f32_16x16x32_bf16 v[144:147], v[24:27], a[160:163], v[144:147]
  s_add_u32 m0, s63, 78848
  ds_read_b128 a[220:223], v9 offset:6144
  v_add_u32 v9, 32768, v9
  v_mfma_f32_16x16x32_bf16 v[144:147], v[28:31], a[176:179], v[144:147]
  ds_read_b64_tr_b16 v[40:41], v7 offset:40960
  v_mfma_f32_16x16x32_bf16 v[148:151], v[24:27], a[164:167], v[148:151]
  ds_read_b64_tr_b16 v[42:43], v7 offset:41472
  v_mfma_f32_16x16x32_bf16 v[148:151], v[28:31], a[180:183], v[148:151]
  buffer_load_dwordx4 v22, s[8:11], s57 offen lds
  v_mfma_f32_16x16x32_bf16 v[152:155], v[24:27], a[168:171], v[152:155]
  s_add_u32 m0, s62, 82944
  ds_read_b64_tr_b16 v[44:45], v7 offset:45056
  v_mfma_f32_16x16x32_bf16 v[152:155], v[28:31], a[184:187], v[152:155]
  ds_read_b64_tr_b16 v[46:47], v7 offset:45568
  v_mfma_f32_16x16x32_bf16 v[156:159], v[24:27], a[172:175], v[156:159]
  v_mfma_f32_16x16x32_bf16 v[156:159], v[28:31], a[188:191], v[156:159]
  s_waitcnt lgkmcnt(5)
  s_waitcnt lgkmcnt(0) vmcnt(15)
  s_barrier
  v_mfma_f32_16x16x32_bf16 v[160:163], v[32:35], a[160:163], v[160:163]
  s_add_u32 m0, s60, 0
  ds_read_b64_tr_b16 v[24:25], v4 offset:0
  v_mfma_f32_16x16x32_bf16 v[160:163], v[36:39], a[176:179], v[160:163]
  ds_read_b64_tr_b16 v[26:27], v4 offset:512
  v_mfma_f32_16x16x32_bf16 v[164:167], v[32:35], a[164:167], v[164:167]
  ds_read_b64_tr_b16 v[28:29], v4 offset:4096
  v_mfma_f32_16x16x32_bf16 v[164:167], v[36:39], a[180:183], v[164:167]
  ds_read_b64_tr_b16 v[30:31], v4 offset:4608
  v_mfma_f32_16x16x32_bf16 v[168:171], v[32:35], a[168:171], v[168:171]
  v_mfma_f32_16x16x32_bf16 v[168:171], v[36:39], a[184:187], v[168:171]
  buffer_load_dwordx4 v1, s[4:7], 0 offen lds
  v_mfma_f32_16x16x32_bf16 v[172:175], v[32:35], a[172:175], v[172:175]
  s_add_u32 m0, s60, 1024
  v_mfma_f32_16x16x32_bf16 v[172:175], v[36:39], a[188:191], v[172:175]
  s_waitcnt lgkmcnt(4)
  v_mfma_f32_16x16x32_bf16 v[176:179], v[40:43], a[160:163], v[176:179]
  ds_read_b64_tr_b16 v[32:33], v4 offset:8192
  v_mfma_f32_16x16x32_bf16 v[176:179], v[44:47], a[176:179], v[176:179]
  ds_read_b64_tr_b16 v[34:35], v4 offset:8704
  v_mfma_f32_16x16x32_bf16 v[180:183], v[40:43], a[164:167], v[180:183]
  buffer_load_dwordx4 v2, s[4:7], s65 offen lds
  v_mfma_f32_16x16x32_bf16 v[180:183], v[44:47], a[180:183], v[180:183]
  s_add_u32 m0, s60, 2048
  ds_read_b64_tr_b16 v[36:37], v4 offset:12288
  v_mfma_f32_16x16x32_bf16 v[184:187], v[40:43], a[168:171], v[184:187]
  ds_read_b64_tr_b16 v[38:39], v4 offset:12800
  v_mfma_f32_16x16x32_bf16 v[184:187], v[44:47], a[184:187], v[184:187]
  v_mfma_f32_16x16x32_bf16 v[188:191], v[40:43], a[172:175], v[188:191]
  buffer_load_dwordx4 v1, s[4:7], s66 offen lds
  v_mfma_f32_16x16x32_bf16 v[188:191], v[44:47], a[188:191], v[188:191]
  s_waitcnt lgkmcnt(4)
  s_add_u32 m0, s60, 3072
  v_mfma_f32_16x16x32_bf16 v[64:67], v[24:27], a[192:195], v[64:67]
  ds_read_b64_tr_b16 v[40:41], v5 offset:0
  v_mfma_f32_16x16x32_bf16 v[64:67], v[28:31], a[208:211], v[64:67]
  ds_read_b64_tr_b16 v[42:43], v5 offset:512
  v_mfma_f32_16x16x32_bf16 v[68:71], v[24:27], a[196:199], v[68:71]
  ds_read_b64_tr_b16 v[44:45], v5 offset:4096
  v_mfma_f32_16x16x32_bf16 v[68:71], v[28:31], a[212:215], v[68:71]
  buffer_load_dwordx4 v2, s[4:7], s67 offen lds
  v_mfma_f32_16x16x32_bf16 v[72:75], v[24:27], a[200:203], v[72:75]
  s_add_u32 m0, s60, 4096
  ds_read_b64_tr_b16 v[46:47], v5 offset:4608
  v_mfma_f32_16x16x32_bf16 v[72:75], v[28:31], a[216:219], v[72:75]
  v_mfma_f32_16x16x32_bf16 v[76:79], v[24:27], a[204:207], v[76:79]
  v_mfma_f32_16x16x32_bf16 v[76:79], v[28:31], a[220:223], v[76:79]
  s_waitcnt lgkmcnt(4)
  v_mfma_f32_16x16x32_bf16 v[80:83], v[32:35], a[192:195], v[80:83]
  buffer_load_dwordx4 v1, s[4:7], s68 offen lds
  v_mfma_f32_16x16x32_bf16 v[80:83], v[36:39], a[208:211], v[80:83]
  s_add_u32 m0, s60, 5120
  ds_read_b64_tr_b16 v[24:25], v5 offset:8192
  v_mfma_f32_16x16x32_bf16 v[84:87], v[32:35], a[196:199], v[84:87]
  ds_read_b64_tr_b16 v[26:27], v5 offset:8704
  v_mfma_f32_16x16x32_bf16 v[84:87], v[36:39], a[212:215], v[84:87]
  ds_read_b64_tr_b16 v[28:29], v5 offset:12288
  v_mfma_f32_16x16x32_bf16 v[88:91], v[32:35], a[200:203], v[88:91]
  buffer_load_dwordx4 v2, s[4:7], s69 offen lds
  v_mfma_f32_16x16x32_bf16 v[88:91], v[36:39], a[216:219], v[88:91]
  s_add_u32 m0, s60, 6144
  ds_read_b64_tr_b16 v[30:31], v5 offset:12800
  v_mfma_f32_16x16x32_bf16 v[92:95], v[32:35], a[204:207], v[92:95]
  v_mfma_f32_16x16x32_bf16 v[92:95], v[36:39], a[220:223], v[92:95]
  s_waitcnt lgkmcnt(4) vmcnt(11)
  v_mfma_f32_16x16x32_bf16 v[96:99], v[40:43], a[192:195], v[96:99]
  ds_read_b64_tr_b16 v[32:33], v6 offset:0
  v_mfma_f32_16x16x32_bf16 v[96:99], v[44:47], a[208:211], v[96:99]
  buffer_load_dwordx4 v1, s[4:7], s70 offen lds
  v_mfma_f32_16x16x32_bf16 v[100:103], v[40:43], a[196:199], v[100:103]
  s_add_u32 m0, s60, 7168
  ds_read_b64_tr_b16 v[34:35], v6 offset:512
  v_mfma_f32_16x16x32_bf16 v[100:103], v[44:47], a[212:215], v[100:103]
  ds_read_b64_tr_b16 v[36:37], v6 offset:4096
  v_mfma_f32_16x16x32_bf16 v[104:107], v[40:43], a[200:203], v[104:107]
  ds_read_b64_tr_b16 v[38:39], v6 offset:4608
  v_mfma_f32_16x16x32_bf16 v[104:107], v[44:47], a[216:219], v[104:107]
  ds_read_b128 a[224:227], v8 offset:0
  v_mfma_f32_16x16x32_bf16 v[108:111], v[40:43], a[204:207], v[108:111]
  buffer_load_dwordx4 v2, s[4:7], s71 offen lds
  v_mfma_f32_16x16x32_bf16 v[108:111], v[44:47], a[220:223], v[108:111]
  s_waitcnt lgkmcnt(5)
  s_add_u32 m0, s63, 131072
  s_mul_i32 s56, s1, 589824
  v_mfma_f32_16x16x32_bf16 v[112:115], v[24:27], a[192:195], v[112:115]
  ds_read_b128 a[228:231], v8 offset:2048
  v_mfma_f32_16x16x32_bf16 v[112:115], v[28:31], a[208:211], v[112:115]
  ds_read_b128 a[232:235], v8 offset:4096
  v_mfma_f32_16x16x32_bf16 v[116:119], v[24:27], a[196:199], v[116:119]
  buffer_load_dwordx4 v3, s[16:19], s56 offen lds
  v_mfma_f32_16x16x32_bf16 v[116:119], v[28:31], a[212:215], v[116:119]
  s_add_u32 m0, s63, 139264
  ds_read_b64_tr_b16 v[40:41], v6 offset:8192
  v_mfma_f32_16x16x32_bf16 v[120:123], v[24:27], a[200:203], v[120:123]
  ds_read_b64_tr_b16 v[42:43], v6 offset:8704
  v_mfma_f32_16x16x32_bf16 v[120:123], v[28:31], a[216:219], v[120:123]
  ds_read_b64_tr_b16 v[44:45], v6 offset:12288
  v_mfma_f32_16x16x32_bf16 v[124:127], v[24:27], a[204:207], v[124:127]
  ds_read_b64_tr_b16 v[46:47], v6 offset:12800
  v_mfma_f32_16x16x32_bf16 v[124:127], v[28:31], a[220:223], v[124:127]
  s_waitcnt lgkmcnt(7)
  ds_read_b128 a[236:239], v8 offset:6144
  v_mfma_f32_16x16x32_bf16 v[128:131], v[32:35], a[192:195], v[128:131]
  buffer_load_dwordx4 v3, s[20:23], s56 offen lds
  v_mfma_f32_16x16x32_bf16 v[128:131], v[36:39], a[208:211], v[128:131]
  s_add_u32 m0, s63, 135168
  ds_read_b128 a[240:243], v9 offset:0
  v_mfma_f32_16x16x32_bf16 v[132:135], v[32:35], a[196:199], v[132:135]
  ds_read_b128 a[244:247], v9 offset:2048
  v_mfma_f32_16x16x32_bf16 v[132:135], v[36:39], a[212:215], v[132:135]
  ds_read_b128 a[248:251], v9 offset:4096
  v_mfma_f32_16x16x32_bf16 v[136:139], v[32:35], a[200:203], v[136:139]
  ds_read_b64_tr_b16 v[24:25], v7 offset:0
  buffer_load_dwordx4 v20, s[16:19], s56 offen lds
  v_mfma_f32_16x16x32_bf16 v[136:139], v[36:39], a[216:219], v[136:139]
  s_add_u32 m0, s63, 143360
  ds_read_b64_tr_b16 v[26:27], v7 offset:512
  v_subrev_u32 v8, 32768, v8
  v_mfma_f32_16x16x32_bf16 v[140:143], v[32:35], a[204:207], v[140:143]
  ds_read_b64_tr_b16 v[28:29], v7 offset:4096
  v_mfma_f32_16x16x32_bf16 v[140:143], v[36:39], a[220:223], v[140:143]
  s_waitcnt lgkmcnt(7)
  ds_read_b64_tr_b16 v[30:31], v7 offset:4608
  v_mfma_f32_16x16x32_bf16 v[144:147], v[40:43], a[192:195], v[144:147]
  buffer_load_dwordx4 v20, s[20:23], s56 offen lds
  v_mfma_f32_16x16x32_bf16 v[144:147], v[44:47], a[208:211], v[144:147]
  s_add_u32 m0, s62, 82944
  ds_read_b128 a[252:255], v9 offset:6144
  v_subrev_u32 v9, 32768, v9
  v_mfma_f32_16x16x32_bf16 v[148:151], v[40:43], a[196:199], v[148:151]
  ds_read_b64_tr_b16 v[32:33], v7 offset:8192
  v_mfma_f32_16x16x32_bf16 v[148:151], v[44:47], a[212:215], v[148:151]
  ds_read_b64_tr_b16 v[34:35], v7 offset:8704
  v_mfma_f32_16x16x32_bf16 v[152:155], v[40:43], a[200:203], v[152:155]
  ds_read_b64_tr_b16 v[36:37], v7 offset:12288
  v_mfma_f32_16x16x32_bf16 v[152:155], v[44:47], a[216:219], v[152:155]
  s_mov_b64 exec, 0xffff
  buffer_load_dwordx4 v23, s[8:11], s57 offen lds
  s_mov_b64 exec, -1
  v_mfma_f32_16x16x32_bf16 v[156:159], v[40:43], a[204:207], v[156:159]
  s_add_u32 m0, s63, 83968
  s_mul_i32 s57, s3, 221184
  v_mfma_f32_16x16x32_bf16 v[156:159], v[44:47], a[220:223], v[156:159]
  ds_read_b64_tr_b16 v[38:39], v7 offset:12800
  s_waitcnt lgkmcnt(5)
  s_waitcnt lgkmcnt(0) vmcnt(14)
  s_barrier
  v_mfma_f32_16x16x32_bf16 v[160:163], v[24:27], a[192:195], v[160:163]
  buffer_load_dwordx4 v12, s[8:11], s57 offen lds
  v_mfma_f32_16x16x32_bf16 v[160:163], v[28:31], a[208:211], v[160:163]
  s_add_u32 m0, s63, 88064
  ds_read_b64_tr_b16 v[40:41], v4 offset:16384
  v_mfma_f32_16x16x32_bf16 v[164:167], v[24:27], a[196:199], v[164:167]
  ds_read_b64_tr_b16 v[42:43], v4 offset:16896
  v_mfma_f32_16x16x32_bf16 v[164:167], v[28:31], a[212:215], v[164:167]
  ds_read_b64_tr_b16 v[44:45], v4 offset:20480
  v_mfma_f32_16x16x32_bf16 v[168:171], v[24:27], a[200:203], v[168:171]
  ds_read_b64_tr_b16 v[46:47], v4 offset:20992
  v_mfma_f32_16x16x32_bf16 v[168:171], v[28:31], a[216:219], v[168:171]
  v_mfma_f32_16x16x32_bf16 v[172:175], v[24:27], a[204:207], v[172:175]
  v_mfma_f32_16x16x32_bf16 v[172:175], v[28:31], a[220:223], v[172:175]
  s_waitcnt lgkmcnt(4)
  v_mfma_f32_16x16x32_bf16 v[176:179], v[32:35], a[192:195], v[176:179]
  ds_read_b64_tr_b16 v[24:25], v4 offset:24576
  v_mfma_f32_16x16x32_bf16 v[176:179], v[36:39], a[208:211], v[176:179]
  buffer_load_dwordx4 v22, s[8:11], s57 offen lds
  v_mfma_f32_16x16x32_bf16 v[180:183], v[32:35], a[196:199], v[180:183]
  s_add_u32 m0, s62, 92160
  ds_read_b64_tr_b16 v[26:27], v4 offset:25088
  v_mfma_f32_16x16x32_bf16 v[180:183], v[36:39], a[212:215], v[180:183]
  ds_read_b64_tr_b16 v[28:29], v4 offset:28672
  v_mfma_f32_16x16x32_bf16 v[184:187], v[32:35], a[200:203], v[184:187]
  ds_read_b64_tr_b16 v[30:31], v4 offset:29184
  v_mfma_f32_16x16x32_bf16 v[184:187], v[36:39], a[216:219], v[184:187]
  v_mfma_f32_16x16x32_bf16 v[188:191], v[32:35], a[204:207], v[188:191]
  v_mfma_f32_16x16x32_bf16 v[188:191], v[36:39], a[220:223], v[188:191]
  s_waitcnt lgkmcnt(4)
  v_mfma_f32_16x16x32_bf16 v[64:67], v[40:43], a[224:227], v[64:67]
  ds_read_b64_tr_b16 v[32:33], v5 offset:16384
  v_mfma_f32_16x16x32_bf16 v[64:67], v[44:47], a[240:243], v[64:67]
  ds_read_b64_tr_b16 v[34:35], v5 offset:16896
  v_mfma_f32_16x16x32_bf16 v[68:71], v[40:43], a[228:231], v[68:71]
  ds_read_b64_tr_b16 v[36:37], v5 offset:20480
  v_mfma_f32_16x16x32_bf16 v[68:71], v[44:47], a[244:247], v[68:71]
  s_mov_b64 exec, 0xffff
  buffer_load_dwordx4 v23, s[8:11], s57 offen lds
  s_mov_b64 exec, -1
  v_mfma_f32_16x16x32_bf16 v[72:75], v[40:43], a[232:235], v[72:75]
  s_add_u32 m0, s63, 32768
  s_mul_i32 s57, s100, 221184
  v_mfma_f32_16x16x32_bf16 v[72:75], v[44:47], a[248:251], v[72:75]
  ds_read_b64_tr_b16 v[38:39], v5 offset:20992
  v_mfma_f32_16x16x32_bf16 v[76:79], v[40:43], a[236:239], v[76:79]
  buffer_load_dwordx4 v12, s[8:11], s57 offen lds
  v_mfma_f32_16x16x32_bf16 v[76:79], v[44:47], a[252:255], v[76:79]
  s_waitcnt lgkmcnt(4)
  s_add_u32 m0, s63, 36864
  v_mfma_f32_16x16x32_bf16 v[80:83], v[24:27], a[224:227], v[80:83]
  ds_read_b64_tr_b16 v[40:41], v5 offset:24576
  v_mfma_f32_16x16x32_bf16 v[80:83], v[28:31], a[240:243], v[80:83]
  ds_read_b64_tr_b16 v[42:43], v5 offset:25088
  v_mfma_f32_16x16x32_bf16 v[84:87], v[24:27], a[228:231], v[84:87]
  ds_read_b64_tr_b16 v[44:45], v5 offset:28672
  v_mfma_f32_16x16x32_bf16 v[84:87], v[28:31], a[244:247], v[84:87]
  ds_read_b64_tr_b16 v[46:47], v5 offset:29184
  v_mfma_f32_16x16x32_bf16 v[88:91], v[24:27], a[232:235], v[88:91]
  v_mfma_f32_16x16x32_bf16 v[88:91], v[28:31], a[248:251], v[88:91]
  v_mfma_f32_16x16x32_bf16 v[92:95], v[24:27], a[236:239], v[92:95]
  v_mfma_f32_16x16x32_bf16 v[92:95], v[28:31], a[252:255], v[92:95]
  s_waitcnt lgkmcnt(4) vmcnt(9)
  v_mfma_f32_16x16x32_bf16 v[96:99], v[32:35], a[224:227], v[96:99]
  buffer_load_dwordx4 v22, s[8:11], s57 offen lds
  v_mfma_f32_16x16x32_bf16 v[96:99], v[36:39], a[240:243], v[96:99]
  s_add_u32 m0, s62, 40960
  ds_read_b64_tr_b16 v[24:25], v6 offset:16384
  v_mfma_f32_16x16x32_bf16 v[100:103], v[32:35], a[228:231], v[100:103]
  ds_read_b64_tr_b16 v[26:27], v6 offset:16896
  v_mfma_f32_16x16x32_bf16 v[100:103], v[36:39], a[244:247], v[100:103]
  ds_read_b64_tr_b16 v[28:29], v6 offset:20480
  v_mfma_f32_16x16x32_bf16 v[104:107], v[32:35], a[232:235], v[104:107]
  ds_read_b64_tr_b16 v[30:31], v6 offset:20992
  v_mfma_f32_16x16x32_bf16 v[104:107], v[36:39], a[248:251], v[104:107]
  ds_read_b128 v[224:227], v8 offset:0
  v_mfma_f32_16x16x32_bf16 v[108:111], v[32:35], a[236:239], v[108:111]
  ds_read_b128 v[228:231], v8 offset:2048
  v_mfma_f32_16x16x32_bf16 v[108:111], v[36:39], a[252:255], v[108:111]
  s_waitcnt lgkmcnt(6)
  ds_read_b128 v[232:235], v8 offset:4096
  v_mfma_f32_16x16x32_bf16 v[112:115], v[40:43], a[224:227], v[112:115]
  ds_read_b64_tr_b16 v[32:33], v6 offset:24576
  v_mfma_f32_16x16x32_bf16 v[112:115], v[44:47], a[240:243], v[112:115]
  ds_read_b64_tr_b16 v[34:35], v6 offset:25088
  v_mfma_f32_16x16x32_bf16 v[116:119], v[40:43], a[228:231], v[116:119]
  s_mov_b64 exec, 0xffff
  buffer_load_dwordx4 v23, s[8:11], s57 offen lds
  s_mov_b64 exec, -1
  v_mfma_f32_16x16x32_bf16 v[116:119], v[44:47], a[244:247], v[116:119]
  s_add_u32 m0, s63, 41984
  s_mul_i32 s57, s101, 221184
  v_mfma_f32_16x16x32_bf16 v[120:123], v[40:43], a[232:235], v[120:123]
  ds_read_b64_tr_b16 v[36:37], v6 offset:28672
  v_mfma_f32_16x16x32_bf16 v[120:123], v[44:47], a[248:251], v[120:123]
  buffer_load_dwordx4 v12, s[8:11], s57 offen lds
  v_mfma_f32_16x16x32_bf16 v[124:127], v[40:43], a[236:239], v[124:127]
  s_add_u32 m0, s63, 46080
  ds_read_b64_tr_b16 v[38:39], v6 offset:29184
  v_mfma_f32_16x16x32_bf16 v[124:127], v[44:47], a[252:255], v[124:127]
  s_waitcnt lgkmcnt(7)
  ds_read_b128 v[236:239], v8 offset:6144
  v_mfma_f32_16x16x32_bf16 v[128:131], v[24:27], a[224:227], v[128:131]
  ds_read_b128 v[240:243], v9 offset:0
  v_mfma_f32_16x16x32_bf16 v[128:131], v[28:31], a[240:243], v[128:131]
  ds_read_b128 v[244:247], v9 offset:2048
  v_mfma_f32_16x16x32_bf16 v[132:135], v[24:27], a[228:231], v[132:135]
  ds_read_b128 v[248:251], v9 offset:4096
  v_mfma_f32_16x16x32_bf16 v[132:135], v[28:31], a[244:247], v[132:135]
  ds_read_b64_tr_b16 v[40:41], v7 offset:16384
  v_mfma_f32_16x16x32_bf16 v[136:139], v[24:27], a[232:235], v[136:139]
  ds_read_b64_tr_b16 v[42:43], v7 offset:16896
  v_add_u32 v8, 32768, v8
  v_mfma_f32_16x16x32_bf16 v[136:139], v[28:31], a[248:251], v[136:139]
  ds_read_b64_tr_b16 v[44:45], v7 offset:20480
  v_mfma_f32_16x16x32_bf16 v[140:143], v[24:27], a[236:239], v[140:143]
  ds_read_b64_tr_b16 v[46:47], v7 offset:20992
  v_mfma_f32_16x16x32_bf16 v[140:143], v[28:31], a[252:255], v[140:143]
  s_waitcnt lgkmcnt(8)
  ds_read_b128 v[252:255], v9 offset:6144
  v_add_u32 v9, 32768, v9
  v_mfma_f32_16x16x32_bf16 v[144:147], v[32:35], a[224:227], v[144:147]
  buffer_load_dwordx4 v22, s[8:11], s57 offen lds
  v_mfma_f32_16x16x32_bf16 v[144:147], v[36:39], a[240:243], v[144:147]
  s_add_u32 m0, s62, 50176
  ds_read_b64_tr_b16 v[24:25], v7 offset:24576
  v_mfma_f32_16x16x32_bf16 v[148:151], v[32:35], a[228:231], v[148:151]
  ds_read_b64_tr_b16 v[26:27], v7 offset:25088
  v_mfma_f32_16x16x32_bf16 v[148:151], v[36:39], a[244:247], v[148:151]
  ds_read_b64_tr_b16 v[28:29], v7 offset:28672
  v_mfma_f32_16x16x32_bf16 v[152:155], v[32:35], a[232:235], v[152:155]
  ds_read_b64_tr_b16 v[30:31], v7 offset:29184
  v_mfma_f32_16x16x32_bf16 v[152:155], v[36:39], a[248:251], v[152:155]
  v_mfma_f32_16x16x32_bf16 v[156:159], v[32:35], a[236:239], v[156:159]
  v_mfma_f32_16x16x32_bf16 v[156:159], v[36:39], a[252:255], v[156:159]
  s_waitcnt lgkmcnt(5)
  s_waitcnt lgkmcnt(0) vmcnt(9)
  s_barrier
  v_mfma_f32_16x16x32_bf16 v[160:163], v[40:43], a[224:227], v[160:163]
  ds_read_b64_tr_b16 v[32:33], v4 offset:32768
  v_mfma_f32_16x16x32_bf16 v[160:163], v[44:47], a[240:243], v[160:163]
  s_mov_b64 exec, 0xffff
  buffer_load_dwordx4 v23, s[8:11], s57 offen lds
  s_mov_b64 exec, -1
  v_mfma_f32_16x16x32_bf16 v[164:167], v[40:43], a[228:231], v[164:167]
  s_add_u32 m0, s63, 51200
  s_mul_i32 s57, s97, 221184
  v_mfma_f32_16x16x32_bf16 v[164:167], v[44:47], a[244:247], v[164:167]
  buffer_load_dwordx4 v12, s[8:11], s57 offen lds
  v_mfma_f32_16x16x32_bf16 v[168:171], v[40:43], a[232:235], v[168:171]
  s_add_u32 m0, s63, 55296
  ds_read_b64_tr_b16 v[34:35], v4 offset:33280
  v_mfma_f32_16x16x32_bf16 v[168:171], v[44:47], a[248:251], v[168:171]
  ds_read_b64_tr_b16 v[36:37], v4 offset:36864
  v_mfma_f32_16x16x32_bf16 v[172:175], v[40:43], a[236:239], v[172:175]
  ds_read_b64_tr_b16 v[38:39], v4 offset:37376
  v_mfma_f32_16x16x32_bf16 v[172:175], v[44:47], a[252:255], v[172:175]
  s_waitcnt lgkmcnt(4)
  v_mfma_f32_16x16x32_bf16 v[176:179], v[24:27], a[224:227], v[176:179]
  ds_read_b64_tr_b16 v[40:41], v4 offset:40960
  v_mfma_f32_16x16x32_bf16 v[176:179], v[28:31], a[240:243], v[176:179]
  ds_read_b64_tr_b16 v[42:43], v4 offset:41472
  v_mfma_f32_16x16x32_bf16 v[180:183], v[24:27], a[228:231], v[180:183]
  ds_read_b64_tr_b16 v[44:45], v4 offset:45056
  v_mfma_f32_16x16x32_bf16 v[180:183], v[28:31], a[244:247], v[180:183]
  ds_read_b64_tr_b16 v[46:47], v4 offset:45568
  v_mfma_f32_16x16x32_bf16 v[184:187], v[24:27], a[232:235], v[184:187]
  v_mfma_f32_16x16x32_bf16 v[184:187], v[28:31], a[248:251], v[184:187]
  buffer_load_dwordx4 v22, s[8:11], s57 offen lds
  v_mfma_f32_16x16x32_bf16 v[188:191], v[24:27], a[236:239], v[188:191]
  s_add_u32 m0, s62, 59392
  v_mfma_f32_16x16x32_bf16 v[188:191], v[28:31], a[252:255], v[188:191]
  s_waitcnt lgkmcnt(4)
  v_mfma_f32_16x16x32_bf16 v[64:67], v[32:35], v[224:227], v[64:67]
  ds_read_b64_tr_b16 v[24:25], v5 offset:32768
  v_mfma_f32_16x16x32_bf16 v[64:67], v[36:39], v[240:243], v[64:67]
  ds_read_b64_tr_b16 v[26:27], v5 offset:33280
  v_mfma_f32_16x16x32_bf16 v[68:71], v[32:35], v[228:231], v[68:71]
  ds_read_b64_tr_b16 v[28:29], v5 offset:36864
  v_mfma_f32_16x16x32_bf16 v[68:71], v[36:39], v[244:247], v[68:71]
  ds_read_b64_tr_b16 v[30:31], v5 offset:37376
  v_mfma_f32_16x16x32_bf16 v[72:75], v[32:35], v[232:235], v[72:75]
  buffer_load_dword v55, v59, s[36:39], 0 offen sc1
  v_mfma_f32_16x16x32_bf16 v[72:75], v[36:39], v[248:251], v[72:75]
  v_mfma_f32_16x16x32_bf16 v[76:79], v[32:35], v[236:239], v[76:79]
  s_mov_b64 exec, 0xffff
  buffer_load_dwordx4 v23, s[8:11], s57 offen lds
  s_mov_b64 exec, -1
  v_mfma_f32_16x16x32_bf16 v[76:79], v[36:39], v[252:255], v[76:79]
  s_waitcnt lgkmcnt(4)
  s_add_u32 m0, s63, 0
  s_mul_i32 s57, s88, 221184
  v_mfma_f32_16x16x32_bf16 v[80:83], v[40:43], v[224:227], v[80:83]
  ds_read_b64_tr_b16 v[32:33], v5 offset:40960
  v_mfma_f32_16x16x32_bf16 v[80:83], v[44:47], v[240:243], v[80:83]
  buffer_load_dwordx4 v12, s[8:11], s57 offen lds
  v_mfma_f32_16x16x32_bf16 v[84:87], v[40:43], v[228:231], v[84:87]
  s_add_u32 m0, s63, 4096
  ds_read_b64_tr_b16 v[34:35], v5 offset:41472
  v_mfma_f32_16x16x32_bf16 v[84:87], v[44:47], v[244:247], v[84:87]
  ds_read_b64_tr_b16 v[36:37], v5 offset:45056
  v_mfma_f32_16x16x32_bf16 v[88:91], v[40:43], v[232:235], v[88:91]
  ds_read_b64_tr_b16 v[38:39], v5 offset:45568
  v_mfma_f32_16x16x32_bf16 v[88:91], v[44:47], v[248:251], v[88:91]
  v_mfma_f32_16x16x32_bf16 v[92:95], v[40:43], v[236:239], v[92:95]
  v_mfma_f32_16x16x32_bf16 v[92:95], v[44:47], v[252:255], v[92:95]
  s_waitcnt lgkmcnt(4)
  v_mfma_f32_16x16x32_bf16 v[96:99], v[24:27], v[224:227], v[96:99]
  ds_read_b64_tr_b16 v[40:41], v6 offset:32768
  v_mfma_f32_16x16x32_bf16 v[96:99], v[28:31], v[240:243], v[96:99]
  ds_read_b64_tr_b16 v[42:43], v6 offset:33280
  v_mfma_f32_16x16x32_bf16 v[100:103], v[24:27], v[228:231], v[100:103]
  ds_read_b64_tr_b16 v[44:45], v6 offset:36864
  v_mul_f32 v64, v64, v80
  v_mfma_f32_16x16x32_bf16 v[100:103], v[28:31], v[244:247], v[100:103]
  buffer_load_dwordx4 v22, s[8:11], s57 offen lds
  v_mfma_f32_16x16x32_bf16 v[104:107], v[24:27], v[232:235], v[104:107]
  s_add_u32 m0, s62, 8192
  ds_read_b64_tr_b16 v[46:47], v6 offset:37376
  v_mul_f32 v65, v65, v81
  v_mfma_f32_16x16x32_bf16 v[104:107], v[28:31], v[248:251], v[104:107]
  v_mul_f32 v66, v66, v82
  v_mul_f32 v67, v67, v83
  v_mfma_f32_16x16x32_bf16 v[108:111], v[24:27], v[236:239], v[108:111]
  v_cvt_pk_bf16_f32 v208, v64, v65
  v_mfma_f32_16x16x32_bf16 v[108:111], v[28:31], v[252:255], v[108:111]
  s_waitcnt lgkmcnt(4)
  v_cvt_pk_bf16_f32 v209, v66, v67
  v_mul_f32 v68, v68, v84
  v_mfma_f32_16x16x32_bf16 v[112:115], v[32:35], v[224:227], v[112:115]
  ds_read_b64_tr_b16 v[24:25], v6 offset:40960
  v_mul_f32 v69, v69, v85
  v_mfma_f32_16x16x32_bf16 v[112:115], v[36:39], v[240:243], v[112:115]
  ds_read_b64_tr_b16 v[26:27], v6 offset:41472
  v_mul_f32 v70, v70, v86
  v_mfma_f32_16x16x32_bf16 v[116:119], v[32:35], v[228:231], v[116:119]
  ds_read_b64_tr_b16 v[28:29], v6 offset:45056
  v_mul_f32 v71, v71, v87
  v_mfma_f32_16x16x32_bf16 v[116:119], v[36:39], v[244:247], v[116:119]
  ds_read_b64_tr_b16 v[30:31], v6 offset:45568
  v_cvt_pk_bf16_f32 v212, v68, v69
  v_mfma_f32_16x16x32_bf16 v[120:123], v[32:35], v[232:235], v[120:123]
  v_cvt_pk_bf16_f32 v213, v70, v71
  v_mul_f32 v72, v72, v88
  v_mfma_f32_16x16x32_bf16 v[120:123], v[36:39], v[248:251], v[120:123]
  s_mov_b64 exec, 0xffff
  buffer_load_dwordx4 v23, s[8:11], s57 offen lds
  s_mov_b64 exec, -1
  v_mfma_f32_16x16x32_bf16 v[124:127], v[32:35], v[236:239], v[124:127]
  s_add_u32 m0, s63, 9216
  s_mul_i32 s57, s89, 221184
  v_mul_f32 v73, v73, v89
  v_mfma_f32_16x16x32_bf16 v[124:127], v[36:39], v[252:255], v[124:127]
  s_waitcnt lgkmcnt(4)
  v_mul_f32 v74, v74, v90
  v_mul_f32 v75, v75, v91
  v_mfma_f32_16x16x32_bf16 v[128:131], v[40:43], v[224:227], v[128:131]
  buffer_load_dwordx4 v12, s[8:11], s57 offen lds
  v_mfma_f32_16x16x32_bf16 v[128:131], v[44:47], v[240:243], v[128:131]
  s_add_u32 m0, s63, 13312
  ds_read_b64_tr_b16 v[32:33], v7 offset:32768
  v_cvt_pk_bf16_f32 v216, v72, v73
  v_mfma_f32_16x16x32_bf16 v[132:135], v[40:43], v[228:231], v[132:135]
  ds_read_b64_tr_b16 v[34:35], v7 offset:33280
  v_cvt_pk_bf16_f32 v217, v74, v75
  v_mfma_f32_16x16x32_bf16 v[132:135], v[44:47], v[244:247], v[132:135]
  ds_read_b64_tr_b16 v[36:37], v7 offset:36864
  v_mul_f32 v76, v76, v92
  v_mfma_f32_16x16x32_bf16 v[136:139], v[40:43], v[232:235], v[136:139]
  ds_read_b64_tr_b16 v[38:39], v7 offset:37376
  v_mul_f32 v77, v77, v93
  v_mfma_f32_16x16x32_bf16 v[136:139], v[44:47], v[248:251], v[136:139]
  v_mul_f32 v78, v78, v94
  v_mul_f32 v79, v79, v95
  v_mfma_f32_16x16x32_bf16 v[140:143], v[40:43], v[236:239], v[140:143]
  v_cvt_pk_bf16_f32 v220, v76, v77
  v_mfma_f32_16x16x32_bf16 v[140:143], v[44:47], v[252:255], v[140:143]
  s_waitcnt lgkmcnt(4)
  v_cvt_pk_bf16_f32 v221, v78, v79
  v_mul_f32 v96, v96, v112
  v_mfma_f32_16x16x32_bf16 v[144:147], v[24:27], v[224:227], v[144:147]
  ds_read_b64_tr_b16 v[40:41], v7 offset:40960
  v_mul_f32 v97, v97, v113
  v_mfma_f32_16x16x32_bf16 v[144:147], v[28:31], v[240:243], v[144:147]
  ds_read_b64_tr_b16 v[42:43], v7 offset:41472
  v_mul_f32 v98, v98, v114
  v_mfma_f32_16x16x32_bf16 v[148:151], v[24:27], v[228:231], v[148:151]
  buffer_load_dwordx4 v22, s[8:11], s57 offen lds
  v_mfma_f32_16x16x32_bf16 v[148:151], v[28:31], v[244:247], v[148:151]
  s_add_u32 m0, s62, 17408
  ds_read_b64_tr_b16 v[44:45], v7 offset:45056
  v_mul_f32 v99, v99, v115
  v_mfma_f32_16x16x32_bf16 v[152:155], v[24:27], v[232:235], v[152:155]
  ds_read_b64_tr_b16 v[46:47], v7 offset:45568
  v_mul_f32 v100, v100, v116
  v_mfma_f32_16x16x32_bf16 v[152:155], v[28:31], v[248:251], v[152:155]
  v_mul_f32 v101, v101, v117
  v_mul_f32 v102, v102, v118
  v_mfma_f32_16x16x32_bf16 v[156:159], v[24:27], v[236:239], v[156:159]
  v_mul_f32 v103, v103, v119
  v_mfma_f32_16x16x32_bf16 v[156:159], v[28:31], v[252:255], v[156:159]
  s_waitcnt lgkmcnt(4) vmcnt(15)
  s_barrier
  v_mfma_f32_16x16x32_bf16 v[160:163], v[32:35], v[224:227], v[160:163]
  ds_read_b64_tr_b16 v[24:25], v14 offset:0
  v_mul_f32 v104, v104, v120
  v_mfma_f32_16x16x32_bf16 v[160:163], v[36:39], v[240:243], v[160:163]
  ds_read_b64_tr_b16 v[26:27], v14 offset:576
  v_mul_f32 v105, v105, v121
  v_mfma_f32_16x16x32_bf16 v[164:167], v[32:35], v[228:231], v[164:167]
  ds_read_b64_tr_b16 v[28:29], v14 offset:4608
  v_mul_f32 v128, v128, v144
  v_mfma_f32_16x16x32_bf16 v[164:167], v[36:39], v[244:247], v[164:167]
  ds_read_b64_tr_b16 v[30:31], v14 offset:5184
  v_mul_f32 v129, v129, v145
  v_mfma_f32_16x16x32_bf16 v[168:171], v[32:35], v[232:235], v[168:171]
  s_mov_b64 exec, 0xffff
  buffer_load_dwordx4 v23, s[8:11], s57 offen lds
  s_mov_b64 exec, -1
  v_mfma_f32_16x16x32_bf16 v[168:171], v[36:39], v[248:251], v[168:171]
  s_add_u32 m0, s63, 18432
  s_mul_i32 s57, s1, 221184
  v_mul_f32 v130, v130, v146
  v_mfma_f32_16x16x32_bf16 v[172:175], v[32:35], v[236:239], v[172:175]
  buffer_load_dwordx4 v12, s[8:11], s57 offen lds
  v_mfma_f32_16x16x32_bf16 v[172:175], v[36:39], v[252:255], v[172:175]
  s_waitcnt lgkmcnt(4)
  s_add_u32 m0, s63, 22528
  v_mul_f32 v131, v131, v147
  v_mfma_f32_16x16x32_bf16 v[176:179], v[40:43], v[224:227], v[176:179]
  ds_read_b64_tr_b16 v[32:33], v14 offset:48
  v_cvt_pk_bf16_f32 v144, v128, v129
  v_mfma_f32_16x16x32_bf16 v[176:179], v[44:47], v[240:243], v[176:179]
  ds_read_b64_tr_b16 v[34:35], v14 offset:624
  v_cvt_pk_bf16_f32 v145, v130, v131
  v_mfma_f32_16x16x32_bf16 v[180:183], v[40:43], v[228:231], v[180:183]
  ds_read_b64_tr_b16 v[36:37], v14 offset:4656
  v_mul_f32 v132, v132, v148
  v_mfma_f32_16x16x32_bf16 v[180:183], v[44:47], v[244:247], v[180:183]
  ds_read_b64_tr_b16 v[38:39], v14 offset:5232
  v_mul_f32 v133, v133, v149
  v_mfma_f32_16x16x32_bf16 v[184:187], v[40:43], v[232:235], v[184:187]
  v_mul_f32 v134, v134, v150
  v_mul_f32 v135, v135, v151
  v_mfma_f32_16x16x32_bf16 v[184:187], v[44:47], v[248:251], v[184:187]
  v_cvt_pk_bf16_f32 v148, v132, v133
  v_mfma_f32_16x16x32_bf16 v[188:191], v[40:43], v[236:239], v[188:191]
  v_cvt_pk_bf16_f32 v149, v134, v135
  v_mul_f32 v106, v106, v122
  v_mfma_f32_16x16x32_bf16 v[188:191], v[44:47], v[252:255], v[188:191]
  s_waitcnt lgkmcnt(4)
  v_mul_f32 v107, v107, v123
  v_mfma_f32_16x16x32_bf16 v[64:67], v[24:27], a[0:3], 0
  s_barrier
  v_mfma_f32_16x16x32_bf16 v[64:67], v[28:31], a[16:19], v[64:67]
  buffer_load_dwordx4 v22, s[8:11], s57 offen lds
  v_mfma_f32_16x16x32_bf16 v[68:71], v[24:27], a[4:7], 0
  s_add_u32 m0, s62, 26624
  ds_read_b64_tr_b16 v[40:41], v14 offset:96
  v_mul_f32 v108, v108, v124
  v_mfma_f32_16x16x32_bf16 v[68:71], v[28:31], a[20:23], v[68:71]
  ds_read_b64_tr_b16 v[42:43], v14 offset:672
  v_mul_f32 v109, v109, v125
  v_mfma_f32_16x16x32_bf16 v[72:75], v[24:27], a[8:11], 0
  ds_read_b64_tr_b16 v[44:45], v14 offset:4704
  v_mul_f32 v110, v110, v126
  v_mfma_f32_16x16x32_bf16 v[72:75], v[28:31], a[24:27], v[72:75]
  ds_read_b64_tr_b16 v[46:47], v14 offset:5280
  v_mul_f32 v111, v111, v127
  v_mfma_f32_16x16x32_bf16 v[76:79], v[24:27], a[12:15], 0
  ds_read_b128 v[128:131], v10 offset:0
  v_cvt_pk_bf16_f32 v210, v96, v97
  v_mfma_f32_16x16x32_bf16 v[76:79], v[28:31], a[28:31], v[76:79]
  s_waitcnt lgkmcnt(5)
  ds_read_b128 v[132:135], v10 offset:64
  v_cvt_pk_bf16_f32 v211, v98, v99
  v_mfma_f32_16x16x32_bf16 v[112:115], a[0:3], v[32:35], 0
  s_add_u32 s59, s77, 0
  ds_read_b64_tr_b16 v[24:25], v15 offset:0
  v_cvt_pk_bf16_f32 v214, v100, v101
  v_mfma_f32_16x16x32_bf16 v[112:115], a[16:19], v[36:39], v[112:115]
  ds_read_b64_tr_b16 v[26:27], v15 offset:576
  v_cvt_pk_bf16_f32 v215, v102, v103
  v_mfma_f32_16x16x32_bf16 v[116:119], a[4:7], v[32:35], 0
  ds_read_b64_tr_b16 v[28:29], v15 offset:4608
  v_cvt_pk_bf16_f32 v218, v104, v105
  v_mfma_f32_16x16x32_bf16 v[116:119], a[20:23], v[36:39], v[116:119]
  ds_read_b64_tr_b16 v[30:31], v15 offset:5184
  v_cvt_pk_bf16_f32 v219, v106, v107
  v_mfma_f32_16x16x32_bf16 v[120:123], a[8:11], v[32:35], 0
  buffer_store_dwordx4 v[208:211], v11, s[40:43], s59 offen sc1
  v_mfma_f32_16x16x32_bf16 v[120:123], a[24:27], v[36:39], v[120:123]
  v_cvt_pk_bf16_f32 v222, v108, v109
  v_cvt_pk_bf16_f32 v223, v110, v111
  v_mfma_f32_16x16x32_bf16 v[124:127], a[12:15], v[32:35], 0
  v_mul_f32 v136, v136, v152
  v_mfma_f32_16x16x32_bf16 v[124:127], a[28:31], v[36:39], v[124:127]
  s_waitcnt lgkmcnt(6)
  s_waitcnt lgkmcnt(4)
  v_mul_f32 v137, v137, v153
  v_mfma_f32_16x16x32_bf16 v[96:99], a[0:3], v[40:43], 0
  s_waitcnt lgkmcnt(0)
  v_cndmask_b32_e64 v24, v24, v128, s[78:79]
  v_cndmask_b32_e64 v25, v25, v129, s[78:79]
  v_mfma_f32_16x16x32_bf16 v[96:99], a[16:19], v[44:47], v[96:99]
  ds_read_b64_tr_b16 v[32:33], v14 offset:9216
  v_cndmask_b32_e64 v26, v26, v130, s[78:79]
  v_mfma_f32_16x16x32_bf16 v[100:103], a[4:7], v[40:43], 0
  ds_read_b64_tr_b16 v[34:35], v14 offset:9792
  v_cndmask_b32_e64 v27, v27, v131, s[78:79]
  v_mfma_f32_16x16x32_bf16 v[100:103], a[20:23], v[44:47], v[100:103]
  ds_read_b64_tr_b16 v[36:37], v14 offset:13824
  v_cndmask_b32_e64 v28, v28, v132, s[78:79]
  v_mfma_f32_16x16x32_bf16 v[104:107], a[8:11], v[40:43], 0
  ds_read_b64_tr_b16 v[38:39], v14 offset:14400
  v_cndmask_b32_e64 v29, v29, v133, s[78:79]
  v_mfma_f32_16x16x32_bf16 v[104:107], a[24:27], v[44:47], v[104:107]
  v_cndmask_b32_e64 v30, v30, v134, s[78:79]
  v_cndmask_b32_e64 v31, v31, v135, s[78:79]
  v_mfma_f32_16x16x32_bf16 v[108:111], a[12:15], v[40:43], 0
  v_mul_f32 v138, v138, v154
  v_mfma_f32_16x16x32_bf16 v[108:111], a[28:31], v[44:47], v[108:111]
  v_mul_f32 v139, v139, v155
  v_cvt_pk_bf16_f32 v152, v136, v137
  v_mfma_f32_16x16x32_bf16 v[192:195], a[0:3], v[24:27], 0
  ds_read_b64_tr_b16 v[40:41], v14 offset:9264
  v_cvt_pk_bf16_f32 v153, v138, v139
  v_mfma_f32_16x16x32_bf16 v[192:195], a[16:19], v[28:31], v[192:195]
  s_mov_b64 exec, 0xffff
  buffer_load_dwordx4 v23, s[8:11], s57 offen lds
  s_mov_b64 exec, -1
  v_mfma_f32_16x16x32_bf16 v[196:199], a[4:7], v[24:27], 0
  s_add_u32 m0, s61, 122880
  s_mul_i32 s58, s86, 589824
  v_mul_f32 v140, v140, v156
  v_mfma_f32_16x16x32_bf16 v[196:199], a[20:23], v[28:31], v[196:199]
  ds_read_b64_tr_b16 v[42:43], v14 offset:9840
  v_mul_f32 v141, v141, v157
  v_mfma_f32_16x16x32_bf16 v[200:203], a[8:11], v[24:27], 0
  buffer_load_dwordx4 v17, s[44:47], s58 offen lds
  v_mfma_f32_16x16x32_bf16 v[200:203], a[24:27], v[28:31], v[200:203]
  s_add_u32 m0, s61, 126976
  ds_read_b64_tr_b16 v[44:45], v14 offset:13872
  v_mul_f32 v142, v142, v158
  v_mfma_f32_16x16x32_bf16 v[204:207], a[12:15], v[24:27], 0
  ds_read_b64_tr_b16 v[46:47], v14 offset:14448
  v_mul_f32 v143, v143, v159
  v_mfma_f32_16x16x32_bf16 v[204:207], a[28:31], v[28:31], v[204:207]
  s_waitcnt lgkmcnt(4)
  v_cvt_pk_bf16_f32 v156, v140, v141
  v_cvt_pk_bf16_f32 v157, v142, v143
  v_mfma_f32_16x16x32_bf16 v[64:67], v[32:35], a[32:35], v[64:67]
  ds_read_b64_tr_b16 v[24:25], v14 offset:9312
  v_mul_f32 v160, v160, v176
  v_mfma_f32_16x16x32_bf16 v[64:67], v[36:39], a[48:51], v[64:67]
  ds_read_b64_tr_b16 v[26:27], v14 offset:9888
  v_mul_f32 v161, v161, v177
  v_mfma_f32_16x16x32_bf16 v[68:71], v[32:35], a[36:39], v[68:71]
  ds_read_b64_tr_b16 v[28:29], v14 offset:13920
  v_mul_f32 v162, v162, v178
  v_mfma_f32_16x16x32_bf16 v[68:71], v[36:39], a[52:55], v[68:71]
  buffer_load_dwordx4 v63, s[44:47], s58 offen lds
  v_mfma_f32_16x16x32_bf16 v[72:75], v[32:35], a[40:43], v[72:75]
  s_add_u32 s59, s77, 40960
  ds_read_b64_tr_b16 v[30:31], v14 offset:14496
  v_mul_f32 v163, v163, v179
  v_mfma_f32_16x16x32_bf16 v[72:75], v[36:39], a[56:59], v[72:75]
  ds_read_b128 v[136:139], v10 offset:128
  v_cvt_pk_bf16_f32 v146, v160, v161
  v_mfma_f32_16x16x32_bf16 v[76:79], v[32:35], a[44:47], v[76:79]
  ds_read_b128 v[140:143], v10 offset:192
  v_cvt_pk_bf16_f32 v147, v162, v163
  v_mfma_f32_16x16x32_bf16 v[76:79], v[36:39], a[60:63], v[76:79]
  s_waitcnt lgkmcnt(6)
  v_mul_f32 v164, v164, v180
  v_mul_f32 v165, v165, v181
  v_mfma_f32_16x16x32_bf16 v[112:115], a[32:35], v[40:43], v[112:115]
  ds_read_b64_tr_b16 v[32:33], v15 offset:9216
  v_mul_f32 v166, v166, v182
  v_mfma_f32_16x16x32_bf16 v[112:115], a[48:51], v[44:47], v[112:115]
  ds_read_b64_tr_b16 v[34:35], v15 offset:9792
  v_mul_f32 v167, v167, v183
  v_mfma_f32_16x16x32_bf16 v[116:119], a[36:39], v[40:43], v[116:119]
  ds_read_b64_tr_b16 v[36:37], v15 offset:13824
  v_cvt_pk_bf16_f32 v150, v164, v165
  v_mfma_f32_16x16x32_bf16 v[116:119], a[52:55], v[44:47], v[116:119]
  ds_read_b64_tr_b16 v[38:39], v15 offset:14400
  v_cvt_pk_bf16_f32 v151, v166, v167
  v_mfma_f32_16x16x32_bf16 v[120:123], a[40:43], v[40:43], v[120:123]
  buffer_store_dwordx4 v[212:215], v11, s[40:43], s59 offen sc1
  v_mfma_f32_16x16x32_bf16 v[120:123], a[56:59], v[44:47], v[120:123]
  s_add_u32 m0, s61, 131072
  s_mul_i32 s58, s87, 589824
  v_mul_f32 v168, v168, v184
  v_mfma_f32_16x16x32_bf16 v[124:127], a[44:47], v[40:43], v[124:127]
  v_mul_f32 v169, v169, v185
  v_mul_f32 v170, v170, v186
  v_mfma_f32_16x16x32_bf16 v[124:127], a[60:63], v[44:47], v[124:127]
  s_waitcnt lgkmcnt(6)
  s_waitcnt lgkmcnt(4)
  v_mul_f32 v171, v171, v187
  v_mfma_f32_16x16x32_bf16 v[96:99], a[32:35], v[24:27], v[96:99]
  s_waitcnt lgkmcnt(0)
  v_cndmask_b32_e64 v32, v32, v136, s[78:79]
  v_cndmask_b32_e64 v33, v33, v137, s[78:79]
  v_mfma_f32_16x16x32_bf16 v[96:99], a[48:51], v[28:31], v[96:99]
  ds_read_b64_tr_b16 v[40:41], v14 offset:18432
  v_cndmask_b32_e64 v34, v34, v138, s[78:79]
  v_mfma_f32_16x16x32_bf16 v[100:103], a[36:39], v[24:27], v[100:103]
  s_waitcnt vmcnt(14)
  v_readfirstlane_b32 s85, v55
  v_cndmask_b32_e64 v35, v35, v139, s[78:79]
  v_mfma_f32_16x16x32_bf16 v[100:103], a[52:55], v[28:31], v[100:103]
  s_cmp_lg_u32 s85, 0
  s_cbranch_scc0 L_slow_5
L_ok_4:
  v_mfma_f32_16x16x32_bf16 v[104:107], a[40:43], v[24:27], v[104:107]
  ds_read_b64_tr_b16 v[42:43], v14 offset:19008
  v_cndmask_b32_e64 v36, v36, v140, s[78:79]
  v_mfma_f32_16x16x32_bf16 v[104:107], a[56:59], v[28:31], v[104:107]
  ds_read_b64_tr_b16 v[44:45], v14 offset:23040
  v_cndmask_b32_e64 v37, v37, v141, s[78:79]
  v_mfma_f32_16x16x32_bf16 v[108:111], a[44:47], v[24:27], v[108:111]
  ds_read_b64_tr_b16 v[46:47], v14 offset:23616
  v_cndmask_b32_e64 v38, v38, v142, s[78:79]
  v_mfma_f32_16x16x32_bf16 v[108:111], a[60:63], v[28:31], v[108:111]
  v_cndmask_b32_e64 v39, v39, v143, s[78:79]
  v_cvt_pk_bf16_f32 v154, v168, v169
  v_mfma_f32_16x16x32_bf16 v[192:195], a[32:35], v[32:35], v[192:195]
  ds_read_b64_tr_b16 v[24:25], v14 offset:18480
  v_cvt_pk_bf16_f32 v155, v170, v171
  v_mfma_f32_16x16x32_bf16 v[192:195], a[48:51], v[36:39], v[192:195]
  ds_read_b64_tr_b16 v[26:27], v14 offset:19056
  v_mul_f32 v172, v172, v188
  v_mfma_f32_16x16x32_bf16 v[196:199], a[36:39], v[32:35], v[196:199]
  buffer_load_dwordx4 v17, s[44:47], s58 offen lds
  v_mfma_f32_16x16x32_bf16 v[196:199], a[52:55], v[36:39], v[196:199]
  s_add_u32 m0, s61, 135168
  ds_read_b64_tr_b16 v[28:29], v14 offset:23088
  v_mul_f32 v173, v173, v189
  v_mfma_f32_16x16x32_bf16 v[200:203], a[40:43], v[32:35], v[200:203]
  s_mul_i32 s83, s53, 288
  ds_read_b64_tr_b16 v[30:31], v14 offset:23664
  v_mul_f32 v174, v174, v190
  v_mfma_f32_16x16x32_bf16 v[200:203], a[56:59], v[36:39], v[200:203]
  s_lshl_b32 s71, s51, 1
  v_mul_f32 v175, v175, v191
  v_cvt_pk_bf16_f32 v158, v172, v173
  v_mfma_f32_16x16x32_bf16 v[204:207], a[44:47], v[32:35], v[204:207]
  s_min_u32 s84, s51, 1
  s_add_u32 s71, s71, s84
  v_cvt_pk_bf16_f32 v159, v174, v175
  v_mfma_f32_16x16x32_bf16 v[204:207], a[60:63], v[36:39], v[204:207]
  s_waitcnt lgkmcnt(4)
  s_lshl_b32 s91, s71, 1
  v_or_b32 v53, s48, v0
  v_mfma_f32_16x16x32_bf16 v[64:67], v[40:43], a[64:67], v[64:67]
  s_sub_u32 s84, s83, 0
  ds_read_b64_tr_b16 v[32:33], v14 offset:18528
  v_cmp_eq_u32 vcc, 0, v53
  v_mfma_f32_16x16x32_bf16 v[64:67], v[44:47], a[80:83], v[64:67]
  buffer_load_dwordx4 v63, s[44:47], s58 offen lds
  v_mfma_f32_16x16x32_bf16 v[68:71], v[40:43], a[68:71], v[68:71]
  s_add_u32 m0, s61, 139264
  s_mul_i32 s58, s3, 589824
  v_add_u32 v53, 0, v0
  v_mfma_f32_16x16x32_bf16 v[68:71], v[44:47], a[84:87], v[68:71]
  ds_read_b64_tr_b16 v[34:35], v14 offset:19104
  v_mul_u32_u24 v61, 3641, v53
  v_mfma_f32_16x16x32_bf16 v[72:75], v[40:43], a[72:75], v[72:75]
  s_add_u32 s59, s77, 81920
  ds_read_b64_tr_b16 v[36:37], v14 offset:23136
  v_lshrrev_b32 v61, 16, v61
  v_mfma_f32_16x16x32_bf16 v[72:75], v[44:47], a[88:91], v[72:75]
  ds_read_b64_tr_b16 v[38:39], v14 offset:23712
  v_subrev_u32 v14, 32768, v14
  v_mfma_f32_16x16x32_bf16 v[76:79], v[40:43], a[76:79], v[76:79]
  ds_read_b128 v[128:131], v10 offset:256
  v_mul_u32_u24 v1, 18, v61
  v_mfma_f32_16x16x32_bf16 v[76:79], v[44:47], a[92:95], v[76:79]
  s_waitcnt lgkmcnt(5)
  ds_read_b128 v[132:135], v10 offset:320
  v_sub_u32 v53, v53, v1
  v_mfma_f32_16x16x32_bf16 v[112:115], a[64:67], v[24:27], v[112:115]
  ds_read_b64_tr_b16 v[40:41], v15 offset:18432
  v_add_u32 v53, s91, v53
  v_mfma_f32_16x16x32_bf16 v[112:115], a[80:83], v[28:31], v[112:115]
  ds_read_b64_tr_b16 v[42:43], v15 offset:19008
  buffer_store_dwordx4 v[216:219], v11, s[40:43], s59 offen sc1
  v_mfma_f32_16x16x32_bf16 v[116:119], a[68:71], v[24:27], v[116:119]
  ds_read_b64_tr_b16 v[44:45], v15 offset:23040
  v_subrev_u32 v1, 18, v53
  v_mfma_f32_16x16x32_bf16 v[116:119], a[84:87], v[28:31], v[116:119]
  ds_read_b64_tr_b16 v[46:47], v15 offset:23616
  v_subrev_u32 v15, 32768, v15
  v_mfma_f32_16x16x32_bf16 v[120:123], a[72:75], v[24:27], v[120:123]
  v_min_u32 v53, v53, v1
  v_mul_u32_u24 v61, 1152, v61
  v_mfma_f32_16x16x32_bf16 v[120:123], a[88:91], v[28:31], v[120:123]
  v_lshl_add_u32 v53, v53, 4, v61
  v_mfma_f32_16x16x32_bf16 v[124:127], a[76:79], v[24:27], v[124:127]
  v_add_u32 v1, s84, v53
  v_add_u32 v53, 64, v0
  v_mfma_f32_16x16x32_bf16 v[124:127], a[92:95], v[28:31], v[124:127]
  s_waitcnt lgkmcnt(6)
  s_waitcnt lgkmcnt(0) vmcnt(16)
  s_barrier
  v_mfma_f32_16x16x32_bf16 v[96:99], a[64:67], v[32:35], v[96:99]
  s_waitcnt lgkmcnt(4)
  s_waitcnt lgkmcnt(0)
  v_cndmask_b32_e64 v40, v40, v128, s[78:79]
  v_mfma_f32_16x16x32_bf16 v[96:99], a[80:83], v[36:39], v[96:99]
  s_sub_u32 s84, s83, 1024
  v_cndmask_b32_e64 v41, v41, v129, s[78:79]
  v_cndmask_b32_e64 v42, v42, v130, s[78:79]
  v_mfma_f32_16x16x32_bf16 v[100:103], a[68:71], v[32:35], v[100:103]
  ds_read_b64_tr_b16 v[24:25], v14 offset:0
  v_cndmask_b32_e64 v43, v43, v131, s[78:79]
  v_mfma_f32_16x16x32_bf16 v[100:103], a[84:87], v[36:39], v[100:103]
  ds_read_b64_tr_b16 v[26:27], v14 offset:576
  v_cndmask_b32_e64 v44, v44, v132, s[78:79]
  v_mfma_f32_16x16x32_bf16 v[104:107], a[72:75], v[32:35], v[104:107]
  ds_read_b64_tr_b16 v[28:29], v14 offset:4608
  v_cndmask_b32_e64 v45, v45, v133, s[78:79]
  v_mfma_f32_16x16x32_bf16 v[104:107], a[88:91], v[36:39], v[104:107]
  ds_read_b64_tr_b16 v[30:31], v14 offset:5184
  v_cndmask_b32_e64 v46, v46, v134, s[78:79]
  v_mfma_f32_16x16x32_bf16 v[108:111], a[76:79], v[32:35], v[108:111]
  v_cndmask_b32_e64 v47, v47, v135, s[78:79]
  v_mul_u32_u24 v61, 3641, v53
  v_mfma_f32_16x16x32_bf16 v[108:111], a[92:95], v[36:39], v[108:111]
  buffer_load_dwordx4 v17, s[44:47], s58 offen lds
  v_mfma_f32_16x16x32_bf16 v[192:195], a[64:67], v[40:43], v[192:195]
  s_add_u32 m0, s61, 143360
  ds_read_b64_tr_b16 v[32:33], v14 offset:48
  v_sub_u32 v52, 35, v0
  v_mfma_f32_16x16x32_bf16 v[192:195], a[80:83], v[44:47], v[192:195]
  ds_read_b64_tr_b16 v[34:35], v14 offset:624
  v_and_b32 v52, 0x7f000000, v52
  v_mfma_f32_16x16x32_bf16 v[196:199], a[68:71], v[40:43], v[196:199]
  ds_read_b64_tr_b16 v[36:37], v14 offset:4656
  v_lshl_or_b32 v52, v0, 7, v52
  v_mfma_f32_16x16x32_bf16 v[196:199], a[84:87], v[44:47], v[196:199]
  ds_read_b64_tr_b16 v[38:39], v14 offset:5232
  v_lshrrev_b32 v61, 16, v61
  v_mfma_f32_16x16x32_bf16 v[200:203], a[72:75], v[40:43], v[200:203]
  v_mul_u32_u24 v2, 18, v61
  v_sub_u32 v53, v53, v2
  v_mfma_f32_16x16x32_bf16 v[200:203], a[88:91], v[44:47], v[200:203]
  buffer_load_dword v48, v52, s[24:27], s16 offen
  v_mfma_f32_16x16x32_bf16 v[204:207], a[76:79], v[40:43], v[204:207]
  v_add_u32 v53, s91, v53
  v_subrev_u32 v2, 18, v53
  v_mfma_f32_16x16x32_bf16 v[204:207], a[92:95], v[44:47], v[204:207]
  s_waitcnt lgkmcnt(4)
  v_min_u32 v53, v53, v2
  v_mfma_f32_16x16x32_bf16 v[64:67], v[24:27], a[96:99], v[64:67]
  ds_read_b64_tr_b16 v[40:41], v14 offset:96
  v_mul_u32_u24 v61, 1152, v61
  v_mfma_f32_16x16x32_bf16 v[64:67], v[28:31], a[112:115], v[64:67]
  s_add_u32 s59, s77, 122880
  ds_read_b64_tr_b16 v[42:43], v14 offset:672
  v_lshl_add_u32 v53, v53, 4, v61
  v_mfma_f32_16x16x32_bf16 v[68:71], v[24:27], a[100:103], v[68:71]
  ds_read_b64_tr_b16 v[44:45], v14 offset:4704
  v_add_u32 v2, s84, v53
  v_mfma_f32_16x16x32_bf16 v[68:71], v[28:31], a[116:119], v[68:71]
  s_sub_u32 s84, s83, 2048
  ds_read_b64_tr_b16 v[46:47], v14 offset:5280
  v_add_u32 v53, 128, v0
  v_mfma_f32_16x16x32_bf16 v[72:75], v[24:27], a[104:107], v[72:75]
  s_mul_i32 s16, s51, 10368
  ds_read_b128 v[136:139], v10 offset:384
  v_mul_u32_u24 v61, 3641, v53
  v_mfma_f32_16x16x32_bf16 v[72:75], v[28:31], a[120:123], v[72:75]
  ds_read_b128 v[140:143], v10 offset:448
  v_lshrrev_b32 v61, 16, v61
  v_mfma_f32_16x16x32_bf16 v[76:79], v[24:27], a[108:111], v[76:79]
  v_mul_u32_u24 v3, 18, v61
  v_sub_u32 v53, v53, v3
  v_mfma_f32_16x16x32_bf16 v[76:79], v[28:31], a[124:127], v[76:79]
  s_waitcnt lgkmcnt(6)
  v_add_u32 v53, s91, v53
  v_mfma_f32_16x16x32_bf16 v[112:115], a[96:99], v[32:35], v[112:115]
  ds_read_b64_tr_b16 v[24:25], v15 offset:0
  v_subrev_u32 v3, 18, v53
  v_mfma_f32_16x16x32_bf16 v[112:115], a[112:115], v[36:39], v[112:115]
  ds_read_b64_tr_b16 v[26:27], v15 offset:576
  v_min_u32 v53, v53, v3
  v_mfma_f32_16x16x32_bf16 v[116:119], a[100:103], v[32:35], v[116:119]
  ds_read_b64_tr_b16 v[28:29], v15 offset:4608
  v_mul_u32_u24 v61, 1152, v61
  v_mfma_f32_16x16x32_bf16 v[116:119], a[116:119], v[36:39], v[116:119]
  ds_read_b64_tr_b16 v[30:31], v15 offset:5184
  v_lshl_add_u32 v53, v53, 4, v61
  v_mfma_f32_16x16x32_bf16 v[120:123], a[104:107], v[32:35], v[120:123]
  v_add_u32 v3, s84, v53
  v_add_u32 v53, 192, v0
  v_mfma_f32_16x16x32_bf16 v[120:123], a[120:123], v[36:39], v[120:123]
  s_sub_u32 s84, s83, 3072
  v_mul_u32_u24 v61, 3641, v53
  v_mfma_f32_16x16x32_bf16 v[124:127], a[108:111], v[32:35], v[124:127]
  v_lshrrev_b32 v61, 16, v61
  v_mul_u32_u24 v4, 18, v61
  v_mfma_f32_16x16x32_bf16 v[124:127], a[124:127], v[36:39], v[124:127]
  s_waitcnt lgkmcnt(6)
  s_waitcnt lgkmcnt(4)
  v_sub_u32 v53, v53, v4
  v_mfma_f32_16x16x32_bf16 v[96:99], a[96:99], v[40:43], v[96:99]
  s_waitcnt lgkmcnt(0)
  v_cndmask_b32_e64 v24, v24, v136, s[78:79]
  v_cndmask_b32_e64 v25, v25, v137, s[78:79]
  v_mfma_f32_16x16x32_bf16 v[96:99], a[112:115], v[44:47], v[96:99]
  ds_read_b64_tr_b16 v[32:33], v14 offset:9216
  v_cndmask_b32_e64 v26, v26, v138, s[78:79]
  v_mfma_f32_16x16x32_bf16 v[100:103], a[100:103], v[40:43], v[100:103]
  ds_read_b64_tr_b16 v[34:35], v14 offset:9792
  v_cndmask_b32_e64 v27, v27, v139, s[78:79]
  v_mfma_f32_16x16x32_bf16 v[100:103], a[116:119], v[44:47], v[100:103]
  ds_read_b64_tr_b16 v[36:37], v14 offset:13824
  v_cndmask_b32_e64 v28, v28, v140, s[78:79]
  v_mfma_f32_16x16x32_bf16 v[104:107], a[104:107], v[40:43], v[104:107]
  ds_read_b64_tr_b16 v[38:39], v14 offset:14400
  v_cndmask_b32_e64 v29, v29, v141, s[78:79]
  v_mfma_f32_16x16x32_bf16 v[104:107], a[120:123], v[44:47], v[104:107]
  v_cndmask_b32_e64 v30, v30, v142, s[78:79]
  v_cndmask_b32_e64 v31, v31, v143, s[78:79]
  v_mfma_f32_16x16x32_bf16 v[108:111], a[108:111], v[40:43], v[108:111]
  v_add_u32 v53, s91, v53
  v_mfma_f32_16x16x32_bf16 v[108:111], a[124:127], v[44:47], v[108:111]
  v_subrev_u32 v4, 18, v53
  v_min_u32 v53, v53, v4
  v_mfma_f32_16x16x32_bf16 v[192:195], a[96:99], v[24:27], v[192:195]
  ds_read_b64_tr_b16 v[40:41], v14 offset:9264
  v_mul_u32_u24 v61, 1152, v61
  v_mfma_f32_16x16x32_bf16 v[192:195], a[112:115], v[28:31], v[192:195]
  ds_read_b64_tr_b16 v[42:43], v14 offset:9840
  v_lshl_add_u32 v53, v53, 4, v61
  v_mfma_f32_16x16x32_bf16 v[196:199], a[100:103], v[24:27], v[196:199]
  ds_read_b64_tr_b16 v[44:45], v14 offset:13872
  v_add_u32 v4, s84, v53
  v_mfma_f32_16x16x32_bf16 v[196:199], a[116:119], v[28:31], v[196:199]
  s_sub_u32 s84, s83, 0
  ds_read_b64_tr_b16 v[46:47], v14 offset:14448
  v_add_u32 v53, 256, v0
  v_mfma_f32_16x16x32_bf16 v[200:203], a[104:107], v[24:27], v[200:203]
  v_mul_u32_u24 v61, 3641, v53
  v_lshrrev_b32 v61, 16, v61
  v_mfma_f32_16x16x32_bf16 v[200:203], a[120:123], v[28:31], v[200:203]
  v_mul_u32_u24 v5, 18, v61
  v_mfma_f32_16x16x32_bf16 v[204:207], a[108:111], v[24:27], v[204:207]
  v_sub_u32 v53, v53, v5
  v_add_u32 v53, s91, v53
  v_mfma_f32_16x16x32_bf16 v[204:207], a[124:127], v[28:31], v[204:207]
  s_waitcnt lgkmcnt(4)
  v_subrev_u32 v5, 18, v53
  v_mfma_f32_16x16x32_bf16 v[64:67], v[32:35], a[128:131], v[64:67]
  buffer_store_dwordx4 v[220:223], v11, s[40:43], s59 offen sc1
  v_mfma_f32_16x16x32_bf16 v[64:67], v[36:39], a[144:147], v[64:67]
  ds_read_b64_tr_b16 v[24:25], v14 offset:9312
  v_min_u32 v53, v53, v5
  v_mfma_f32_16x16x32_bf16 v[68:71], v[32:35], a[132:135], v[68:71]
  ds_read_b64_tr_b16 v[26:27], v14 offset:9888
  v_mul_u32_u24 v61, 1152, v61
  v_mfma_f32_16x16x32_bf16 v[68:71], v[36:39], a[148:151], v[68:71]
  ds_read_b64_tr_b16 v[28:29], v14 offset:13920
  v_lshl_add_u32 v53, v53, 4, v61
  v_mfma_f32_16x16x32_bf16 v[72:75], v[32:35], a[136:139], v[72:75]
  ds_read_b64_tr_b16 v[30:31], v14 offset:14496
  v_add_u32 v5, s84, v53
  v_mfma_f32_16x16x32_bf16 v[72:75], v[36:39], a[152:155], v[72:75]
  s_sub_u32 s84, s83, 1024
  ds_read_b128 v[128:131], v10 offset:512
  v_add_u32 v53, 320, v0
  v_mfma_f32_16x16x32_bf16 v[76:79], v[32:35], a[140:143], v[76:79]
  ds_read_b128 v[132:135], v10 offset:576
  v_mul_u32_u24 v61, 3641, v53
  v_mfma_f32_16x16x32_bf16 v[76:79], v[36:39], a[156:159], v[76:79]
  s_waitcnt lgkmcnt(6)
  v_lshrrev_b32 v61, 16, v61
  v_mul_u32_u24 v6, 18, v61
  v_mfma_f32_16x16x32_bf16 v[112:115], a[128:131], v[40:43], v[112:115]
  ds_read_b64_tr_b16 v[32:33], v15 offset:9216
  v_sub_u32 v53, v53, v6
  v_mfma_f32_16x16x32_bf16 v[112:115], a[144:147], v[44:47], v[112:115]
  ds_read_b64_tr_b16 v[34:35], v15 offset:9792
  v_add_u32 v53, s91, v53
  v_mfma_f32_16x16x32_bf16 v[116:119], a[132:135], v[40:43], v[116:119]
  ds_read_b64_tr_b16 v[36:37], v15 offset:13824
  v_subrev_u32 v6, 18, v53
  v_mfma_f32_16x16x32_bf16 v[116:119], a[148:151], v[44:47], v[116:119]
  ds_read_b64_tr_b16 v[38:39], v15 offset:14400
  v_min_u32 v53, v53, v6
  v_mfma_f32_16x16x32_bf16 v[120:123], a[136:139], v[40:43], v[120:123]
  v_mul_u32_u24 v61, 1152, v61
  v_lshl_add_u32 v53, v53, 4, v61
  v_mfma_f32_16x16x32_bf16 v[120:123], a[152:155], v[44:47], v[120:123]
  v_add_u32 v6, s84, v53
  v_mfma_f32_16x16x32_bf16 v[124:127], a[140:143], v[40:43], v[124:127]
  s_sub_u32 s84, s83, 2048
  v_add_u32 v53, 384, v0
  v_mul_u32_u24 v61, 3641, v53
  v_mfma_f32_16x16x32_bf16 v[124:127], a[156:159], v[44:47], v[124:127]
  s_waitcnt lgkmcnt(6)
  s_waitcnt lgkmcnt(4)
  v_lshrrev_b32 v61, 16, v61
  v_mfma_f32_16x16x32_bf16 v[96:99], a[128:131], v[24:27], v[96:99]
  buffer_load_dwordx4 v63, s[44:47], s58 offen lds
  v_mfma_f32_16x16x32_bf16 v[96:99], a[144:147], v[28:31], v[96:99]
  s_add_u32 m0, s61, 98304
  s_mul_i32 s58, s100, 589824
  s_waitcnt lgkmcnt(0)
  v_mfma_f32_16x16x32_bf16 v[100:103], a[132:135], v[24:27], v[100:103]
  v_cndmask_b32_e64 v32, v32, v128, s[78:79]
  v_cndmask_b32_e64 v33, v33, v129, s[78:79]
  v_mfma_f32_16x16x32_bf16 v[100:103], a[148:151], v[28:31], v[100:103]
  ds_read_b64_tr_b16 v[40:41], v14 offset:18432
  v_cndmask_b32_e64 v34, v34, v130, s[78:79]
  v_mfma_f32_16x16x32_bf16 v[104:107], a[136:139], v[24:27], v[104:107]
  ds_read_b64_tr_b16 v[42:43], v14 offset:19008
  v_cndmask_b32_e64 v35, v35, v131, s[78:79]
  v_mfma_f32_16x16x32_bf16 v[104:107], a[152:155], v[28:31], v[104:107]
  ds_read_b64_tr_b16 v[44:45], v14 offset:23040
  v_cndmask_b32_e64 v36, v36, v132, s[78:79]
  v_mfma_f32_16x16x32_bf16 v[108:111], a[140:143], v[24:27], v[108:111]
  buffer_load_dwordx4 v17, s[44:47], s58 offen lds
  v_mfma_f32_16x16x32_bf16 v[108:111], a[156:159], v[28:31], v[108:111]
  ds_read_b64_tr_b16 v[46:47], v14 offset:23616
  v_cndmask_b32_e64 v37, v37, v133, s[78:79]
  v_cndmask_b32_e64 v38, v38, v134, s[78:79]
  v_cndmask_b32_e64 v39, v39, v135, s[78:79]
  v_mfma_f32_16x16x32_bf16 v[192:195], a[128:131], v[32:35], v[192:195]
  s_add_u32 s59, s77, 1024
  ds_read_b64_tr_b16 v[24:25], v14 offset:18480
  v_mul_u32_u24 v7, 18, v61
  v_mfma_f32_16x16x32_bf16 v[192:195], a[144:147], v[36:39], v[192:195]
  ds_read_b64_tr_b16 v[26:27], v14 offset:19056
  v_sub_u32 v53, v53, v7
  v_mfma_f32_16x16x32_bf16 v[196:199], a[132:135], v[32:35], v[196:199]
  ds_read_b64_tr_b16 v[28:29], v14 offset:23088
  v_add_u32 v53, s91, v53
  v_mfma_f32_16x16x32_bf16 v[196:199], a[148:151], v[36:39], v[196:199]
  ds_read_b64_tr_b16 v[30:31], v14 offset:23664
  v_subrev_u32 v7, 18, v53
  v_mfma_f32_16x16x32_bf16 v[200:203], a[136:139], v[32:35], v[200:203]
  v_min_u32 v53, v53, v7
  v_mul_u32_u24 v61, 1152, v61
  v_mfma_f32_16x16x32_bf16 v[200:203], a[152:155], v[36:39], v[200:203]
  v_lshl_add_u32 v53, v53, 4, v61
  v_mfma_f32_16x16x32_bf16 v[204:207], a[140:143], v[32:35], v[204:207]
  v_add_u32 v7, s84, v53
  v_add_u32 v53, 448, v0
  v_mfma_f32_16x16x32_bf16 v[204:207], a[156:159], v[36:39], v[204:207]
  s_waitcnt lgkmcnt(4)
  s_sub_u32 s84, s83, 3072
  v_mul_u32_u24 v61, 3641, v53
  v_mfma_f32_16x16x32_bf16 v[64:67], v[40:43], a[160:163], v[64:67]
  buffer_store_dwordx4 v[144:147], v11, s[40:43], s59 offen sc1
  v_mfma_f32_16x16x32_bf16 v[64:67], v[44:47], a[176:179], v[64:67]
  s_add_u32 m0, s61, 102400
  ds_read_b64_tr_b16 v[32:33], v14 offset:18528
  v_lshrrev_b32 v61, 16, v61
  v_mfma_f32_16x16x32_bf16 v[68:71], v[40:43], a[164:167], v[68:71]
  ds_read_b64_tr_b16 v[34:35], v14 offset:19104
  v_mul_u32_u24 v8, 18, v61
  v_mfma_f32_16x16x32_bf16 v[68:71], v[44:47], a[180:183], v[68:71]
  ds_read_b64_tr_b16 v[36:37], v14 offset:23136
  v_sub_u32 v53, v53, v8
  v_mfma_f32_16x16x32_bf16 v[72:75], v[40:43], a[168:171], v[72:75]
  ds_read_b64_tr_b16 v[38:39], v14 offset:23712
  v_subrev_u32 v14, 32768, v14
  v_mfma_f32_16x16x32_bf16 v[72:75], v[44:47], a[184:187], v[72:75]
  ds_read_b128 v[136:139], v10 offset:640
  v_add_u32 v53, s91, v53
  v_mfma_f32_16x16x32_bf16 v[76:79], v[40:43], a[172:175], v[76:79]
  ds_read_b128 v[140:143], v10 offset:704
  v_subrev_u32 v8, 18, v53
  v_mfma_f32_16x16x32_bf16 v[76:79], v[44:47], a[188:191], v[76:79]
  s_waitcnt lgkmcnt(6)
  v_min_u32 v53, v53, v8
  v_mul_u32_u24 v61, 1152, v61
  v_mfma_f32_16x16x32_bf16 v[112:115], a[160:163], v[24:27], v[112:115]
  ds_read_b64_tr_b16 v[40:41], v15 offset:18432
  v_lshl_add_u32 v53, v53, 4, v61
  v_mfma_f32_16x16x32_bf16 v[112:115], a[176:179], v[28:31], v[112:115]
  ds_read_b64_tr_b16 v[42:43], v15 offset:19008
  v_add_u32 v8, s84, v53
  v_mfma_f32_16x16x32_bf16 v[116:119], a[164:167], v[24:27], v[116:119]
  s_sub_u32 s84, s83, 0
  ds_read_b64_tr_b16 v[44:45], v15 offset:23040
  v_add_u32 v53, 512, v0
  v_mfma_f32_16x16x32_bf16 v[116:119], a[180:183], v[28:31], v[116:119]
  s_lshl_b32 s83, s54, 2
  ds_read_b64_tr_b16 v[46:47], v15 offset:23616
  v_subrev_u32 v15, 32768, v15
  v_mfma_f32_16x16x32_bf16 v[120:123], a[168:171], v[24:27], v[120:123]
  s_add_u32 s83, s83, s48
  v_mul_u32_u24 v61, 3641, v53
  v_lshrrev_b32 v61, 16, v61
  v_mfma_f32_16x16x32_bf16 v[120:123], a[184:187], v[28:31], v[120:123]
  buffer_load_dwordx4 v63, s[44:47], s58 offen lds
  v_mfma_f32_16x16x32_bf16 v[124:127], a[172:175], v[24:27], v[124:127]
  s_add_u32 m0, s61, 106496
  s_mul_i32 s58, s101, 589824
  v_mul_u32_u24 v9, 18, v61
  v_mfma_f32_16x16x32_bf16 v[124:127], a[188:191], v[28:31], v[124:127]
  s_waitcnt lgkmcnt(6) vmcnt(13)
  s_barrier
  v_mfma_f32_16x16x32_bf16 v[96:99], a[160:163], v[32:35], v[96:99]
  s_waitcnt lgkmcnt(4)
  s_waitcnt lgkmcnt(0)
  v_cndmask_b32_e64 v40, v40, v136, s[78:79]
  v_mfma_f32_16x16x32_bf16 v[96:99], a[176:179], v[36:39], v[96:99]
  s_mul_i32 s19, s83, 11
  v_cndmask_b32_e64 v41, v41, v137, s[78:79]
  v_cndmask_b32_e64 v42, v42, v138, s[78:79]
  v_mfma_f32_16x16x32_bf16 v[100:103], a[164:167], v[32:35], v[100:103]
  s_and_b32 s18, s83, 63
  ds_read_b64_tr_b16 v[24:25], v14 offset:0
  v_cndmask_b32_e64 v43, v43, v139, s[78:79]
  v_mfma_f32_16x16x32_bf16 v[100:103], a[180:183], v[36:39], v[100:103]
  s_mul_i32 s18, s18, 9
  ds_read_b64_tr_b16 v[26:27], v14 offset:576
  v_cndmask_b32_e64 v44, v44, v140, s[78:79]
  v_mfma_f32_16x16x32_bf16 v[104:107], a[168:171], v[32:35], v[104:107]
  ds_read_b64_tr_b16 v[28:29], v14 offset:4608
  v_cndmask_b32_e64 v45, v45, v141, s[78:79]
  v_mfma_f32_16x16x32_bf16 v[104:107], a[184:187], v[36:39], v[104:107]
  ds_read_b64_tr_b16 v[30:31], v14 offset:5184
  v_cndmask_b32_e64 v46, v46, v142, s[78:79]
  v_mfma_f32_16x16x32_bf16 v[108:111], a[172:175], v[32:35], v[108:111]
  buffer_load_dwordx4 v17, s[44:47], s58 offen lds
  v_mfma_f32_16x16x32_bf16 v[108:111], a[188:191], v[36:39], v[108:111]
  s_add_u32 m0, s61, 110592
  v_cndmask_b32_e64 v47, v47, v143, s[78:79]
  v_sub_u32 v53, v53, v9
  v_mfma_f32_16x16x32_bf16 v[192:195], a[160:163], v[40:43], v[192:195]
  s_add_u32 s59, s77, 41984
  ds_read_b64_tr_b16 v[32:33], v14 offset:48
  v_add_u32 v53, s91, v53
  v_mfma_f32_16x16x32_bf16 v[192:195], a[176:179], v[44:47], v[192:195]
  ds_read_b64_tr_b16 v[34:35], v14 offset:624
  v_subrev_u32 v9, 18, v53
  v_mfma_f32_16x16x32_bf16 v[196:199], a[164:167], v[40:43], v[196:199]
  ds_read_b64_tr_b16 v[36:37], v14 offset:4656
  v_min_u32 v53, v53, v9
  v_mfma_f32_16x16x32_bf16 v[196:199], a[180:183], v[44:47], v[196:199]
  ds_read_b64_tr_b16 v[38:39], v14 offset:5232
  v_mul_u32_u24 v61, 1152, v61
  v_mfma_f32_16x16x32_bf16 v[200:203], a[168:171], v[40:43], v[200:203]
  s_mov_b32 s80, 0xffff
  v_lshl_add_u32 v53, v53, 4, v61
  v_add_u32 v9, s84, v53
  v_mfma_f32_16x16x32_bf16 v[200:203], a[184:187], v[44:47], v[200:203]
  s_mul_i32 s84, s51, 1296
  s_add_u32 s19, s19, s84
  s_lshr_b32 s84, s83, 6
  v_mfma_f32_16x16x32_bf16 v[204:207], a[172:175], v[40:43], v[204:207]
  s_mul_i32 s84, s84, 5184
  s_add_u32 s84, s84, s16
  s_add_u32 s18, s18, s84
  v_mfma_f32_16x16x32_bf16 v[204:207], a[188:191], v[44:47], v[204:207]
  s_waitcnt lgkmcnt(4)
  s_bfe_u32 s16, s83, 0x20004
  s_mul_i32 s16, s16, 1152
  v_mfma_f32_16x16x32_bf16 v[64:67], v[24:27], a[192:195], v[64:67]
  buffer_store_dwordx4 v[148:151], v11, s[40:43], s59 offen sc1
  v_mfma_f32_16x16x32_bf16 v[64:67], v[28:31], a[208:211], v[64:67]
  s_add_u32 s84, s84, s16
  ds_read_b64_tr_b16 v[40:41], v14 offset:96
  v_mov_b32 v60, 0x7f000000
  v_mfma_f32_16x16x32_bf16 v[68:71], v[24:27], a[196:199], v[68:71]
  s_and_b32 s83, s83, 15
  ds_read_b64_tr_b16 v[42:43], v14 offset:672
  v_cndmask_b32 v60, v60, 0, vcc
  v_mfma_f32_16x16x32_bf16 v[68:71], v[28:31], a[212:215], v[68:71]
  s_mul_i32 s17, s83, 18
  ds_read_b64_tr_b16 v[44:45], v14 offset:4704
  v_mfma_f32_16x16x32_bf16 v[72:75], v[24:27], a[200:203], v[72:75]
  s_add_u32 s17, s17, s84
  ds_read_b64_tr_b16 v[46:47], v14 offset:5280
  v_mfma_f32_16x16x32_bf16 v[72:75], v[28:31], a[216:219], v[72:75]
  s_add_u32 s17, s17, 576
  ds_read_b128 v[128:131], v10 offset:768
  v_mfma_f32_16x16x32_bf16 v[76:79], v[24:27], a[204:207], v[76:79]
  s_lshl_b32 s17, s17, 7
  ds_read_b128 v[132:135], v10 offset:832
  v_mfma_f32_16x16x32_bf16 v[76:79], v[28:31], a[220:223], v[76:79]
  s_waitcnt lgkmcnt(6)
  s_add_u32 s20, s17, 36864
  s_add_u32 s18, s18, 4608
  v_mfma_f32_16x16x32_bf16 v[112:115], a[192:195], v[32:35], v[112:115]
  s_lshl_b32 s18, s18, 7
  ds_read_b64_tr_b16 v[24:25], v15 offset:0
  v_mfma_f32_16x16x32_bf16 v[112:115], a[208:211], v[36:39], v[112:115]
  s_add_u32 s19, s19, 144
  ds_read_b64_tr_b16 v[26:27], v15 offset:576
  v_mfma_f32_16x16x32_bf16 v[116:119], a[196:199], v[32:35], v[116:119]
  s_lshl_b32 s19, s19, 7
  ds_read_b64_tr_b16 v[28:29], v15 offset:4608
  v_mfma_f32_16x16x32_bf16 v[116:119], a[212:215], v[36:39], v[116:119]
  s_mul_i32 s16, s83, 36
  ds_read_b64_tr_b16 v[30:31], v15 offset:5184
  v_mfma_f32_16x16x32_bf16 v[120:123], a[200:203], v[32:35], v[120:123]
  s_add_u32 s16, s16, s84
  s_mul_i32 s83, s51, 1327104
  s_lshr_b32 s84, s48, 1
  v_mfma_f32_16x16x32_bf16 v[120:123], a[216:219], v[36:39], v[120:123]
  buffer_load_dwordx4 v63, s[44:47], s58 offen lds
  v_mfma_f32_16x16x32_bf16 v[124:127], a[204:207], v[32:35], v[124:127]
  s_add_u32 m0, s61, 114688
  s_mul_i32 s58, s97, 589824
  s_mul_i32 s84, s84, 147456
  v_mfma_f32_16x16x32_bf16 v[124:127], a[220:223], v[36:39], v[124:127]
  s_waitcnt lgkmcnt(6)
  s_waitcnt lgkmcnt(4)
  s_add_u32 s72, s83, s84
  v_mfma_f32_16x16x32_bf16 v[96:99], a[192:195], v[40:43], v[96:99]
  s_waitcnt lgkmcnt(0)
  v_cndmask_b32_e64 v24, v24, v128, s[78:79]
  v_cndmask_b32_e64 v25, v25, v129, s[78:79]
  v_mfma_f32_16x16x32_bf16 v[96:99], a[208:211], v[44:47], v[96:99]
  s_and_b32 s84, s48, 1
  ds_read_b64_tr_b16 v[32:33], v14 offset:9216
  v_cndmask_b32_e64 v26, v26, v130, s[78:79]
  v_mfma_f32_16x16x32_bf16 v[100:103], a[196:199], v[40:43], v[100:103]
  s_mul_i32 s84, s84, 36864
  ds_read_b64_tr_b16 v[34:35], v14 offset:9792
  v_cndmask_b32_e64 v27, v27, v131, s[78:79]
  v_mfma_f32_16x16x32_bf16 v[100:103], a[212:215], v[44:47], v[100:103]
  s_add_u32 s72, s72, s84
  ds_read_b64_tr_b16 v[36:37], v14 offset:13824
  v_cndmask_b32_e64 v28, v28, v132, s[78:79]
  v_mfma_f32_16x16x32_bf16 v[104:107], a[200:203], v[40:43], v[104:107]
  s_mul_i32 s84, s48, 147456
  ds_read_b64_tr_b16 v[38:39], v14 offset:14400
  v_cndmask_b32_e64 v29, v29, v133, s[78:79]
  v_mfma_f32_16x16x32_bf16 v[104:107], a[216:219], v[44:47], v[104:107]
  s_add_u32 s73, s83, s84
  v_cndmask_b32_e64 v30, v30, v134, s[78:79]
  v_cndmask_b32_e64 v31, v31, v135, s[78:79]
  v_mfma_f32_16x16x32_bf16 v[108:111], a[204:207], v[40:43], v[108:111]
  buffer_load_dwordx4 v17, s[44:47], s58 offen lds
  v_mfma_f32_16x16x32_bf16 v[108:111], a[220:223], v[44:47], v[108:111]
  s_add_u32 m0, s61, 118784
  v_sub_u32 v52, 17, v0
  v_and_b32 v52, 0x7f000000, v52
  v_mfma_f32_16x16x32_bf16 v[192:195], a[192:195], v[24:27], v[192:195]
  s_add_u32 s59, s77, 82944
  ds_read_b64_tr_b16 v[40:41], v14 offset:9264
  v_lshl_or_b32 v52, v0, 7, v52
  v_mfma_f32_16x16x32_bf16 v[192:195], a[208:211], v[28:31], v[192:195]
  s_mul_i32 s84, s48, 18432
  ds_read_b64_tr_b16 v[42:43], v14 offset:9840
  v_mfma_f32_16x16x32_bf16 v[196:199], a[196:199], v[24:27], v[196:199]
  s_add_u32 s74, s83, s84
  ds_read_b64_tr_b16 v[44:45], v14 offset:13872
  v_mfma_f32_16x16x32_bf16 v[196:199], a[212:215], v[28:31], v[196:199]
  buffer_load_dword v48, v52, s[24:27], s20 offen
  v_mfma_f32_16x16x32_bf16 v[200:203], a[200:203], v[24:27], v[200:203]
  s_lshl_b32 s83, s51, 3
  ds_read_b64_tr_b16 v[46:47], v14 offset:14448
  v_mfma_f32_16x16x32_bf16 v[200:203], a[216:219], v[28:31], v[200:203]
  s_add_u32 s84, s83, s48
  s_xor_b32 s75, s84, 0
  s_add_u32 s84, s84, s48
  v_mfma_f32_16x16x32_bf16 v[204:207], a[204:207], v[24:27], v[204:207]
  s_mul_i32 s82, s84, 20736
  s_add_u32 s84, s53, s52
  s_add_u32 s83, s84, 0
  v_mfma_f32_16x16x32_bf16 v[204:207], a[220:223], v[28:31], v[204:207]
  s_waitcnt lgkmcnt(4)
  s_and_b32 s83, s83, 3
  s_lshl_b32 s69, s83, 12
  v_mfma_f32_16x16x32_bf16 v[64:67], v[32:35], a[224:227], v[64:67]
  s_lshr_b32 s65, s83, 1
  ds_read_b64_tr_b16 v[24:25], v14 offset:9312
  v_mfma_f32_16x16x32_bf16 v[64:67], v[36:39], a[240:243], v[64:67]
  s_mul_i32 s65, s65, 663552
  ds_read_b64_tr_b16 v[26:27], v14 offset:9888
  v_mfma_f32_16x16x32_bf16 v[68:71], v[32:35], a[228:231], v[68:71]
  s_and_b32 s83, s83, 1
  ds_read_b64_tr_b16 v[28:29], v14 offset:13920
  v_mfma_f32_16x16x32_bf16 v[68:71], v[36:39], a[244:247], v[68:71]
  s_mul_i32 s83, s83, 294912
  ds_read_b64_tr_b16 v[30:31], v14 offset:14496
  v_mfma_f32_16x16x32_bf16 v[72:75], v[32:35], a[232:235], v[72:75]
  s_add_u32 s65, s65, s83
  ds_read_b128 v[136:139], v10 offset:896
  v_mfma_f32_16x16x32_bf16 v[72:75], v[36:39], a[248:251], v[72:75]
  s_add_u32 s65, s65, s72
  ds_read_b128 v[140:143], v10 offset:960
  v_mfma_f32_16x16x32_bf16 v[76:79], v[32:35], a[236:239], v[76:79]
  s_add_u32 s83, s84, 1
  s_and_b32 s83, s83, 3
  s_lshl_b32 s70, s83, 12
  v_mfma_f32_16x16x32_bf16 v[76:79], v[36:39], a[252:255], v[76:79]
  s_waitcnt lgkmcnt(6)
  s_lshr_b32 s66, s83, 1
  s_mul_i32 s66, s66, 663552
  v_mfma_f32_16x16x32_bf16 v[112:115], a[224:227], v[40:43], v[112:115]
  s_and_b32 s83, s83, 1
  ds_read_b64_tr_b16 v[32:33], v15 offset:9216
  v_mfma_f32_16x16x32_bf16 v[112:115], a[240:243], v[44:47], v[112:115]
  s_mul_i32 s83, s83, 294912
  ds_read_b64_tr_b16 v[34:35], v15 offset:9792
  v_mfma_f32_16x16x32_bf16 v[116:119], a[228:231], v[40:43], v[116:119]
  s_add_u32 s66, s66, s83
  ds_read_b64_tr_b16 v[36:37], v15 offset:13824
  v_mfma_f32_16x16x32_bf16 v[116:119], a[244:247], v[44:47], v[116:119]
  s_add_u32 s66, s66, s72
  ds_read_b64_tr_b16 v[38:39], v15 offset:14400
  v_mfma_f32_16x16x32_bf16 v[120:123], a[232:235], v[40:43], v[120:123]
  s_add_u32 s83, s84, 2
  s_and_b32 s83, s83, 3
  s_lshl_b32 s76, s83, 12
  v_mfma_f32_16x16x32_bf16 v[120:123], a[248:251], v[44:47], v[120:123]
  buffer_store_dwordx4 v[152:155], v11, s[40:43], s59 offen sc1
  v_mfma_f32_16x16x32_bf16 v[124:127], a[236:239], v[40:43], v[124:127]
  s_lshr_b32 s67, s83, 1
  s_mul_i32 s67, s67, 663552
  s_and_b32 s83, s83, 1
  v_mfma_f32_16x16x32_bf16 v[124:127], a[252:255], v[44:47], v[124:127]
  s_waitcnt lgkmcnt(6)
  s_waitcnt lgkmcnt(4)
  s_mul_i32 s83, s83, 294912
  v_mfma_f32_16x16x32_bf16 v[96:99], a[224:227], v[24:27], v[96:99]
  s_waitcnt lgkmcnt(0)
  v_cndmask_b32_e64 v32, v32, v136, s[78:79]
  v_cndmask_b32_e64 v33, v33, v137, s[78:79]
  v_mfma_f32_16x16x32_bf16 v[96:99], a[240:243], v[28:31], v[96:99]
  s_add_u32 s67, s67, s83
  ds_read_b64_tr_b16 v[40:41], v14 offset:18480
  v_cndmask_b32_e64 v34, v34, v138, s[78:79]
  v_mfma_f32_16x16x32_bf16 v[100:103], a[228:231], v[24:27], v[100:103]
  s_add_u32 s67, s67, s72
  ds_read_b64_tr_b16 v[42:43], v14 offset:19056
  v_cndmask_b32_e64 v35, v35, v139, s[78:79]
  v_mfma_f32_16x16x32_bf16 v[100:103], a[244:247], v[28:31], v[100:103]
  s_add_u32 s83, s84, 3
  ds_read_b64_tr_b16 v[44:45], v14 offset:23088
  v_cndmask_b32_e64 v36, v36, v140, s[78:79]
  v_mfma_f32_16x16x32_bf16 v[104:107], a[232:235], v[24:27], v[104:107]
  s_and_b32 s83, s83, 3
  ds_read_b64_tr_b16 v[46:47], v14 offset:23664
  v_cndmask_b32_e64 v37, v37, v141, s[78:79]
  v_mfma_f32_16x16x32_bf16 v[104:107], a[248:251], v[28:31], v[104:107]
  s_lshl_b32 s4, s83, 12
  v_cndmask_b32_e64 v38, v38, v142, s[78:79]
  v_cndmask_b32_e64 v39, v39, v143, s[78:79]
  v_mfma_f32_16x16x32_bf16 v[108:111], a[236:239], v[24:27], v[108:111]
  s_lshr_b32 s68, s83, 1
  s_mul_i32 s68, s68, 663552
  s_and_b32 s83, s83, 1
  v_mfma_f32_16x16x32_bf16 v[108:111], a[252:255], v[28:31], v[108:111]
  s_mul_i32 s83, s83, 294912
  s_add_u32 s68, s68, s83
  s_add_u32 s68, s68, s72
  v_mfma_f32_16x16x32_bf16 v[192:195], a[224:227], v[32:35], v[192:195]
  s_add_u32 s83, s84, 0
  ds_read_b64_tr_b16 v[24:25], v14 offset:18528
  v_mfma_f32_16x16x32_bf16 v[192:195], a[240:243], v[36:39], v[192:195]
  s_and_b32 s83, s83, 1
  ds_read_b64_tr_b16 v[26:27], v14 offset:19104
  v_mfma_f32_16x16x32_bf16 v[196:199], a[228:231], v[32:35], v[196:199]
  s_lshl_b32 s11, s83, 12
  ds_read_b64_tr_b16 v[28:29], v14 offset:23136
  v_mfma_f32_16x16x32_bf16 v[196:199], a[244:247], v[36:39], v[196:199]
  buffer_load_dwordx4 v63, s[44:47], s58 offen lds
  v_mfma_f32_16x16x32_bf16 v[200:203], a[232:235], v[32:35], v[200:203]
  s_add_u32 m0, s61, 73728
  s_mul_i32 s58, s88, 589824
  v_sub_u32 v52, 8, v0
  v_mfma_f32_16x16x32_bf16 v[200:203], a[248:251], v[36:39], v[200:203]
  s_mul_i32 s9, s83, 82944
  ds_read_b64_tr_b16 v[30:31], v14 offset:23712
  v_and_b32 v52, 0x7f000000, v52
  v_mfma_f32_16x16x32_bf16 v[204:207], a[236:239], v[32:35], v[204:207]
  s_mul_i32 s83, s83, 663552
  ds_read_b128 v[128:131], v10 offset:1024
  v_lshl_or_b32 v52, v0, 7, v52
  v_mfma_f32_16x16x32_bf16 v[204:207], a[252:255], v[36:39], v[204:207]
  s_waitcnt lgkmcnt(5)
  ds_read_b128 v[132:135], v10 offset:1088
  v_mfma_f32_16x16x32_bf16 v[112:115], v[224:227], v[40:43], v[112:115]
  s_add_u32 s5, s83, s73
  ds_read_b64_tr_b16 v[32:33], v15 offset:18432
  v_mfma_f32_16x16x32_bf16 v[112:115], v[240:243], v[44:47], v[112:115]
  s_add_u32 s7, s83, s74
  ds_read_b64_tr_b16 v[34:35], v15 offset:19008
  v_mfma_f32_16x16x32_bf16 v[116:119], v[228:231], v[40:43], v[116:119]
  ds_read_b64_tr_b16 v[36:37], v15 offset:23040
  buffer_load_dword v48, v52, s[24:27], s18 offen
  v_mfma_f32_16x16x32_bf16 v[116:119], v[244:247], v[44:47], v[116:119]
  s_add_u32 s83, s84, 1
  ds_read_b64_tr_b16 v[38:39], v15 offset:23616
  v_mfma_f32_16x16x32_bf16 v[120:123], v[232:235], v[40:43], v[120:123]
  s_and_b32 s83, s83, 1
  s_lshl_b32 s72, s83, 12
  s_mul_i32 s10, s83, 82944
  v_mfma_f32_16x16x32_bf16 v[120:123], v[248:251], v[44:47], v[120:123]
  s_add_u32 s59, s77, 123904
  s_mul_i32 s83, s83, 663552
  s_add_u32 s6, s83, s73
  v_mfma_f32_16x16x32_bf16 v[124:127], v[236:239], v[40:43], v[124:127]
  s_add_u32 s8, s83, s74
  v_sub_u32 v52, 10, v0
  v_and_b32 v52, 0x7f000000, v52
  v_mfma_f32_16x16x32_bf16 v[124:127], v[252:255], v[44:47], v[124:127]
  s_waitcnt lgkmcnt(6)
  s_waitcnt lgkmcnt(4)
  v_lshl_or_b32 v52, v0, 7, v52
  v_mfma_f32_16x16x32_bf16 v[96:99], v[224:227], v[24:27], v[96:99]
  s_waitcnt lgkmcnt(0)
  v_cndmask_b32_e64 v32, v32, v128, s[78:79]
  v_cndmask_b32_e64 v33, v33, v129, s[78:79]
  v_mfma_f32_16x16x32_bf16 v[96:99], v[240:243], v[28:31], v[96:99]
  s_lshl_b32 s83, s48, 12
  ds_read_b64_tr_b16 v[40:41], v14 offset:18432
  v_cndmask_b32_e64 v34, v34, v130, s[78:79]
  v_mfma_f32_16x16x32_bf16 v[100:103], v[228:231], v[24:27], v[100:103]
  s_add_u32 s83, s83, 147456
  ds_read_b64_tr_b16 v[42:43], v14 offset:19008
  v_cndmask_b32_e64 v35, v35, v131, s[78:79]
  v_mfma_f32_16x16x32_bf16 v[100:103], v[244:247], v[28:31], v[100:103]
  buffer_store_dwordx4 v[156:159], v11, s[40:43], s59 offen sc1
  v_mfma_f32_16x16x32_bf16 v[104:107], v[232:235], v[24:27], v[104:107]
  buffer_load_dword v48, v52, s[12:15], s19 offen
  v_mfma_f32_16x16x32_bf16 v[104:107], v[248:251], v[28:31], v[104:107]
  s_mov_b32 s81, 0
  ds_read_b64_tr_b16 v[44:45], v14 offset:23040
  v_cndmask_b32_e64 v36, v36, v132, s[78:79]
  v_mfma_f32_16x16x32_bf16 v[108:111], v[236:239], v[24:27], v[108:111]
  s_mul_i32 s75, s75, 20736
  ds_read_b64_tr_b16 v[46:47], v14 offset:23616
  v_cndmask_b32_e64 v37, v37, v133, s[78:79]
  v_mfma_f32_16x16x32_bf16 v[108:111], v[252:255], v[28:31], v[108:111]
  v_cndmask_b32_e64 v38, v38, v134, s[78:79]
  v_cndmask_b32_e64 v39, v39, v135, s[78:79]
  s_waitcnt lgkmcnt(0) vmcnt(13)
  s_barrier
  v_mfma_f32_16x16x32_bf16 v[192:195], v[224:227], v[32:35], v[192:195]
  s_add_u32 s9, s9, s75
  ds_read_b64_tr_b16 v[24:25], v18 offset:0
  v_mul_f32 v12, 0x3fb8aa3b, v112
  v_mfma_f32_16x16x32_bf16 v[192:195], v[240:243], v[36:39], v[192:195]
  s_add_u32 s10, s10, s75
  ds_read_b64_tr_b16 v[26:27], v18 offset:1024
  v_mul_f32 v56, 0x3fb8aa3b, v113
  v_mfma_f32_16x16x32_bf16 v[196:199], v[228:231], v[32:35], v[196:199]
  s_lshl_b32 s16, s16, 7
  ds_read_b64_tr_b16 v[28:29], v18 offset:4096
  v_max_f32 v112, 0x358637bd, v112
  v_mfma_f32_16x16x32_bf16 v[196:199], v[244:247], v[36:39], v[196:199]
  ds_read_b64_tr_b16 v[30:31], v18 offset:5120
  v_max_f32 v113, 0x358637bd, v113
  v_mfma_f32_16x16x32_bf16 v[200:203], v[232:235], v[32:35], v[200:203]
  v_exp_f32_e64 v12, v12 clamp
  v_mfma_f32_16x16x32_bf16 v[200:203], v[248:251], v[36:39], v[200:203]
  v_exp_f32_e64 v56, v56 clamp
  v_mfma_f32_16x16x32_bf16 v[204:207], v[236:239], v[32:35], v[204:207]
  buffer_load_dwordx4 v17, s[44:47], s58 offen lds
  v_mfma_f32_16x16x32_bf16 v[204:207], v[252:255], v[36:39], v[204:207]
  s_waitcnt lgkmcnt(4)
  s_add_u32 m0, s61, 77824
  v_add_f32 v112, v12, v112
  v_mfma_f32_16x16x32_bf16 v[64:67], v[40:43], v[224:227], v[64:67]
  ds_read_b64_tr_b16 v[32:33], v18 offset:2048
  v_sub_u32 v52, 17, v0
  v_mfma_f32_16x16x32_bf16 v[64:67], v[44:47], v[240:243], v[64:67]
  ds_read_b64_tr_b16 v[34:35], v18 offset:3072
  v_and_b32 v52, 0x7f000000, v52
  v_mfma_f32_16x16x32_bf16 v[68:71], v[40:43], v[228:231], v[68:71]
  ds_read_b64_tr_b16 v[36:37], v18 offset:6144
  v_lshl_or_b32 v52, v0, 7, v52
  v_mfma_f32_16x16x32_bf16 v[68:71], v[44:47], v[244:247], v[68:71]
  ds_read_b64_tr_b16 v[38:39], v18 offset:7168
  v_add_f32 v113, v56, v113
  v_mfma_f32_16x16x32_bf16 v[72:75], v[40:43], v[232:235], v[72:75]
  v_mul_f32 v12, 0x3fb8aa3b, v114
  v_mul_f32 v56, 0x3fb8aa3b, v115
  v_mfma_f32_16x16x32_bf16 v[72:75], v[44:47], v[248:251], v[72:75]
  v_exp_f32_e64 v12, v12 clamp
  v_mfma_f32_16x16x32_bf16 v[76:79], v[40:43], v[236:239], v[76:79]
  buffer_load_dword v48, v52, s[24:27], s17 offen
  v_mfma_f32_16x16x32_bf16 v[76:79], v[44:47], v[252:255], v[76:79]
  s_waitcnt lgkmcnt(4)
  v_exp_f32_e64 v56, v56 clamp
  v_mfma_f32_16x16x32_bf16 v[80:83], v[24:27], a[0:3], 0
  ds_read_b64_tr_b16 v[40:41], v19 offset:0
  v_max_f32 v114, 0x358637bd, v114
  v_mfma_f32_16x16x32_bf16 v[80:83], v[28:31], a[16:19], v[80:83]
  ds_read_b64_tr_b16 v[42:43], v19 offset:1024
  v_max_f32 v115, 0x358637bd, v115
  v_mfma_f32_16x16x32_bf16 v[84:87], v[24:27], a[4:7], 0
  ds_read_b64_tr_b16 v[44:45], v19 offset:4096
  v_add_f32 v114, v12, v114
  v_mfma_f32_16x16x32_bf16 v[84:87], v[28:31], a[20:23], v[84:87]
  ds_read_b64_tr_b16 v[46:47], v19 offset:5120
  v_add_f32 v115, v56, v115
  v_mfma_f32_16x16x32_bf16 v[88:91], v[24:27], a[8:11], 0
  v_mul_f32 v12, 0x3fb8aa3b, v116
  v_mul_f32 v56, 0x3fb8aa3b, v117
  v_mfma_f32_16x16x32_bf16 v[88:91], v[28:31], a[24:27], v[88:91]
  v_exp_f32_e64 v12, v12 clamp
  v_mfma_f32_16x16x32_bf16 v[92:95], v[24:27], a[12:15], 0
  v_exp_f32_e64 v56, v56 clamp
  v_mfma_f32_16x16x32_bf16 v[92:95], v[28:31], a[28:31], v[92:95]
  s_waitcnt lgkmcnt(4)
  v_max_f32 v116, 0x358637bd, v116
  v_max_f32 v117, 0x358637bd, v117
  v_mfma_f32_16x16x32_bf16 v[128:131], v[32:35], a[0:3], 0
  ds_read_b64_tr_b16 v[24:25], v19 offset:2048
  v_add_f32 v116, v12, v116
  v_mfma_f32_16x16x32_bf16 v[128:131], v[36:39], a[16:19], v[128:131]
  ds_read_b64_tr_b16 v[26:27], v19 offset:3072
  v_add_f32 v117, v56, v117
  v_mfma_f32_16x16x32_bf16 v[132:135], v[32:35], a[4:7], 0
  ds_read_b64_tr_b16 v[28:29], v19 offset:6144
  v_mul_f32 v12, 0x3fb8aa3b, v118
  v_mfma_f32_16x16x32_bf16 v[132:135], v[36:39], a[20:23], v[132:135]
  ds_read_b64_tr_b16 v[30:31], v19 offset:7168
  v_mul_f32 v56, 0x3fb8aa3b, v119
  v_mfma_f32_16x16x32_bf16 v[136:139], v[32:35], a[8:11], 0
  v_exp_f32_e64 v12, v12 clamp
  v_mfma_f32_16x16x32_bf16 v[136:139], v[36:39], a[24:27], v[136:139]
  v_exp_f32_e64 v56, v56 clamp
  v_mfma_f32_16x16x32_bf16 v[140:143], v[32:35], a[12:15], 0
  v_max_f32 v118, 0x358637bd, v118
  v_max_f32 v119, 0x358637bd, v119
  v_mfma_f32_16x16x32_bf16 v[140:143], v[36:39], a[28:31], v[140:143]
  s_waitcnt lgkmcnt(4)
  v_add_f32 v118, v12, v118
  v_mfma_f32_16x16x32_bf16 v[160:163], v[40:43], a[0:3], 0
  buffer_load_dwordx4 v63, s[44:47], s58 offen lds
  v_mfma_f32_16x16x32_bf16 v[160:163], v[44:47], a[16:19], v[160:163]
  s_add_u32 m0, s61, 81920
  s_mul_i32 s58, s89, 589824
  v_add_f32 v119, v56, v119
  v_mfma_f32_16x16x32_bf16 v[164:167], v[40:43], a[4:7], 0
  ds_read_b64_tr_b16 v[32:33], v18 offset:8192
  v_mul_f32 v12, 0x3fb8aa3b, v120
  v_mfma_f32_16x16x32_bf16 v[164:167], v[44:47], a[20:23], v[164:167]
  ds_read_b64_tr_b16 v[34:35], v18 offset:9216
  v_mul_f32 v56, 0x3fb8aa3b, v121
  v_mfma_f32_16x16x32_bf16 v[168:171], v[40:43], a[8:11], 0
  ds_read_b64_tr_b16 v[36:37], v18 offset:12288
  v_max_f32 v120, 0x358637bd, v120
  v_mfma_f32_16x16x32_bf16 v[168:171], v[44:47], a[24:27], v[168:171]
  ds_read_b64_tr_b16 v[38:39], v18 offset:13312
  v_max_f32 v121, 0x358637bd, v121
  v_mfma_f32_16x16x32_bf16 v[172:175], v[40:43], a[12:15], 0
  v_exp_f32_e64 v12, v12 clamp
  v_mfma_f32_16x16x32_bf16 v[172:175], v[44:47], a[28:31], v[172:175]
  s_waitcnt lgkmcnt(4)
  v_exp_f32_e64 v56, v56 clamp
  v_mfma_f32_16x16x32_bf16 v[176:179], v[24:27], a[0:3], 0
  ds_read_b64_tr_b16 v[40:41], v18 offset:10240
  v_add_f32 v120, v12, v120
  v_mfma_f32_16x16x32_bf16 v[176:179], v[28:31], a[16:19], v[176:179]
  buffer_load_dwordx4 v17, s[44:47], s58 offen lds
  v_mfma_f32_16x16x32_bf16 v[180:183], v[24:27], a[4:7], 0
  s_add_u32 m0, s61, 86016
  ds_read_b64_tr_b16 v[42:43], v18 offset:11264
  v_add_f32 v121, v56, v121
  v_mfma_f32_16x16x32_bf16 v[180:183], v[28:31], a[20:23], v[180:183]
  ds_read_b64_tr_b16 v[44:45], v18 offset:14336
  v_mul_f32 v12, 0x3fb8aa3b, v122
  v_mfma_f32_16x16x32_bf16 v[184:187], v[24:27], a[8:11], 0
  ds_read_b64_tr_b16 v[46:47], v18 offset:15360
  v_mul_f32 v56, 0x3fb8aa3b, v123
  v_mfma_f32_16x16x32_bf16 v[184:187], v[28:31], a[24:27], v[184:187]
  v_exp_f32_e64 v12, v12 clamp
  v_mfma_f32_16x16x32_bf16 v[188:191], v[24:27], a[12:15], 0
  v_exp_f32_e64 v56, v56 clamp
  v_mfma_f32_16x16x32_bf16 v[188:191], v[28:31], a[28:31], v[188:191]
  s_waitcnt lgkmcnt(4)
  v_max_f32 v122, 0x358637bd, v122
  v_max_f32 v123, 0x358637bd, v123
  v_mfma_f32_16x16x32_bf16 v[80:83], v[32:35], a[32:35], v[80:83]
  ds_read_b64_tr_b16 v[24:25], v19 offset:8192
  v_add_f32 v122, v12, v122
  v_mfma_f32_16x16x32_bf16 v[80:83], v[36:39], a[48:51], v[80:83]
  buffer_load_dwordx4 v63, s[44:47], s58 offen lds
  v_mfma_f32_16x16x32_bf16 v[84:87], v[32:35], a[36:39], v[84:87]
  s_add_u32 m0, s61, 90112
  s_mul_i32 s58, s1, 589824
  v_add_f32 v123, v56, v123
  v_mfma_f32_16x16x32_bf16 v[84:87], v[36:39], a[52:55], v[84:87]
  ds_read_b64_tr_b16 v[26:27], v19 offset:9216
  v_mul_f32 v12, 0x3fb8aa3b, v124
  v_mfma_f32_16x16x32_bf16 v[88:91], v[32:35], a[40:43], v[88:91]
  ds_read_b64_tr_b16 v[28:29], v19 offset:12288
  v_mul_f32 v56, 0x3fb8aa3b, v125
  v_mfma_f32_16x16x32_bf16 v[88:91], v[36:39], a[56:59], v[88:91]
  ds_read_b64_tr_b16 v[30:31], v19 offset:13312
  v_max_f32 v124, 0x358637bd, v124
  v_mfma_f32_16x16x32_bf16 v[92:95], v[32:35], a[44:47], v[92:95]
  v_exp_f32_e64 v12, v12 clamp
  v_mfma_f32_16x16x32_bf16 v[92:95], v[36:39], a[60:63], v[92:95]
  s_waitcnt lgkmcnt(4)
  v_exp_f32_e64 v56, v56 clamp
  v_mfma_f32_16x16x32_bf16 v[128:131], v[40:43], a[32:35], v[128:131]
  ds_read_b64_tr_b16 v[32:33], v19 offset:10240
  v_max_f32 v125, 0x358637bd, v125
  v_mfma_f32_16x16x32_bf16 v[128:131], v[44:47], a[48:51], v[128:131]
  ds_read_b64_tr_b16 v[34:35], v19 offset:11264
  v_add_f32 v124, v12, v124
  v_mfma_f32_16x16x32_bf16 v[132:135], v[40:43], a[36:39], v[132:135]
  buffer_load_dwordx4 v17, s[44:47], s58 offen lds
  v_mfma_f32_16x16x32_bf16 v[132:135], v[44:47], a[52:55], v[132:135]
  s_add_u32 m0, s61, 94208
  ds_read_b64_tr_b16 v[36:37], v19 offset:14336
  v_add_f32 v125, v56, v125
  v_mfma_f32_16x16x32_bf16 v[136:139], v[40:43], a[40:43], v[136:139]
  ds_read_b64_tr_b16 v[38:39], v19 offset:15360
  v_mul_f32 v12, 0x3fb8aa3b, v126
  v_mfma_f32_16x16x32_bf16 v[136:139], v[44:47], a[56:59], v[136:139]
  v_mul_f32 v56, 0x3fb8aa3b, v127
  v_max_f32 v126, 0x358637bd, v126
  v_mfma_f32_16x16x32_bf16 v[140:143], v[40:43], a[44:47], v[140:143]
  v_exp_f32_e64 v12, v12 clamp
  v_mfma_f32_16x16x32_bf16 v[140:143], v[44:47], a[60:63], v[140:143]
  s_waitcnt lgkmcnt(4)
  v_exp_f32_e64 v56, v56 clamp
  v_mfma_f32_16x16x32_bf16 v[160:163], v[24:27], a[32:35], v[160:163]
  ds_read_b64_tr_b16 v[40:41], v18 offset:16384
  v_max_f32 v127, 0x358637bd, v127
  v_mfma_f32_16x16x32_bf16 v[160:163], v[28:31], a[48:51], v[160:163]
  ds_read_b64_tr_b16 v[42:43], v18 offset:17408
  v_add_f32 v126, v12, v126
  v_mfma_f32_16x16x32_bf16 v[164:167], v[24:27], a[36:39], v[164:167]
  ds_read_b64_tr_b16 v[44:45], v18 offset:20480
  v_add_f32 v127, v56, v127
  v_mfma_f32_16x16x32_bf16 v[164:167], v[28:31], a[52:55], v[164:167]
  buffer_load_dwordx4 v63, s[44:47], s58 offen lds
  v_mfma_f32_16x16x32_bf16 v[168:171], v[24:27], a[40:43], v[168:171]
  ds_read_b64_tr_b16 v[46:47], v18 offset:21504
  v_lshl_add_u32 v14, v0, 4, s83
  v_mfma_f32_16x16x32_bf16 v[168:171], v[28:31], a[56:59], v[168:171]
  v_and_b32 v15, 3, v0
  v_cmp_eq_u32 s[78:79], 3, v15
  v_mfma_f32_16x16x32_bf16 v[172:175], v[24:27], a[44:47], v[172:175]
  v_mov_b32 v56, 0x3f803f80
  v_mfma_f32_16x16x32_bf16 v[172:175], v[28:31], a[60:63], v[172:175]
  s_waitcnt lgkmcnt(4)
  v_cvt_pk_bf16_f32 v112, v112, v113
  v_cvt_pk_bf16_f32 v113, v114, v115
  v_mfma_f32_16x16x32_bf16 v[176:179], v[32:35], a[32:35], v[176:179]
  ds_read_b64_tr_b16 v[24:25], v18 offset:18432
  v_cvt_pk_bf16_f32 v114, v116, v117
  v_mfma_f32_16x16x32_bf16 v[176:179], v[36:39], a[48:51], v[176:179]
  ds_read_b64_tr_b16 v[26:27], v18 offset:19456
  v_cvt_pk_bf16_f32 v115, v118, v119
  v_mfma_f32_16x16x32_bf16 v[180:183], v[32:35], a[36:39], v[180:183]
  ds_read_b64_tr_b16 v[28:29], v18 offset:22528
  v_cvt_pk_bf16_f32 v116, v120, v121
  v_mfma_f32_16x16x32_bf16 v[180:183], v[36:39], a[52:55], v[180:183]
  ds_read_b64_tr_b16 v[30:31], v18 offset:23552
  v_subrev_u32 v18, 24576, v18
  v_mfma_f32_16x16x32_bf16 v[184:187], v[32:35], a[40:43], v[184:187]
  v_cvt_pk_bf16_f32 v117, v122, v123
  v_cvt_pk_bf16_f32 v118, v124, v125
  v_mfma_f32_16x16x32_bf16 v[184:187], v[36:39], a[56:59], v[184:187]
  v_cvt_pk_bf16_f32 v119, v126, v127
  v_mfma_f32_16x16x32_bf16 v[188:191], v[32:35], a[44:47], v[188:191]
  v_cvt_pk_bf16_f32 v96, v96, v97
  v_cvt_pk_bf16_f32 v97, v98, v99
  v_mfma_f32_16x16x32_bf16 v[188:191], v[36:39], a[60:63], v[188:191]
  s_waitcnt lgkmcnt(4)
  v_cvt_pk_bf16_f32 v98, v100, v101
  v_mfma_f32_16x16x32_bf16 v[80:83], v[40:43], a[64:67], v[80:83]
  ds_read_b64_tr_b16 v[32:33], v19 offset:16384
  v_cvt_pk_bf16_f32 v99, v102, v103
  v_mfma_f32_16x16x32_bf16 v[80:83], v[44:47], a[80:83], v[80:83]
  ds_read_b64_tr_b16 v[34:35], v19 offset:17408
  v_cvt_pk_bf16_f32 v100, v104, v105
  v_mfma_f32_16x16x32_bf16 v[84:87], v[40:43], a[68:71], v[84:87]
  ds_read_b64_tr_b16 v[36:37], v19 offset:20480
  v_cvt_pk_bf16_f32 v101, v106, v107
  v_mfma_f32_16x16x32_bf16 v[84:87], v[44:47], a[84:87], v[84:87]
  ds_read_b64_tr_b16 v[38:39], v19 offset:21504
  v_cvt_pk_bf16_f32 v102, v108, v109
  v_mfma_f32_16x16x32_bf16 v[88:91], v[40:43], a[72:75], v[88:91]
  v_cvt_pk_bf16_f32 v103, v110, v111
  v_cvt_pk_bf16_f32 v104, v192, v193
  v_mfma_f32_16x16x32_bf16 v[88:91], v[44:47], a[88:91], v[88:91]
  v_cndmask_b32_e64 v104, v104, v56, s[78:79]
  v_mfma_f32_16x16x32_bf16 v[92:95], v[40:43], a[76:79], v[92:95]
  v_cvt_pk_bf16_f32 v105, v194, v195
  v_cndmask_b32_e64 v105, v105, v56, s[78:79]
  v_mfma_f32_16x16x32_bf16 v[92:95], v[44:47], a[92:95], v[92:95]
  s_waitcnt lgkmcnt(4)
  v_cvt_pk_bf16_f32 v106, v196, v197
  v_mfma_f32_16x16x32_bf16 v[128:131], v[24:27], a[64:67], v[128:131]
  ds_read_b64_tr_b16 v[40:41], v19 offset:18432
  v_cndmask_b32_e64 v106, v106, v56, s[78:79]
  v_mfma_f32_16x16x32_bf16 v[128:131], v[28:31], a[80:83], v[128:131]
  ds_read_b64_tr_b16 v[42:43], v19 offset:19456
  v_cvt_pk_bf16_f32 v107, v198, v199
  v_mfma_f32_16x16x32_bf16 v[132:135], v[24:27], a[68:71], v[132:135]
  ds_read_b64_tr_b16 v[44:45], v19 offset:22528
  v_cndmask_b32_e64 v107, v107, v56, s[78:79]
  v_mfma_f32_16x16x32_bf16 v[132:135], v[28:31], a[84:87], v[132:135]
  ds_read_b64_tr_b16 v[46:47], v19 offset:23552
  v_subrev_u32 v19, 24576, v19
  v_mfma_f32_16x16x32_bf16 v[136:139], v[24:27], a[72:75], v[136:139]
  v_cvt_pk_bf16_f32 v108, v200, v201
  v_cndmask_b32_e64 v108, v108, v56, s[78:79]
  v_mfma_f32_16x16x32_bf16 v[136:139], v[28:31], a[88:91], v[136:139]
  v_cvt_pk_bf16_f32 v109, v202, v203
  v_mfma_f32_16x16x32_bf16 v[140:143], v[24:27], a[76:79], v[140:143]
  v_cndmask_b32_e64 v109, v109, v56, s[78:79]
  v_cvt_pk_bf16_f32 v110, v204, v205
  v_mfma_f32_16x16x32_bf16 v[140:143], v[28:31], a[92:95], v[140:143]
  s_waitcnt lgkmcnt(4)
  s_waitcnt lgkmcnt(0) vmcnt(8)
  s_barrier
  v_mfma_f32_16x16x32_bf16 v[160:163], v[32:35], a[64:67], v[160:163]
  s_add_u32 m0, s61, 122816
  s_mul_i32 s58, s86, 589824
  v_cndmask_b32_e64 v110, v110, v56, s[78:79]
  v_mfma_f32_16x16x32_bf16 v[160:163], v[36:39], a[80:83], v[160:163]
  buffer_load_dwordx4 v17, s[44:47], s58 offen offset:64 lds
  v_mfma_f32_16x16x32_bf16 v[164:167], v[32:35], a[68:71], v[164:167]
  s_add_u32 m0, s61, 126912
  ds_read_b64_tr_b16 v[24:25], v18 offset:0
  v_cvt_pk_bf16_f32 v111, v206, v207
  v_mfma_f32_16x16x32_bf16 v[164:167], v[36:39], a[84:87], v[164:167]
  s_add_u32 s28, s85, 1
  ds_read_b64_tr_b16 v[26:27], v18 offset:1024
  v_cndmask_b32_e64 v111, v111, v56, s[78:79]
  v_mfma_f32_16x16x32_bf16 v[168:171], v[32:35], a[72:75], v[168:171]
  ds_read_b64_tr_b16 v[28:29], v18 offset:4096
  v_mul_f32 v12, 0x3fb8aa3b, v192
  v_mfma_f32_16x16x32_bf16 v[168:171], v[36:39], a[88:91], v[168:171]
  buffer_load_dwordx4 v63, s[44:47], s58 offen offset:64 lds
  v_mfma_f32_16x16x32_bf16 v[172:175], v[32:35], a[76:79], v[172:175]
  s_add_u32 m0, s61, 131008
  s_mul_i32 s58, s87, 589824
  v_mul_f32 v56, 0x3fb8aa3b, v193
  v_mfma_f32_16x16x32_bf16 v[172:175], v[36:39], a[92:95], v[172:175]
  s_waitcnt lgkmcnt(3)
  ds_read_b64_tr_b16 v[30:31], v18 offset:5120
  v_max_f32 v192, 0x358637bd, v192
  v_mfma_f32_16x16x32_bf16 v[176:179], v[40:43], a[64:67], v[176:179]
  ds_read_b64_tr_b16 v[32:33], v18 offset:2048
  v_max_f32 v193, 0x358637bd, v193
  v_mfma_f32_16x16x32_bf16 v[176:179], v[44:47], a[80:83], v[176:179]
  ds_read_b64_tr_b16 v[34:35], v18 offset:3072
  v_lshlrev_b32 v15, 4, v0
  v_mfma_f32_16x16x32_bf16 v[180:183], v[40:43], a[68:71], v[180:183]
  ds_read_b64_tr_b16 v[36:37], v18 offset:6144
  v_mov_b32 v51, s28
  v_mfma_f32_16x16x32_bf16 v[180:183], v[44:47], a[84:87], v[180:183]
  buffer_store_dword v51, v60, s[40:43], s55 offen sc1
  v_mfma_f32_16x16x32_bf16 v[184:187], v[40:43], a[72:75], v[184:187]
  buffer_load_dwordx4 v17, s[44:47], s58 offen offset:64 lds
  v_mfma_f32_16x16x32_bf16 v[184:187], v[44:47], a[88:91], v[184:187]
  s_add_u32 m0, s61, 135104
  ds_read_b64_tr_b16 v[38:39], v18 offset:7168
  v_mfma_f32_16x16x32_bf16 v[188:191], v[40:43], a[76:79], v[188:191]
  v_exp_f32_e64 v12, v12 clamp
  v_mfma_f32_16x16x32_bf16 v[188:191], v[44:47], a[92:95], v[188:191]
  s_waitcnt lgkmcnt(4)
  v_exp_f32_e64 v56, v56 clamp
  v_mfma_f32_16x16x32_bf16 v[80:83], v[24:27], a[96:99], v[80:83]
  ds_read_b64_tr_b16 v[40:41], v19 offset:0
  v_add_f32 v192, v12, v192
  v_mfma_f32_16x16x32_bf16 v[80:83], v[28:31], a[112:115], v[80:83]
  ds_read_b64_tr_b16 v[42:43], v19 offset:1024
  v_add_f32 v193, v56, v193
  v_mfma_f32_16x16x32_bf16 v[84:87], v[24:27], a[100:103], v[84:87]
  ds_read_b64_tr_b16 v[44:45], v19 offset:4096
  v_mul_f32 v12, 0x3fb8aa3b, v194
  v_mfma_f32_16x16x32_bf16 v[84:87], v[28:31], a[116:119], v[84:87]
  ds_read_b64_tr_b16 v[46:47], v19 offset:5120
  v_mul_f32 v56, 0x3fb8aa3b, v195
  v_mfma_f32_16x16x32_bf16 v[88:91], v[24:27], a[104:107], v[88:91]
  v_exp_f32_e64 v12, v12 clamp
  v_mfma_f32_16x16x32_bf16 v[88:91], v[28:31], a[120:123], v[88:91]
  buffer_load_dwordx4 v63, s[44:47], s58 offen offset:64 lds
  v_mfma_f32_16x16x32_bf16 v[92:95], v[24:27], a[108:111], v[92:95]
  s_add_u32 m0, s61, 139200
  s_mul_i32 s58, s3, 589824
  v_max_f32 v194, 0x358637bd, v194
  v_mfma_f32_16x16x32_bf16 v[92:95], v[28:31], a[124:127], v[92:95]
  s_waitcnt lgkmcnt(4)
  v_exp_f32_e64 v56, v56 clamp
  v_mfma_f32_16x16x32_bf16 v[128:131], v[32:35], a[96:99], v[128:131]
  ds_read_b64_tr_b16 v[24:25], v19 offset:2048
  v_max_f32 v195, 0x358637bd, v195
  v_mfma_f32_16x16x32_bf16 v[128:131], v[36:39], a[112:115], v[128:131]
  ds_read_b64_tr_b16 v[26:27], v19 offset:3072
  v_add_f32 v194, v12, v194
  v_mfma_f32_16x16x32_bf16 v[132:135], v[32:35], a[100:103], v[132:135]
  ds_read_b64_tr_b16 v[28:29], v19 offset:6144
  v_add_f32 v195, v56, v195
  v_mfma_f32_16x16x32_bf16 v[132:135], v[36:39], a[116:119], v[132:135]
  ds_read_b64_tr_b16 v[30:31], v19 offset:7168
  v_mul_f32 v12, 0x3fb8aa3b, v196
  v_mfma_f32_16x16x32_bf16 v[136:139], v[32:35], a[104:107], v[136:139]
  v_mul_f32 v56, 0x3fb8aa3b, v197
  v_max_f32 v196, 0x358637bd, v196
  v_mfma_f32_16x16x32_bf16 v[136:139], v[36:39], a[120:123], v[136:139]
  v_exp_f32_e64 v12, v12 clamp
  v_mfma_f32_16x16x32_bf16 v[140:143], v[32:35], a[108:111], v[140:143]
  buffer_load_dwordx4 v17, s[44:47], s58 offen offset:64 lds
  v_mfma_f32_16x16x32_bf16 v[140:143], v[36:39], a[124:127], v[140:143]
  s_waitcnt lgkmcnt(4)
  s_add_u32 m0, s61, 143296
  v_max_f32 v197, 0x358637bd, v197
  v_mfma_f32_16x16x32_bf16 v[160:163], v[40:43], a[96:99], v[160:163]
  ds_read_b64_tr_b16 v[32:33], v18 offset:8192
  v_add_f32 v196, v12, v196
  v_mfma_f32_16x16x32_bf16 v[160:163], v[44:47], a[112:115], v[160:163]
  ds_read_b64_tr_b16 v[34:35], v18 offset:9216
  v_mul_f32 v12, 0x3fb8aa3b, v198
  v_mfma_f32_16x16x32_bf16 v[164:167], v[40:43], a[100:103], v[164:167]
  ds_read_b64_tr_b16 v[36:37], v18 offset:12288
  v_max_f32 v198, 0x358637bd, v198
  v_mfma_f32_16x16x32_bf16 v[164:167], v[44:47], a[116:119], v[164:167]
  ds_read_b64_tr_b16 v[38:39], v18 offset:13312
  v_cvt_pk_bf16_f32 v192, v192, v193
  v_mfma_f32_16x16x32_bf16 v[168:171], v[40:43], a[104:107], v[168:171]
  v_exp_f32_e64 v56, v56 clamp
  v_mfma_f32_16x16x32_bf16 v[168:171], v[44:47], a[120:123], v[168:171]
  v_add_f32 v197, v56, v197
  v_mul_f32 v56, 0x3fb8aa3b, v199
  v_mfma_f32_16x16x32_bf16 v[172:175], v[40:43], a[108:111], v[172:175]
  v_exp_f32_e64 v12, v12 clamp
  v_mfma_f32_16x16x32_bf16 v[172:175], v[44:47], a[124:127], v[172:175]
  s_waitcnt lgkmcnt(4)
  v_exp_f32_e64 v56, v56 clamp
  v_mfma_f32_16x16x32_bf16 v[176:179], v[24:27], a[96:99], v[176:179]
  buffer_load_dwordx4 v63, s[44:47], s58 offen offset:64 lds
  v_mfma_f32_16x16x32_bf16 v[176:179], v[28:31], a[112:115], v[176:179]
  s_add_u32 m0, s64, 0
  s_mov_b32 s56, s65
  v_max_f32 v199, 0x358637bd, v199
  v_mfma_f32_16x16x32_bf16 v[180:183], v[24:27], a[100:103], v[180:183]
  ds_read_b64_tr_b16 v[40:41], v18 offset:10240
  v_add_f32 v198, v12, v198
  v_mfma_f32_16x16x32_bf16 v[180:183], v[28:31], a[116:119], v[180:183]
  ds_read_b64_tr_b16 v[42:43], v18 offset:11264
  v_add_f32 v199, v56, v199
  v_mfma_f32_16x16x32_bf16 v[184:187], v[24:27], a[104:107], v[184:187]
  ds_read_b64_tr_b16 v[44:45], v18 offset:14336
  v_mul_f32 v12, 0x3fb8aa3b, v200
  v_mfma_f32_16x16x32_bf16 v[184:187], v[28:31], a[120:123], v[184:187]
  v_mfma_f32_16x16x32_bf16 v[120:123], v[112:115], v[96:99], 0
  v_mfma_f32_16x16x32_bf16 v[188:191], v[24:27], a[108:111], v[188:191]
  v_mfma_f32_16x16x32_bf16 v[124:127], v[112:115], v[104:107], 0
  v_mfma_f32_16x16x32_bf16 v[188:191], v[28:31], a[124:127], v[188:191]
  s_waitcnt lgkmcnt(3)
  ds_read_b64_tr_b16 v[46:47], v18 offset:15360
  v_mul_f32 v56, 0x3fb8aa3b, v201
  v_mfma_f32_16x16x32_bf16 v[80:83], v[32:35], a[128:131], v[80:83]
  v_mfma_f32_16x16x32_bf16 v[120:123], v[116:119], v[100:103], v[120:123]
  v_mfma_f32_16x16x32_bf16 v[80:83], v[36:39], a[144:147], v[80:83]
  v_mfma_f32_16x16x32_bf16 v[124:127], v[116:119], v[108:111], v[124:127]
  v_mfma_f32_16x16x32_bf16 v[84:87], v[32:35], a[132:135], v[84:87]
  buffer_load_dwordx4 v1, s[24:27], s56 offen lds
  v_mfma_f32_16x16x32_bf16 v[84:87], v[36:39], a[148:151], v[84:87]
  buffer_load_dwordx4 v2, s[24:27], s56 offen offset:1024 lds
  v_mfma_f32_16x16x32_bf16 v[88:91], v[32:35], a[136:139], v[88:91]
  ds_read_b64_tr_b16 v[24:25], v19 offset:8192
  v_max_f32 v200, 0x358637bd, v200
  v_mfma_f32_16x16x32_bf16 v[88:91], v[36:39], a[152:155], v[88:91]
  ds_read_b64_tr_b16 v[26:27], v19 offset:9216
  v_max_f32 v201, 0x358637bd, v201
  v_mfma_f32_16x16x32_bf16 v[92:95], v[32:35], a[140:143], v[92:95]
  ds_read_b64_tr_b16 v[28:29], v19 offset:12288
  v_cvt_pk_bf16_f32 v193, v194, v195
  v_mfma_f32_16x16x32_bf16 v[92:95], v[36:39], a[156:159], v[92:95]
  s_waitcnt lgkmcnt(3)
  ds_read_b64_tr_b16 v[30:31], v19 offset:13312
  v_cvt_pk_bf16_f32 v194, v196, v197
  v_mfma_f32_16x16x32_bf16 v[128:131], v[40:43], a[128:131], v[128:131]
  ds_write_b128 v14, v[120:123] offset:0
  v_mfma_f32_16x16x32_bf16 v[128:131], v[44:47], a[144:147], v[128:131]
  ds_write_b128 v14, v[124:127] offset:1024
  v_mfma_f32_16x16x32_bf16 v[132:135], v[40:43], a[132:135], v[132:135]
  buffer_load_dwordx4 v3, s[24:27], s56 offen offset:2048 lds
  v_mfma_f32_16x16x32_bf16 v[132:135], v[44:47], a[148:151], v[132:135]
  buffer_load_dwordx4 v4, s[24:27], s56 offen offset:3072 lds
  v_mfma_f32_16x16x32_bf16 v[136:139], v[40:43], a[136:139], v[136:139]
  s_add_u32 m0, s64, 4096
  ds_read_b64_tr_b16 v[32:33], v19 offset:10240
  v_cvt_pk_bf16_f32 v195, v198, v199
  v_mfma_f32_16x16x32_bf16 v[136:139], v[44:47], a[152:155], v[136:139]
  s_add_u32 s83, s63, 147456
  ds_read_b64_tr_b16 v[34:35], v19 offset:11264
  v_add_u32 v22, s83, v15
  v_mfma_f32_16x16x32_bf16 v[140:143], v[40:43], a[140:143], v[140:143]
  s_lshl_b32 s91, s50, 3
  ds_read_b64_tr_b16 v[36:37], v19 offset:14336
  v_mfma_f32_16x16x32_bf16 v[140:143], v[44:47], a[156:159], v[140:143]
  s_waitcnt lgkmcnt(5)
  ds_read_b64_tr_b16 v[38:39], v19 offset:15360
  v_mfma_f32_16x16x32_bf16 v[160:163], v[24:27], a[128:131], v[160:163]
  buffer_load_dwordx4 v5, s[24:27], s56 offen lds
  v_mfma_f32_16x16x32_bf16 v[160:163], v[28:31], a[144:147], v[160:163]
  s_add_u32 s91, s91, s49
  v_exp_f32_e64 v12, v12 clamp
  v_mfma_f32_16x16x32_bf16 v[164:167], v[24:27], a[132:135], v[164:167]
  s_lshl_b32 s91, s91, 12
  v_exp_f32_e64 v56, v56 clamp
  v_mfma_f32_16x16x32_bf16 v[164:167], v[28:31], a[148:151], v[164:167]
  s_add_u32 s91, s91, s63
  v_add_f32 v200, v12, v200
  v_add_f32 v201, v56, v201
  v_mfma_f32_16x16x32_bf16 v[168:171], v[24:27], a[136:139], v[168:171]
  v_mul_f32 v12, 0x3fb8aa3b, v202
  v_mul_f32 v56, 0x3fb8aa3b, v203
  v_exp_f32_e64 v12, v12 clamp
  v_exp_f32_e64 v56, v56 clamp
  v_max_f32 v202, 0x358637bd, v202
  v_max_f32 v203, 0x358637bd, v203
  v_add_f32 v202, v12, v202
  v_add_f32 v203, v56, v203
  v_mul_f32 v12, 0x3fb8aa3b, v204
  v_mul_f32 v56, 0x3fb8aa3b, v205
  v_exp_f32_e64 v12, v12 clamp
  v_exp_f32_e64 v56, v56 clamp
  v_max_f32 v204, 0x358637bd, v204
  v_max_f32 v205, 0x358637bd, v205
  v_add_f32 v204, v12, v204
  v_add_f32 v205, v56, v205
  v_mul_f32 v12, 0x3fb8aa3b, v206
  v_mul_f32 v56, 0x3fb8aa3b, v207
  v_exp_f32_e64 v12, v12 clamp
  v_exp_f32_e64 v56, v56 clamp
  v_max_f32 v206, 0x358637bd, v206
  v_max_f32 v207, 0x358637bd, v207
  v_add_f32 v206, v12, v206
  v_add_f32 v207, v56, v207
  v_cvt_pk_bf16_f32 v196, v200, v201
  v_cvt_pk_bf16_f32 v197, v202, v203
  v_cvt_pk_bf16_f32 v198, v204, v205
  v_cvt_pk_bf16_f32 v199, v206, v207
  v_mfma_f32_16x16x32_bf16 v[200:203], v[192:195], v[96:99], 0
  v_mfma_f32_16x16x32_bf16 v[204:207], v[192:195], v[104:107], 0
  v_mfma_f32_16x16x32_bf16 v[200:203], v[196:199], v[100:103], v[200:203]
  v_mfma_f32_16x16x32_bf16 v[204:207], v[196:199], v[108:111], v[204:207]
  s_nop 6
  ds_write_b128 v14, v[200:203] offset:2048
  ds_write_b128 v14, v[204:207] offset:3072
  s_waitcnt lgkmcnt(0)
  s_barrier
  v_mfma_f32_16x16x32_bf16 v[168:171], v[28:31], a[152:155], v[168:171]
  ds_read_b64_tr_b16 v[40:41], v18 offset:16384
  buffer_load_dwordx4 v6, s[24:27], s56 offen offset:1024 lds
  v_mfma_f32_16x16x32_bf16 v[172:175], v[24:27], a[140:143], v[172:175]
  ds_read_b64_tr_b16 v[42:43], v18 offset:17408
  buffer_load_dwordx4 v7, s[24:27], s56 offen offset:2048 lds
  v_mfma_f32_16x16x32_bf16 v[172:175], v[28:31], a[156:159], v[172:175]
  ds_read_b64_tr_b16 v[44:45], v18 offset:20480
  ds_read_b64_tr_b16 v[46:47], v18 offset:21504
  s_waitcnt lgkmcnt(6)
  v_mfma_f32_16x16x32_bf16 v[176:179], v[32:35], a[128:131], v[176:179]
  s_add_u32 s91, s91, 21495808
  ds_read_b64_tr_b16 v[24:25], v18 offset:18432
  v_bfe_u32 v12, v0, 2, 2
  v_mfma_f32_16x16x32_bf16 v[176:179], v[36:39], a[144:147], v[176:179]
  buffer_load_dwordx4 v8, s[24:27], s56 offen offset:3072 lds
  v_mfma_f32_16x16x32_bf16 v[180:183], v[32:35], a[132:135], v[180:183]
  s_add_u32 m0, s64, 8192
  ds_read_b64_tr_b16 v[26:27], v18 offset:19456
  v_lshrrev_b32 v103, 4, v0
  v_mfma_f32_16x16x32_bf16 v[180:183], v[36:39], a[148:151], v[180:183]
  ds_read_b64_tr_b16 v[28:29], v18 offset:22528
  v_cmp_eq_u32 vcc, v12, v103
  v_mfma_f32_16x16x32_bf16 v[184:187], v[32:35], a[136:139], v[184:187]
  ds_read_b64_tr_b16 v[30:31], v18 offset:23552
  v_subrev_u32 v18, 24576, v18
  v_mfma_f32_16x16x32_bf16 v[184:187], v[36:39], a[152:155], v[184:187]
  ds_read_b128 v[112:115], v22 offset:0
  v_and_b32 v12, 1, v0
  v_mfma_f32_16x16x32_bf16 v[188:191], v[32:35], a[140:143], v[188:191]
  buffer_load_dwordx4 v9, s[24:27], s56 offen lds
  v_mfma_f32_16x16x32_bf16 v[188:191], v[36:39], a[156:159], v[188:191]
  s_waitcnt lgkmcnt(5)
  s_add_u32 m0, s64, 36864
  s_mov_b32 s56, s66
  v_mfma_f32_16x16x32_bf16 v[80:83], v[40:43], a[160:163], v[80:83]
  s_lshl_b32 s83, s51, 3
  ds_read_b64_tr_b16 v[32:33], v19 offset:16384
  v_lshlrev_b32 v12, 4, v12
  v_mfma_f32_16x16x32_bf16 v[80:83], v[44:47], a[176:179], v[80:83]
  s_add_u32 s83, s83, s49
  ds_read_b64_tr_b16 v[34:35], v19 offset:17408
  v_mov_b32 v56, 0x3f80
  v_mfma_f32_16x16x32_bf16 v[84:87], v[40:43], a[164:167], v[84:87]
  s_lshl_b32 s83, s83, 2
  ds_read_b64_tr_b16 v[36:37], v19 offset:20480
  v_lshlrev_b32 v56, v12, v56
  v_mfma_f32_16x16x32_bf16 v[84:87], v[44:47], a[180:183], v[84:87]
  buffer_load_dwordx4 v1, s[24:27], s56 offen lds
  v_mfma_f32_16x16x32_bf16 v[88:91], v[40:43], a[168:171], v[88:91]
  s_add_u32 s83, s83, s48
  ds_read_b64_tr_b16 v[38:39], v19 offset:21504
  v_cndmask_b32 v56, 0, v56, vcc
  v_mfma_f32_16x16x32_bf16 v[88:91], v[44:47], a[184:187], v[88:91]
  s_lshl_b32 s83, s83, 8
  ds_read_b128 v[116:119], v22 offset:4096
  v_and_b32 v12, 2, v0
  v_mfma_f32_16x16x32_bf16 v[92:95], v[40:43], a[172:175], v[92:95]
  s_add_u32 s83, s83, 22609920
  ds_read_b128 v[120:123], v22 offset:8192
  v_cmp_eq_u32 vcc, 0, v12
  v_mfma_f32_16x16x32_bf16 v[92:95], v[44:47], a[188:191], v[92:95]
  s_waitcnt lgkmcnt(7)
  ds_read_b128 v[124:127], v22 offset:12288
  v_cndmask_b32 v96, 0, v56, vcc
  v_mfma_f32_16x16x32_bf16 v[128:131], v[24:27], a[160:163], v[128:131]
  buffer_load_dwordx4 v2, s[24:27], s56 offen offset:1024 lds
  v_mfma_f32_16x16x32_bf16 v[128:131], v[28:31], a[176:179], v[128:131]
  s_waitcnt lgkmcnt(0)
  v_add_f32 v112, v112, v116
  v_add_f32 v113, v113, v117
  v_mfma_f32_16x16x32_bf16 v[132:135], v[24:27], a[164:167], v[132:135]
  ds_read_b64_tr_b16 v[40:41], v19 offset:18432
  v_add_f32 v114, v114, v118
  v_mfma_f32_16x16x32_bf16 v[132:135], v[28:31], a[180:183], v[132:135]
  v_add_f32 v115, v115, v119
  v_add_f32 v112, v112, v120
  v_mfma_f32_16x16x32_bf16 v[136:139], v[24:27], a[168:171], v[136:139]
  ds_read_b64_tr_b16 v[42:43], v19 offset:19456
  v_add_f32 v113, v113, v121
  v_mfma_f32_16x16x32_bf16 v[136:139], v[28:31], a[184:187], v[136:139]
  buffer_load_dwordx4 v3, s[24:27], s56 offen offset:2048 lds
  v_mfma_f32_16x16x32_bf16 v[140:143], v[24:27], a[172:175], v[140:143]
  v_add_f32 v114, v114, v122
  v_add_f32 v115, v115, v123
  v_add_f32 v112, v112, v124
  v_add_f32 v113, v113, v125
  v_add_f32 v114, v114, v126
  v_add_f32 v115, v115, v127
  buffer_store_dwordx4 v[112:115], v15, s[40:43], s91 offen sc1
  v_mfma_f32_16x16x32_bf16 v[140:143], v[28:31], a[188:191], v[140:143]
  ds_read_b64_tr_b16 v[44:45], v19 offset:22528
  ds_read_b64_tr_b16 v[46:47], v19 offset:23552
  s_waitcnt lgkmcnt(7)
  s_waitcnt lgkmcnt(0) vmcnt(20)
  s_barrier
  v_mfma_f32_16x16x32_bf16 v[160:163], v[32:35], a[160:163], v[160:163]
  s_add_u32 m0, s61, 98240
  s_mul_i32 s58, s100, 589824
  v_subrev_u32 v19, 24576, v19
  v_mfma_f32_16x16x32_bf16 v[160:163], v[36:39], a[176:179], v[160:163]
  ds_read_b64_tr_b16 v[24:25], v18 offset:0
  v_cndmask_b32 v97, v56, 0, vcc
  v_mfma_f32_16x16x32_bf16 v[164:167], v[32:35], a[164:167], v[164:167]
  ds_read_b64_tr_b16 v[26:27], v18 offset:1024
  v_lshl_add_u32 v23, v0, 2, s83
  v_mfma_f32_16x16x32_bf16 v[164:167], v[36:39], a[180:183], v[164:167]
  ds_read_b64_tr_b16 v[28:29], v18 offset:4096
  v_mov_b32 v98, 0
  v_mfma_f32_16x16x32_bf16 v[168:171], v[32:35], a[168:171], v[168:171]
  ds_read_b64_tr_b16 v[30:31], v18 offset:5120
  v_mov_b32 v99, 0
  v_mfma_f32_16x16x32_bf16 v[168:171], v[36:39], a[184:187], v[168:171]
  s_nop 0
  v_mfma_f32_16x16x32_bf16 v[192:195], v[104:107], v[96:99], 0
  v_mfma_f32_16x16x32_bf16 v[172:175], v[32:35], a[172:175], v[172:175]
  v_mfma_f32_16x16x32_bf16 v[200:203], v[108:111], v[96:99], 0
  v_mfma_f32_16x16x32_bf16 v[172:175], v[36:39], a[188:191], v[172:175]
  s_waitcnt lgkmcnt(4)
  v_mov_b32 v102, v96
  v_mov_b32 v103, v97
  v_mfma_f32_16x16x32_bf16 v[176:179], v[40:43], a[160:163], v[176:179]
  ds_read_b64_tr_b16 v[32:33], v18 offset:2048
  v_mov_b32 v100, 0
  v_mfma_f32_16x16x32_bf16 v[176:179], v[44:47], a[176:179], v[176:179]
  buffer_load_dwordx4 v17, s[44:47], s58 offen offset:64 lds
  v_mfma_f32_16x16x32_bf16 v[180:183], v[40:43], a[164:167], v[180:183]
  s_add_u32 m0, s61, 102336
  ds_read_b64_tr_b16 v[34:35], v18 offset:3072
  v_mov_b32 v101, 0
  v_mfma_f32_16x16x32_bf16 v[180:183], v[44:47], a[180:183], v[180:183]
  s_nop 0
  v_mfma_f32_16x16x32_bf16 v[196:199], v[104:107], v[100:103], 0
  v_mfma_f32_16x16x32_bf16 v[184:187], v[40:43], a[168:171], v[184:187]
  v_mfma_f32_16x16x32_bf16 v[204:207], v[108:111], v[100:103], 0
  v_mfma_f32_16x16x32_bf16 v[184:187], v[44:47], a[184:187], v[184:187]
  ds_read_b64_tr_b16 v[36:37], v18 offset:6144
  v_mul_f32 v194, 0xbfb8aa3b, v194
  v_mfma_f32_16x16x32_bf16 v[188:191], v[40:43], a[172:175], v[188:191]
  ds_read_b64_tr_b16 v[38:39], v18 offset:7168
  v_mul_f32 v12, 0x3fb8aa3b, v192
  v_mfma_f32_16x16x32_bf16 v[188:191], v[44:47], a[188:191], v[188:191]
  s_waitcnt lgkmcnt(4)
  v_exp_f32 v194, v194
  v_mfma_f32_16x16x32_bf16 v[80:83], v[24:27], a[192:195], v[80:83]
  buffer_load_dwordx4 v63, s[44:47], s58 offen offset:64 lds
  v_mfma_f32_16x16x32_bf16 v[80:83], v[28:31], a[208:211], v[80:83]
  s_add_u32 m0, s61, 106432
  s_mul_i32 s58, s101, 589824
  v_add_f32 v194, 1.0, v194
  v_mfma_f32_16x16x32_bf16 v[84:87], v[24:27], a[196:199], v[84:87]
  ds_read_b64_tr_b16 v[40:41], v19 offset:0
  v_mul_f32 v56, 0x3fb8aa3b, v193
  v_mfma_f32_16x16x32_bf16 v[84:87], v[28:31], a[212:215], v[84:87]
  ds_read_b64_tr_b16 v[42:43], v19 offset:1024
  v_max_f32 v192, 0x358637bd, v192
  v_mfma_f32_16x16x32_bf16 v[88:91], v[24:27], a[200:203], v[88:91]
  ds_read_b64_tr_b16 v[44:45], v19 offset:4096
  v_max_f32 v193, 0x358637bd, v193
  v_mfma_f32_16x16x32_bf16 v[88:91], v[28:31], a[216:219], v[88:91]
  ds_read_b64_tr_b16 v[46:47], v19 offset:5120
  v_mul_f32 v198, 0xbfb8aa3b, v198
  v_mfma_f32_16x16x32_bf16 v[92:95], v[24:27], a[204:207], v[92:95]
  v_rcp_f32 v49, v194
  v_mfma_f32_16x16x32_bf16 v[92:95], v[28:31], a[220:223], v[92:95]
  s_waitcnt lgkmcnt(4)
  v_exp_f32_e64 v12, v12 clamp
  v_mfma_f32_16x16x32_bf16 v[128:131], v[32:35], a[192:195], v[128:131]
  buffer_load_dwordx4 v17, s[44:47], s58 offen offset:64 lds
  v_mfma_f32_16x16x32_bf16 v[128:131], v[36:39], a[208:211], v[128:131]
  s_add_u32 m0, s61, 110528
  ds_read_b64_tr_b16 v[24:25], v19 offset:2048
  v_add_f32 v192, v12, v192
  v_mfma_f32_16x16x32_bf16 v[132:135], v[32:35], a[196:199], v[132:135]
  ds_read_b64_tr_b16 v[26:27], v19 offset:3072
  v_mul_f32 v12, 0x3fb8aa3b, v196
  v_mfma_f32_16x16x32_bf16 v[132:135], v[36:39], a[212:215], v[132:135]
  ds_read_b64_tr_b16 v[28:29], v19 offset:6144
  v_max_f32 v196, 0x358637bd, v196
  v_mfma_f32_16x16x32_bf16 v[136:139], v[32:35], a[200:203], v[136:139]
  ds_read_b64_tr_b16 v[30:31], v19 offset:7168
  v_mul_f32 v202, 0xbfb8aa3b, v202
  v_mfma_f32_16x16x32_bf16 v[136:139], v[36:39], a[216:219], v[136:139]
  v_exp_f32_e64 v56, v56 clamp
  v_mfma_f32_16x16x32_bf16 v[140:143], v[32:35], a[204:207], v[140:143]
  s_lshr_b32 s83, s52, 1
  s_lshl_b32 s83, s83, 5
  s_lshl_b32 s84, s51, 3
  v_mfma_f32_16x16x32_bf16 v[140:143], v[36:39], a[220:223], v[140:143]
  s_waitcnt lgkmcnt(4)
  s_add_u32 s83, s83, s84
  s_lshl_b32 s83, s83, 7
  v_mfma_f32_16x16x32_bf16 v[160:163], v[40:43], a[192:195], v[160:163]
  s_add_u32 s83, s83, 22544384
  ds_read_b64_tr_b16 v[32:33], v18 offset:8192
  v_lshl_add_u32 v21, v0, 7, s83
  v_mfma_f32_16x16x32_bf16 v[160:163], v[44:47], a[208:211], v[160:163]
  buffer_load_dwordx4 v63, s[44:47], s58 offen offset:64 lds
  v_mfma_f32_16x16x32_bf16 v[164:167], v[40:43], a[196:199], v[164:167]
  s_add_u32 m0, s61, 114624
  s_mul_i32 s58, s97, 589824
  v_cmp_gt_u32 vcc, 8, v0
  v_mfma_f32_16x16x32_bf16 v[164:167], v[44:47], a[212:215], v[164:167]
  s_lshl_b32 s83, s0, 7
  ds_read_b64_tr_b16 v[34:35], v18 offset:9216
  v_or_b32 v20, 0x7f000000, v60
  v_mfma_f32_16x16x32_bf16 v[168:171], v[40:43], a[200:203], v[168:171]
  s_add_u32 s83, s83, 22544384
  ds_read_b64_tr_b16 v[36:37], v18 offset:12288
  v_cndmask_b32 v21, v20, v21, vcc
  v_mfma_f32_16x16x32_bf16 v[168:171], v[44:47], a[216:219], v[168:171]
  ds_read_b64_tr_b16 v[38:39], v18 offset:13312
  v_lshl_add_u32 v59, v0, 12, s83
  v_mfma_f32_16x16x32_bf16 v[172:175], v[40:43], a[204:207], v[172:175]
  v_cndmask_b32 v59, v20, v59, vcc
  v_lshrrev_b32 v20, 2, v0
  v_mfma_f32_16x16x32_bf16 v[172:175], v[44:47], a[220:223], v[172:175]
  s_waitcnt lgkmcnt(4)
  v_mul_u32_u24 v20, 288, v20
  v_mfma_f32_16x16x32_bf16 v[176:179], v[24:27], a[192:195], v[176:179]
  ds_read_b64_tr_b16 v[40:41], v18 offset:10240
  v_and_b32 v10, 3, v0
  v_mfma_f32_16x16x32_bf16 v[176:179], v[28:31], a[208:211], v[176:179]
  ds_read_b64_tr_b16 v[42:43], v18 offset:11264
  v_lshl_add_u32 v10, v10, 3, v20
  v_mfma_f32_16x16x32_bf16 v[180:183], v[24:27], a[196:199], v[180:183]
  buffer_load_dwordx4 v17, s[44:47], s58 offen offset:64 lds
  v_mfma_f32_16x16x32_bf16 v[180:183], v[28:31], a[212:215], v[180:183]
  s_add_u32 m0, s61, 118720
  ds_read_b64_tr_b16 v[44:45], v18 offset:14336
  v_add_f32 v193, v56, v193
  v_mfma_f32_16x16x32_bf16 v[184:187], v[24:27], a[200:203], v[184:187]
  ds_read_b64_tr_b16 v[46:47], v18 offset:15360
  v_cvt_pk_bf16_f32 v144, v192, v193
  v_mfma_f32_16x16x32_bf16 v[184:187], v[28:31], a[216:219], v[184:187]
  v_exp_f32 v198, v198
  v_mfma_f32_16x16x32_bf16 v[188:191], v[24:27], a[204:207], v[188:191]
  buffer_load_dword v20, v21, s[40:43], 0 offen sc1
  v_mfma_f32_16x16x32_bf16 v[188:191], v[28:31], a[220:223], v[188:191]
  s_waitcnt lgkmcnt(4)
  v_add_f32 v198, 1.0, v198
  v_mul_f32 v56, 0x3fb8aa3b, v197
  v_mfma_f32_16x16x32_bf16 v[80:83], v[32:35], a[224:227], v[80:83]
  buffer_load_dwordx4 v63, s[44:47], s58 offen offset:64 lds
  v_mfma_f32_16x16x32_bf16 v[80:83], v[36:39], a[240:243], v[80:83]
  s_add_u32 m0, s64, 36864
  ds_read_b64_tr_b16 v[24:25], v19 offset:8192
  v_max_f32 v197, 0x358637bd, v197
  v_mfma_f32_16x16x32_bf16 v[84:87], v[32:35], a[228:231], v[84:87]
  ds_read_b64_tr_b16 v[26:27], v19 offset:9216
  v_mul_f32 v206, 0xbfb8aa3b, v206
  v_mfma_f32_16x16x32_bf16 v[84:87], v[36:39], a[244:247], v[84:87]
  ds_read_b64_tr_b16 v[28:29], v19 offset:12288
  v_sub_f32 v50, 1.0, v49
  v_mfma_f32_16x16x32_bf16 v[88:91], v[32:35], a[232:235], v[88:91]
  ds_read_b64_tr_b16 v[30:31], v19 offset:13312
  v_mfma_f32_16x16x32_bf16 v[88:91], v[36:39], a[248:251], v[88:91]
  v_rcp_f32 v53, v198
  v_mfma_f32_16x16x32_bf16 v[92:95], v[32:35], a[236:239], v[92:95]
  v_exp_f32_e64 v12, v12 clamp
  v_mfma_f32_16x16x32_bf16 v[92:95], v[36:39], a[252:255], v[92:95]
  s_waitcnt lgkmcnt(4)
  v_exp_f32_e64 v56, v56 clamp
  v_mfma_f32_16x16x32_bf16 v[128:131], v[40:43], a[224:227], v[128:131]
  ds_read_b64_tr_b16 v[32:33], v19 offset:10240
  v_add_f32 v196, v12, v196
  v_mfma_f32_16x16x32_bf16 v[128:131], v[44:47], a[240:243], v[128:131]
  buffer_load_dwordx4 v4, s[24:27], s56 offen offset:3072 lds
  v_mfma_f32_16x16x32_bf16 v[132:135], v[40:43], a[228:231], v[132:135]
  s_add_u32 m0, s64, 40960
  ds_read_b64_tr_b16 v[34:35], v19 offset:11264
  v_add_f32 v197, v56, v197
  v_mfma_f32_16x16x32_bf16 v[132:135], v[44:47], a[244:247], v[132:135]
  ds_read_b64_tr_b16 v[36:37], v19 offset:14336
  v_cvt_pk_bf16_f32 v145, v196, v197
  v_mfma_f32_16x16x32_bf16 v[136:139], v[40:43], a[232:235], v[136:139]
  ds_read_b64_tr_b16 v[38:39], v19 offset:15360
  v_sub_f32 v54, 1.0, v53
  v_mfma_f32_16x16x32_bf16 v[136:139], v[44:47], a[248:251], v[136:139]
  v_exp_f32 v202, v202
  v_mfma_f32_16x16x32_bf16 v[140:143], v[40:43], a[236:239], v[140:143]
  buffer_load_dwordx4 v5, s[24:27], s56 offen lds
  v_mfma_f32_16x16x32_bf16 v[140:143], v[44:47], a[252:255], v[140:143]
  s_waitcnt lgkmcnt(4)
  v_exp_f32 v206, v206
  v_mfma_f32_16x16x32_bf16 v[160:163], v[24:27], a[224:227], v[160:163]
  ds_read_b64_tr_b16 v[40:41], v18 offset:16384
  v_add_f32 v202, 1.0, v202
  v_mfma_f32_16x16x32_bf16 v[160:163], v[28:31], a[240:243], v[160:163]
  ds_read_b64_tr_b16 v[42:43], v18 offset:17408
  v_add_f32 v206, 1.0, v206
  v_mfma_f32_16x16x32_bf16 v[164:167], v[24:27], a[228:231], v[164:167]
  ds_read_b64_tr_b16 v[44:45], v18 offset:20480
  v_mul_f32 v12, 0x3fb8aa3b, v200
  v_mfma_f32_16x16x32_bf16 v[164:167], v[28:31], a[244:247], v[164:167]
  buffer_load_dwordx4 v6, s[24:27], s56 offen offset:1024 lds
  v_mfma_f32_16x16x32_bf16 v[168:171], v[24:27], a[232:235], v[168:171]
  ds_read_b64_tr_b16 v[46:47], v18 offset:21504
  v_mul_f32 v56, 0x3fb8aa3b, v201
  v_mfma_f32_16x16x32_bf16 v[168:171], v[28:31], a[248:251], v[168:171]
  v_rcp_f32 v57, v202
  v_mfma_f32_16x16x32_bf16 v[172:175], v[24:27], a[236:239], v[172:175]
  v_rcp_f32 v61, v206
  v_mfma_f32_16x16x32_bf16 v[172:175], v[28:31], a[252:255], v[172:175]
  s_waitcnt lgkmcnt(4)
  v_sub_f32 v58, 1.0, v57
  v_sub_f32 v62, 1.0, v61
  v_mfma_f32_16x16x32_bf16 v[176:179], v[32:35], a[224:227], v[176:179]
  s_cmp_lg_u32 s77, 0
  s_cbranch_scc1 L_og_7
  s_mov_b64 exec, 0xffff
  buffer_store_dword v50, v23, s[40:43], 0 offen offset:0 sc1
  buffer_store_dword v54, v23, s[40:43], 0 offen offset:64 sc1
  buffer_store_dword v58, v23, s[40:43], 0 offen offset:128 sc1
  buffer_store_dword v62, v23, s[40:43], 0 offen offset:192 sc1
  s_mov_b64 exec, -1
L_og_7:
  v_mfma_f32_16x16x32_bf16 v[176:179], v[36:39], a[240:243], v[176:179]
  buffer_load_dwordx4 v7, s[24:27], s56 offen offset:2048 lds
  v_mfma_f32_16x16x32_bf16 v[180:183], v[32:35], a[228:231], v[180:183]
  ds_read_b64_tr_b16 v[24:25], v18 offset:18432
  v_max_f32 v200, 0x358637bd, v200
  v_mfma_f32_16x16x32_bf16 v[180:183], v[36:39], a[244:247], v[180:183]
  ds_read_b64_tr_b16 v[26:27], v18 offset:19456
  v_max_f32 v201, 0x358637bd, v201
  v_mfma_f32_16x16x32_bf16 v[184:187], v[32:35], a[232:235], v[184:187]
  ds_read_b64_tr_b16 v[28:29], v18 offset:22528
  v_mfma_f32_16x16x32_bf16 v[184:187], v[36:39], a[248:251], v[184:187]
  buffer_load_dwordx4 v8, s[24:27], s56 offen offset:3072 lds
  v_mfma_f32_16x16x32_bf16 v[188:191], v[32:35], a[236:239], v[188:191]
  s_add_u32 m0, s64, 45056
  ds_read_b64_tr_b16 v[30:31], v18 offset:23552
  v_add_u32 v18, 49152, v18
  v_mfma_f32_16x16x32_bf16 v[188:191], v[36:39], a[252:255], v[188:191]
  s_waitcnt lgkmcnt(4)
  v_exp_f32_e64 v12, v12 clamp
  v_mfma_f32_16x16x32_bf16 v[80:83], v[40:43], v[224:227], v[80:83]
  ds_read_b64_tr_b16 v[32:33], v19 offset:16384
  v_add_f32 v200, v12, v200
  v_mfma_f32_16x16x32_bf16 v[80:83], v[44:47], v[240:243], v[80:83]
  ds_read_b64_tr_b16 v[34:35], v19 offset:17408
  v_mul_f32 v12, 0x3fb8aa3b, v204
  v_mfma_f32_16x16x32_bf16 v[84:87], v[40:43], v[228:231], v[84:87]
  buffer_load_dwordx4 v9, s[24:27], s56 offen lds
  v_mfma_f32_16x16x32_bf16 v[84:87], v[44:47], v[244:247], v[84:87]
  ds_read_b64_tr_b16 v[36:37], v19 offset:20480
  v_max_f32 v204, 0x358637bd, v204
  v_mfma_f32_16x16x32_bf16 v[88:91], v[40:43], v[232:235], v[88:91]
  ds_read_b64_tr_b16 v[38:39], v19 offset:21504
  v_mfma_f32_16x16x32_bf16 v[88:91], v[44:47], v[248:251], v[88:91]
  v_exp_f32_e64 v56, v56 clamp
  v_mfma_f32_16x16x32_bf16 v[92:95], v[40:43], v[236:239], v[92:95]
  v_add_f32 v201, v56, v201
  v_cvt_pk_bf16_f32 v146, v200, v201
  v_mfma_f32_16x16x32_bf16 v[92:95], v[44:47], v[252:255], v[92:95]
  s_waitcnt lgkmcnt(4)
  v_mul_f32 v56, 0x3fb8aa3b, v205
  v_mfma_f32_16x16x32_bf16 v[128:131], v[24:27], v[224:227], v[128:131]
  ds_read_b64_tr_b16 v[40:41], v19 offset:18432
  v_max_f32 v205, 0x358637bd, v205
  v_mfma_f32_16x16x32_bf16 v[128:131], v[28:31], v[240:243], v[128:131]
  ds_read_b64_tr_b16 v[42:43], v19 offset:19456
  v_mfma_f32_16x16x32_bf16 v[132:135], v[24:27], v[228:231], v[132:135]
  ds_read_b64_tr_b16 v[44:45], v19 offset:22528
  v_mfma_f32_16x16x32_bf16 v[132:135], v[28:31], v[244:247], v[132:135]
  ds_read_b64_tr_b16 v[46:47], v19 offset:23552
  v_add_u32 v19, 49152, v19
  v_mfma_f32_16x16x32_bf16 v[136:139], v[24:27], v[232:235], v[136:139]
  v_exp_f32_e64 v12, v12 clamp
  v_mfma_f32_16x16x32_bf16 v[136:139], v[28:31], v[248:251], v[136:139]
  v_exp_f32_e64 v56, v56 clamp
  v_mfma_f32_16x16x32_bf16 v[140:143], v[24:27], v[236:239], v[140:143]
  v_add_f32 v204, v12, v204
  v_add_f32 v205, v56, v205
  v_mfma_f32_16x16x32_bf16 v[140:143], v[28:31], v[252:255], v[140:143]
  s_waitcnt lgkmcnt(4)
  s_waitcnt lgkmcnt(0) vmcnt(26)
  s_barrier
  v_mfma_f32_16x16x32_bf16 v[160:163], v[32:35], v[224:227], v[160:163]
  s_add_u32 m0, s61, 73664
  s_mul_i32 s58, s88, 589824
  v_cvt_pk_bf16_f32 v147, v204, v205
  v_mfma_f32_16x16x32_bf16 v[160:163], v[36:39], v[240:243], v[160:163]
  buffer_load_dwordx4 v17, s[44:47], s58 offen offset:64 lds
  v_mfma_f32_16x16x32_bf16 v[164:167], v[32:35], v[228:231], v[164:167]
  s_add_u32 m0, s61, 77760
  ds_read_b64_tr_b16 v[24:25], v18 offset:0
  v_mul_f32 v12, 0x3fb8aa3b, v64
  v_mfma_f32_16x16x32_bf16 v[164:167], v[36:39], v[244:247], v[164:167]
  ds_read_b64_tr_b16 v[26:27], v18 offset:1024
  v_mul_f32 v56, 0x3fb8aa3b, v65
  v_mfma_f32_16x16x32_bf16 v[168:171], v[32:35], v[232:235], v[168:171]
  ds_read_b64_tr_b16 v[28:29], v18 offset:4096
  v_max_f32 v64, 0x358637bd, v64
  v_mfma_f32_16x16x32_bf16 v[168:171], v[36:39], v[248:251], v[168:171]
  buffer_load_dwordx4 v63, s[44:47], s58 offen offset:64 lds
  v_mfma_f32_16x16x32_bf16 v[172:175], v[32:35], v[236:239], v[172:175]
  s_add_u32 m0, s61, 81856
  s_mul_i32 s58, s89, 589824
  v_max_f32 v65, 0x358637bd, v65
  v_mfma_f32_16x16x32_bf16 v[172:175], v[36:39], v[252:255], v[172:175]
  s_waitcnt lgkmcnt(3)
  ds_read_b64_tr_b16 v[30:31], v18 offset:5120
  v_mfma_f32_16x16x32_bf16 v[176:179], v[40:43], v[224:227], v[176:179]
  ds_read_b64_tr_b16 v[32:33], v18 offset:2048
  v_mfma_f32_16x16x32_bf16 v[176:179], v[44:47], v[240:243], v[176:179]
  ds_read_b64_tr_b16 v[34:35], v18 offset:3072
  v_mfma_f32_16x16x32_bf16 v[180:183], v[40:43], v[228:231], v[180:183]
  s_waitcnt vmcnt(9)
  ds_read_b64_tr_b16 v[36:37], v18 offset:6144
  v_subrev_u32 v20, s85, v20
  v_mfma_f32_16x16x32_bf16 v[180:183], v[44:47], v[244:247], v[180:183]
  ds_read_b64_tr_b16 v[38:39], v18 offset:7168
  v_add_u32 v20, -1, v20
  v_mfma_f32_16x16x32_bf16 v[184:187], v[40:43], v[232:235], v[184:187]
  v_cmp_gt_u32 s[22:23], 7, v20
  v_mfma_f32_16x16x32_bf16 v[184:187], v[44:47], v[248:251], v[184:187]
  s_and_b32 s29, s22, 0xff
  s_cmp_eq_u32 s29, 0xff
  s_cbranch_scc0 L_slow_9
L_ok_8:
  v_mfma_f32_16x16x32_bf16 v[188:191], v[40:43], v[236:239], v[188:191]
  buffer_load_dwordx4 v17, s[44:47], s58 offen offset:64 lds
  v_mfma_f32_16x16x32_bf16 v[188:191], v[44:47], v[252:255], v[188:191]
  s_waitcnt lgkmcnt(4)
  s_add_u32 m0, s61, 85952
  v_mfma_f32_16x16x32_bf16 v[112:115], v[24:27], a[0:3], 0
  ds_read_b64_tr_b16 v[40:41], v19 offset:0
  v_mfma_f32_16x16x32_bf16 v[112:115], v[28:31], a[16:19], v[112:115]
  ds_read_b64_tr_b16 v[42:43], v19 offset:1024
  v_mul_f32 v80, v80, v128
  v_mfma_f32_16x16x32_bf16 v[116:119], v[24:27], a[4:7], 0
  ds_read_b64_tr_b16 v[44:45], v19 offset:4096
  v_mul_f32 v81, v81, v129
  v_mfma_f32_16x16x32_bf16 v[116:119], v[28:31], a[20:23], v[116:119]
  ds_read_b64_tr_b16 v[46:47], v19 offset:5120
  v_mul_f32 v82, v82, v130
  v_mfma_f32_16x16x32_bf16 v[120:123], v[24:27], a[8:11], 0
  v_mul_f32 v83, v83, v131
  v_cvt_pk_bf16_f32 v128, v80, v81
  v_mfma_f32_16x16x32_bf16 v[120:123], v[28:31], a[24:27], v[120:123]
  v_cvt_pk_bf16_f32 v129, v82, v83
  v_mfma_f32_16x16x32_bf16 v[124:127], v[24:27], a[12:15], 0
  buffer_load_dwordx4 v63, s[44:47], s58 offen offset:64 lds
  v_mfma_f32_16x16x32_bf16 v[124:127], v[28:31], a[28:31], v[124:127]
  s_waitcnt lgkmcnt(4)
  s_add_u32 m0, s61, 90048
  s_mul_i32 s58, s1, 589824
  v_mfma_f32_16x16x32_bf16 v[96:99], v[32:35], a[0:3], 0
  v_mul_f32 v84, v84, v132
  v_mul_f32 v85, v85, v133
  v_mfma_f32_16x16x32_bf16 v[96:99], v[36:39], a[16:19], v[96:99]
  ds_read_b64_tr_b16 v[24:25], v19 offset:2048
  v_mul_f32 v86, v86, v134
  v_mfma_f32_16x16x32_bf16 v[100:103], v[32:35], a[4:7], 0
  v_mul_f32 v87, v87, v135
  v_cvt_pk_bf16_f32 v132, v84, v85
  v_mfma_f32_16x16x32_bf16 v[100:103], v[36:39], a[20:23], v[100:103]
  ds_read_b64_tr_b16 v[26:27], v19 offset:3072
  v_cvt_pk_bf16_f32 v133, v86, v87
  v_mfma_f32_16x16x32_bf16 v[104:107], v[32:35], a[8:11], 0
  v_mul_f32 v88, v88, v136
  v_mul_f32 v89, v89, v137
  v_mfma_f32_16x16x32_bf16 v[104:107], v[36:39], a[24:27], v[104:107]
  ds_read_b64_tr_b16 v[28:29], v19 offset:6144
  v_mul_f32 v90, v90, v138
  v_mfma_f32_16x16x32_bf16 v[108:111], v[32:35], a[12:15], 0
  v_mul_f32 v91, v91, v139
  v_cvt_pk_bf16_f32 v136, v88, v89
  v_mfma_f32_16x16x32_bf16 v[108:111], v[36:39], a[28:31], v[108:111]
  s_waitcnt lgkmcnt(3)
  ds_read_b64_tr_b16 v[30:31], v19 offset:7168
  v_cvt_pk_bf16_f32 v137, v90, v91
  v_mfma_f32_16x16x32_bf16 v[192:195], v[40:43], a[0:3], 0
  s_waitcnt vmcnt(17)
  s_barrier
  v_mfma_f32_16x16x32_bf16 v[192:195], v[44:47], a[16:19], v[192:195]
  buffer_load_dwordx4 v17, s[44:47], s58 offen offset:64 lds
  v_mfma_f32_16x16x32_bf16 v[196:199], v[40:43], a[4:7], 0
  s_add_u32 m0, s61, 94144
  v_mul_f32 v92, v92, v140
  v_mul_f32 v93, v93, v141
  v_mfma_f32_16x16x32_bf16 v[196:199], v[44:47], a[20:23], v[196:199]
  s_add_u32 s28, s85, 2
  ds_read_b64_tr_b16 v[32:33], v18 offset:8192
  v_mul_f32 v94, v94, v142
  v_mfma_f32_16x16x32_bf16 v[200:203], v[40:43], a[8:11], 0
  s_lshl_b32 s91, s0, 15
  v_mul_f32 v95, v95, v143
  v_cvt_pk_bf16_f32 v140, v92, v93
  v_mfma_f32_16x16x32_bf16 v[200:203], v[44:47], a[24:27], v[200:203]
  s_add_u32 s91, s91, s63
  ds_read_b64_tr_b16 v[34:35], v18 offset:9216
  v_cvt_pk_bf16_f32 v141, v94, v95
  v_mfma_f32_16x16x32_bf16 v[204:207], v[40:43], a[12:15], 0
  v_mul_f32 v160, v160, v176
  v_mul_f32 v161, v161, v177
  v_mfma_f32_16x16x32_bf16 v[204:207], v[44:47], a[28:31], v[204:207]
  ds_read_b64_tr_b16 v[36:37], v18 offset:12288
  ds_read_b64_tr_b16 v[38:39], v18 offset:13312
  s_waitcnt lgkmcnt(4)
  v_mfma_f32_16x16x32_bf16 v[208:211], v[24:27], a[0:3], 0
  buffer_load_dwordx4 v63, s[44:47], s58 offen offset:64 lds
  v_mfma_f32_16x16x32_bf16 v[208:211], v[28:31], a[16:19], v[208:211]
  s_add_u32 m0, s63, 147456
  s_mul_i32 s58, s88, 589824
  v_mul_f32 v162, v162, v178
  v_mfma_f32_16x16x32_bf16 v[212:215], v[24:27], a[4:7], 0
  v_mul_f32 v163, v163, v179
  v_cvt_pk_bf16_f32 v130, v160, v161
  v_mfma_f32_16x16x32_bf16 v[212:215], v[28:31], a[20:23], v[212:215]
  ds_read_b64_tr_b16 v[40:41], v18 offset:10240
  v_cvt_pk_bf16_f32 v131, v162, v163
  v_mfma_f32_16x16x32_bf16 v[216:219], v[24:27], a[8:11], 0
  v_mul_f32 v164, v164, v180
  v_mul_f32 v165, v165, v181
  v_mfma_f32_16x16x32_bf16 v[216:219], v[28:31], a[24:27], v[216:219]
  ds_read_b64_tr_b16 v[42:43], v18 offset:11264
  v_mul_f32 v166, v166, v182
  v_mfma_f32_16x16x32_bf16 v[220:223], v[24:27], a[12:15], 0
  v_mul_f32 v167, v167, v183
  v_cvt_pk_bf16_f32 v134, v164, v165
  v_mfma_f32_16x16x32_bf16 v[220:223], v[28:31], a[28:31], v[220:223]
  ds_read_b64_tr_b16 v[44:45], v18 offset:14336
  ds_read_b64_tr_b16 v[46:47], v18 offset:15360
  s_waitcnt lgkmcnt(4)
  v_mfma_f32_16x16x32_bf16 v[112:115], v[32:35], a[32:35], v[112:115]
  v_cvt_pk_bf16_f32 v135, v166, v167
  v_mul_f32 v168, v168, v184
  v_mfma_f32_16x16x32_bf16 v[112:115], v[36:39], a[48:51], v[112:115]
  buffer_load_dwordx4 v13, s[44:47], s58 offen lds
  v_mfma_f32_16x16x32_bf16 v[116:119], v[32:35], a[36:39], v[116:119]
  s_add_u32 m0, s63, 151552
  s_mul_i32 s58, s89, 589824
  v_mul_f32 v169, v169, v185
  v_mfma_f32_16x16x32_bf16 v[116:119], v[36:39], a[52:55], v[116:119]
  v_mul_f32 v170, v170, v186
  v_mul_f32 v171, v171, v187
  v_mfma_f32_16x16x32_bf16 v[120:123], v[32:35], a[40:43], v[120:123]
  ds_read_b64_tr_b16 v[24:25], v19 offset:8192
  v_cvt_pk_bf16_f32 v138, v168, v169
  v_mfma_f32_16x16x32_bf16 v[120:123], v[36:39], a[56:59], v[120:123]
  v_cvt_pk_bf16_f32 v139, v170, v171
  v_mul_f32 v172, v172, v188
  v_mfma_f32_16x16x32_bf16 v[124:127], v[32:35], a[44:47], v[124:127]
  ds_read_b64_tr_b16 v[26:27], v19 offset:9216
  v_mul_f32 v173, v173, v189
  v_mfma_f32_16x16x32_bf16 v[124:127], v[36:39], a[60:63], v[124:127]
  ds_read_b64_tr_b16 v[28:29], v19 offset:12288
  ds_read_b64_tr_b16 v[30:31], v19 offset:13312
  s_waitcnt lgkmcnt(4)
  v_mfma_f32_16x16x32_bf16 v[96:99], v[40:43], a[32:35], v[96:99]
  v_mul_f32 v174, v174, v190
  v_mul_f32 v175, v175, v191
  v_mfma_f32_16x16x32_bf16 v[96:99], v[44:47], a[48:51], v[96:99]
  ds_read_b64_tr_b16 v[32:33], v19 offset:10240
  v_cvt_pk_bf16_f32 v142, v172, v173
  v_mfma_f32_16x16x32_bf16 v[100:103], v[40:43], a[36:39], v[100:103]
  ds_read_b64_tr_b16 v[34:35], v19 offset:11264
  v_cvt_pk_bf16_f32 v143, v174, v175
  v_mfma_f32_16x16x32_bf16 v[100:103], v[44:47], a[52:55], v[100:103]
  ds_read_b64_tr_b16 v[36:37], v19 offset:14336
  v_mov_b32 v51, s28
  v_mfma_f32_16x16x32_bf16 v[104:107], v[40:43], a[40:43], v[104:107]
  buffer_store_dword v51, v60, s[40:43], s55 offen sc1
  v_mfma_f32_16x16x32_bf16 v[104:107], v[44:47], a[56:59], v[104:107]
  buffer_load_dwordx4 v13, s[44:47], s58 offen lds
  v_mfma_f32_16x16x32_bf16 v[108:111], v[40:43], a[44:47], v[108:111]
  s_add_u32 m0, s63, 155648
  s_mul_i32 s58, s1, 589824
  v_mfma_f32_16x16x32_bf16 v[108:111], v[44:47], a[60:63], v[108:111]
  s_waitcnt lgkmcnt(3)
  ds_read_b64_tr_b16 v[38:39], v19 offset:15360
  v_mfma_f32_16x16x32_bf16 v[192:195], v[24:27], a[32:35], v[192:195]
  ds_read_b64_tr_b16 v[40:41], v18 offset:16384
  v_mfma_f32_16x16x32_bf16 v[192:195], v[28:31], a[48:51], v[192:195]
  ds_read_b64_tr_b16 v[42:43], v18 offset:17408
  v_mfma_f32_16x16x32_bf16 v[196:199], v[24:27], a[36:39], v[196:199]
  ds_read_b64_tr_b16 v[44:45], v18 offset:20480
  v_mfma_f32_16x16x32_bf16 v[196:199], v[28:31], a[52:55], v[196:199]
  ds_read_b64_tr_b16 v[46:47], v18 offset:21504
  v_mfma_f32_16x16x32_bf16 v[200:203], v[24:27], a[40:43], v[200:203]
  v_exp_f32_e64 v12, v12 clamp
  v_mfma_f32_16x16x32_bf16 v[200:203], v[28:31], a[56:59], v[200:203]
  v_exp_f32_e64 v56, v56 clamp
  v_mfma_f32_16x16x32_bf16 v[204:207], v[24:27], a[44:47], v[204:207]
  v_add_f32 v64, v12, v64
  v_add_f32 v65, v56, v65
  v_mfma_f32_16x16x32_bf16 v[204:207], v[28:31], a[60:63], v[204:207]
  s_waitcnt lgkmcnt(4)
  v_mul_f32 v12, 0x3fb8aa3b, v66
  v_mfma_f32_16x16x32_bf16 v[208:211], v[32:35], a[32:35], v[208:211]
  ds_read_b64_tr_b16 v[24:25], v18 offset:18432
  v_mul_f32 v56, 0x3fb8aa3b, v67
  v_mfma_f32_16x16x32_bf16 v[208:211], v[36:39], a[48:51], v[208:211]
  ds_read_b64_tr_b16 v[26:27], v18 offset:19456
  v_max_f32 v66, 0x358637bd, v66
  v_mfma_f32_16x16x32_bf16 v[212:215], v[32:35], a[36:39], v[212:215]
  ds_read_b64_tr_b16 v[28:29], v18 offset:22528
  v_max_f32 v67, 0x358637bd, v67
  v_mfma_f32_16x16x32_bf16 v[212:215], v[36:39], a[52:55], v[212:215]
  ds_read_b64_tr_b16 v[30:31], v18 offset:23552
  v_subrev_u32 v18, 24576, v18
  v_mfma_f32_16x16x32_bf16 v[216:219], v[32:35], a[40:43], v[216:219]
  v_exp_f32_e64 v12, v12 clamp
  v_mfma_f32_16x16x32_bf16 v[216:219], v[36:39], a[56:59], v[216:219]
  v_exp_f32_e64 v56, v56 clamp
  v_mfma_f32_16x16x32_bf16 v[220:223], v[32:35], a[44:47], v[220:223]
  buffer_load_dwordx4 v13, s[44:47], s58 offen lds
  v_mfma_f32_16x16x32_bf16 v[220:223], v[36:39], a[60:63], v[220:223]
  s_waitcnt lgkmcnt(4)
  v_add_f32 v66, v12, v66
  v_add_f32 v67, v56, v67
  v_mfma_f32_16x16x32_bf16 v[112:115], v[40:43], a[64:67], v[112:115]
  ds_read_b64_tr_b16 v[32:33], v19 offset:16384
  v_mul_f32 v12, 0x3fb8aa3b, v68
  v_mfma_f32_16x16x32_bf16 v[112:115], v[44:47], a[80:83], v[112:115]
  ds_read_b64_tr_b16 v[34:35], v19 offset:17408
  v_mul_f32 v56, 0x3fb8aa3b, v69
  v_mfma_f32_16x16x32_bf16 v[116:119], v[40:43], a[68:71], v[116:119]
  ds_read_b64_tr_b16 v[36:37], v19 offset:20480
  v_max_f32 v68, 0x358637bd, v68
  v_mfma_f32_16x16x32_bf16 v[116:119], v[44:47], a[84:87], v[116:119]
  ds_read_b64_tr_b16 v[38:39], v19 offset:21504
  v_max_f32 v69, 0x358637bd, v69
  v_mfma_f32_16x16x32_bf16 v[120:123], v[40:43], a[72:75], v[120:123]
  v_exp_f32_e64 v12, v12 clamp
  v_mfma_f32_16x16x32_bf16 v[120:123], v[44:47], a[88:91], v[120:123]
  v_exp_f32_e64 v56, v56 clamp
  v_mfma_f32_16x16x32_bf16 v[124:127], v[40:43], a[76:79], v[124:127]
  v_add_f32 v68, v12, v68
  v_add_f32 v69, v56, v69
  v_mfma_f32_16x16x32_bf16 v[124:127], v[44:47], a[92:95], v[124:127]
  s_waitcnt lgkmcnt(4)
  v_mul_f32 v12, 0x3fb8aa3b, v70
  v_mfma_f32_16x16x32_bf16 v[96:99], v[24:27], a[64:67], v[96:99]
  ds_read_b64_tr_b16 v[40:41], v19 offset:18432
  v_mul_f32 v56, 0x3fb8aa3b, v71
  v_mfma_f32_16x16x32_bf16 v[96:99], v[28:31], a[80:83], v[96:99]
  ds_read_b64_tr_b16 v[42:43], v19 offset:19456
  v_max_f32 v70, 0x358637bd, v70
  v_mfma_f32_16x16x32_bf16 v[100:103], v[24:27], a[68:71], v[100:103]
  ds_read_b64_tr_b16 v[44:45], v19 offset:22528
  v_max_f32 v71, 0x358637bd, v71
  v_mfma_f32_16x16x32_bf16 v[100:103], v[28:31], a[84:87], v[100:103]
  ds_read_b64_tr_b16 v[46:47], v19 offset:23552
  v_subrev_u32 v19, 24576, v19
  v_mfma_f32_16x16x32_bf16 v[104:107], v[24:27], a[72:75], v[104:107]
  v_exp_f32_e64 v12, v12 clamp
  v_mfma_f32_16x16x32_bf16 v[104:107], v[28:31], a[88:91], v[104:107]
  v_exp_f32_e64 v56, v56 clamp
  v_mfma_f32_16x16x32_bf16 v[108:111], v[24:27], a[76:79], v[108:111]
  v_add_f32 v70, v12, v70
  v_add_f32 v71, v56, v71
  v_mfma_f32_16x16x32_bf16 v[108:111], v[28:31], a[92:95], v[108:111]
  s_waitcnt lgkmcnt(4)
  s_waitcnt lgkmcnt(0) vmcnt(16)
  s_barrier
  v_mfma_f32_16x16x32_bf16 v[192:195], v[32:35], a[64:67], v[192:195]
  s_add_u32 m0, s63, 122880
  s_mul_i32 s58, s86, 589824
  v_mul_f32 v12, 0x3fb8aa3b, v72
  v_mfma_f32_16x16x32_bf16 v[192:195], v[36:39], a[80:83], v[192:195]
  buffer_load_dwordx4 v13, s[44:47], s58 offen lds
  v_mfma_f32_16x16x32_bf16 v[196:199], v[32:35], a[68:71], v[196:199]
  s_add_u32 m0, s63, 126976
  s_mul_i32 s58, s87, 589824
  v_mul_f32 v56, 0x3fb8aa3b, v73
  v_mfma_f32_16x16x32_bf16 v[196:199], v[36:39], a[84:87], v[196:199]
  ds_read_b64_tr_b16 v[24:25], v18 offset:0
  v_max_f32 v72, 0x358637bd, v72
  v_mfma_f32_16x16x32_bf16 v[200:203], v[32:35], a[72:75], v[200:203]
  ds_read_b64_tr_b16 v[26:27], v18 offset:1024
  v_max_f32 v73, 0x358637bd, v73
  v_mfma_f32_16x16x32_bf16 v[200:203], v[36:39], a[88:91], v[200:203]
  ds_read_b64_tr_b16 v[28:29], v18 offset:4096
  v_cvt_pk_bf16_f32 v64, v64, v65
  v_mfma_f32_16x16x32_bf16 v[204:207], v[32:35], a[76:79], v[204:207]
  ds_read_b64_tr_b16 v[30:31], v18 offset:5120
  v_cvt_pk_bf16_f32 v65, v66, v67
  v_mfma_f32_16x16x32_bf16 v[204:207], v[36:39], a[92:95], v[204:207]
  s_waitcnt lgkmcnt(4)
  v_exp_f32_e64 v12, v12 clamp
  v_mfma_f32_16x16x32_bf16 v[208:211], v[40:43], a[64:67], v[208:211]
  ds_read_b64_tr_b16 v[32:33], v18 offset:2048
  v_add_f32 v72, v12, v72
  v_mfma_f32_16x16x32_bf16 v[208:211], v[44:47], a[80:83], v[208:211]
  ds_read_b64_tr_b16 v[34:35], v18 offset:3072
  v_mul_f32 v12, 0x3fb8aa3b, v74
  v_mfma_f32_16x16x32_bf16 v[212:215], v[40:43], a[68:71], v[212:215]
  ds_read_b64_tr_b16 v[36:37], v18 offset:6144
  v_max_f32 v74, 0x358637bd, v74
  v_mfma_f32_16x16x32_bf16 v[212:215], v[44:47], a[84:87], v[212:215]
  ds_read_b64_tr_b16 v[38:39], v18 offset:7168
  v_permlane32_swap_b32 v144, v66
  v_mfma_f32_16x16x32_bf16 v[216:219], v[40:43], a[72:75], v[216:219]
  v_exp_f32_e64 v56, v56 clamp
  v_mfma_f32_16x16x32_bf16 v[216:219], v[44:47], a[88:91], v[216:219]
  v_add_f32 v73, v56, v73
  v_mul_f32 v56, 0x3fb8aa3b, v75
  v_mfma_f32_16x16x32_bf16 v[220:223], v[40:43], a[76:79], v[220:223]
  v_exp_f32_e64 v12, v12 clamp
  v_mfma_f32_16x16x32_bf16 v[220:223], v[44:47], a[92:95], v[220:223]
  s_waitcnt lgkmcnt(4)
  v_exp_f32_e64 v56, v56 clamp
  v_mfma_f32_16x16x32_bf16 v[112:115], v[24:27], a[96:99], v[112:115]
  buffer_load_dwordx4 v13, s[44:47], s58 offen lds
  v_mfma_f32_16x16x32_bf16 v[112:115], v[28:31], a[112:115], v[112:115]
  s_add_u32 m0, s63, 131072
  s_mul_i32 s58, s3, 589824
  v_max_f32 v75, 0x358637bd, v75
  v_mfma_f32_16x16x32_bf16 v[116:119], v[24:27], a[100:103], v[116:119]
  ds_read_b64_tr_b16 v[40:41], v19 offset:0
  v_add_f32 v74, v12, v74
  v_mfma_f32_16x16x32_bf16 v[116:119], v[28:31], a[116:119], v[116:119]
  ds_read_b64_tr_b16 v[42:43], v19 offset:1024
  v_add_f32 v75, v56, v75
  v_mfma_f32_16x16x32_bf16 v[120:123], v[24:27], a[104:107], v[120:123]
  ds_read_b64_tr_b16 v[44:45], v19 offset:4096
  v_mul_f32 v12, 0x3fb8aa3b, v76
  v_mfma_f32_16x16x32_bf16 v[120:123], v[28:31], a[120:123], v[120:123]
  ds_read_b64_tr_b16 v[46:47], v19 offset:5120
  v_mul_f32 v56, 0x3fb8aa3b, v77
  v_mfma_f32_16x16x32_bf16 v[124:127], v[24:27], a[108:111], v[124:127]
  v_exp_f32_e64 v12, v12 clamp
  v_mfma_f32_16x16x32_bf16 v[124:127], v[28:31], a[124:127], v[124:127]
  s_waitcnt lgkmcnt(4)
  v_exp_f32_e64 v56, v56 clamp
  v_mfma_f32_16x16x32_bf16 v[96:99], v[32:35], a[96:99], v[96:99]
  ds_read_b64_tr_b16 v[24:25], v19 offset:2048
  v_max_f32 v76, 0x358637bd, v76
  v_mfma_f32_16x16x32_bf16 v[96:99], v[36:39], a[112:115], v[96:99]
  ds_read_b64_tr_b16 v[26:27], v19 offset:3072
  v_max_f32 v77, 0x358637bd, v77
  v_mfma_f32_16x16x32_bf16 v[100:103], v[32:35], a[100:103], v[100:103]
  ds_read_b64_tr_b16 v[28:29], v19 offset:6144
  v_add_f32 v76, v12, v76
  v_mfma_f32_16x16x32_bf16 v[100:103], v[36:39], a[116:119], v[100:103]
  ds_read_b64_tr_b16 v[30:31], v19 offset:7168
  v_add_f32 v77, v56, v77
  v_mfma_f32_16x16x32_bf16 v[104:107], v[32:35], a[104:107], v[104:107]
  v_mul_f32 v12, 0x3fb8aa3b, v78
  v_mul_f32 v56, 0x3fb8aa3b, v79
  v_mfma_f32_16x16x32_bf16 v[104:107], v[36:39], a[120:123], v[104:107]
  v_exp_f32_e64 v12, v12 clamp
  v_mfma_f32_16x16x32_bf16 v[108:111], v[32:35], a[108:111], v[108:111]
  v_exp_f32_e64 v56, v56 clamp
  v_mfma_f32_16x16x32_bf16 v[108:111], v[36:39], a[124:127], v[108:111]
  s_waitcnt lgkmcnt(4)
  v_max_f32 v78, 0x358637bd, v78
  v_max_f32 v79, 0x358637bd, v79
  v_mfma_f32_16x16x32_bf16 v[192:195], v[40:43], a[96:99], v[192:195]
  buffer_load_dwordx4 v13, s[44:47], s58 offen lds
  v_mfma_f32_16x16x32_bf16 v[192:195], v[44:47], a[112:115], v[192:195]
  s_add_u32 m0, s63, 135168
  s_mul_i32 s58, s100, 589824
  v_add_f32 v78, v12, v78
  v_mfma_f32_16x16x32_bf16 v[196:199], v[40:43], a[100:103], v[196:199]
  ds_read_b64_tr_b16 v[32:33], v18 offset:8192
  v_add_f32 v79, v56, v79
  v_mfma_f32_16x16x32_bf16 v[196:199], v[44:47], a[116:119], v[196:199]
  ds_read_b64_tr_b16 v[34:35], v18 offset:9216
  v_cvt_pk_bf16_f32 v68, v68, v69
  v_mfma_f32_16x16x32_bf16 v[200:203], v[40:43], a[104:107], v[200:203]
  ds_read_b64_tr_b16 v[36:37], v18 offset:12288
  v_cvt_pk_bf16_f32 v69, v70, v71
  v_mfma_f32_16x16x32_bf16 v[200:203], v[44:47], a[120:123], v[200:203]
  ds_read_b64_tr_b16 v[38:39], v18 offset:13312
  v_permlane32_swap_b32 v145, v70
  v_mfma_f32_16x16x32_bf16 v[204:207], v[40:43], a[108:111], v[204:207]
  v_cvt_pk_bf16_f32 v72, v72, v73
  v_cvt_pk_bf16_f32 v73, v74, v75
  v_mfma_f32_16x16x32_bf16 v[204:207], v[44:47], a[124:127], v[204:207]
  s_waitcnt lgkmcnt(4)
  v_permlane32_swap_b32 v146, v74
  v_mfma_f32_16x16x32_bf16 v[208:211], v[24:27], a[96:99], v[208:211]
  ds_read_b64_tr_b16 v[40:41], v18 offset:10240
  v_cvt_pk_bf16_f32 v76, v76, v77
  v_mfma_f32_16x16x32_bf16 v[208:211], v[28:31], a[112:115], v[208:211]
  ds_read_b64_tr_b16 v[42:43], v18 offset:11264
  v_cvt_pk_bf16_f32 v77, v78, v79
  v_mfma_f32_16x16x32_bf16 v[212:215], v[24:27], a[100:103], v[212:215]
  ds_read_b64_tr_b16 v[44:45], v18 offset:14336
  v_permlane32_swap_b32 v147, v78
  v_mfma_f32_16x16x32_bf16 v[212:215], v[28:31], a[116:119], v[212:215]
  ds_read_b64_tr_b16 v[46:47], v18 offset:15360
  v_mov_b32 v67, 0
  v_mfma_f32_16x16x32_bf16 v[216:219], v[24:27], a[104:107], v[216:219]
  v_cndmask_b32_e64 v66, 0, v66, s[80:81]
  v_mov_b32 v71, 0
  v_mfma_f32_16x16x32_bf16 v[216:219], v[28:31], a[120:123], v[216:219]
  v_cndmask_b32_e64 v70, 0, v70, s[80:81]
  v_mfma_f32_16x16x32_bf16 v[220:223], v[24:27], a[108:111], v[220:223]
  v_mov_b32 v75, 0
  v_cndmask_b32_e64 v74, 0, v74, s[80:81]
  v_mfma_f32_16x16x32_bf16 v[220:223], v[28:31], a[124:127], v[220:223]
  s_waitcnt lgkmcnt(4)
  v_mov_b32 v79, 0
  v_mfma_f32_16x16x32_bf16 v[112:115], v[32:35], a[128:131], v[112:115]
  buffer_load_dwordx4 v13, s[44:47], s58 offen lds
  v_mfma_f32_16x16x32_bf16 v[112:115], v[36:39], a[144:147], v[112:115]
  s_add_u32 m0, s63, 139264
  s_mul_i32 s58, s101, 589824
  v_cndmask_b32_e64 v78, 0, v78, s[80:81]
  v_mfma_f32_16x16x32_bf16 v[116:119], v[32:35], a[132:135], v[116:119]
  ds_read_b64_tr_b16 v[24:25], v19 offset:8192
  v_mfma_f32_16x16x32_bf16 v[116:119], v[36:39], a[148:151], v[116:119]
  ds_read_b64_tr_b16 v[26:27], v19 offset:9216
  v_mfma_f32_16x16x32_bf16 v[120:123], v[32:35], a[136:139], v[120:123]
  ds_read_b64_tr_b16 v[28:29], v19 offset:12288
  v_mfma_f32_16x16x32_bf16 v[120:123], v[36:39], a[152:155], v[120:123]
  ds_read_b64_tr_b16 v[30:31], v19 offset:13312
  v_mfma_f32_16x16x32_bf16 v[124:127], v[32:35], a[140:143], v[124:127]
  v_mfma_f32_16x16x32_bf16 v[124:127], v[36:39], a[156:159], v[124:127]
  s_waitcnt lgkmcnt(4)
  v_mfma_f32_16x16x32_bf16 v[96:99], v[40:43], a[128:131], v[96:99]
  ds_read_b64_tr_b16 v[32:33], v19 offset:10240
  v_mfma_f32_16x16x32_bf16 v[96:99], v[44:47], a[144:147], v[96:99]
  ds_read_b64_tr_b16 v[34:35], v19 offset:11264
  v_mfma_f32_16x16x32_bf16 v[100:103], v[40:43], a[132:135], v[100:103]
  ds_read_b64_tr_b16 v[36:37], v19 offset:14336
  v_mfma_f32_16x16x32_bf16 v[100:103], v[44:47], a[148:151], v[100:103]
  ds_read_b64_tr_b16 v[38:39], v19 offset:15360
  v_mfma_f32_16x16x32_bf16 v[104:107], v[40:43], a[136:139], v[104:107]
  buffer_load_dword v55, v59, s[40:43], 0 offen sc1
  v_mfma_f32_16x16x32_bf16 v[104:107], v[44:47], a[152:155], v[104:107]
  v_mfma_f32_16x16x32_bf16 v[108:111], v[40:43], a[140:143], v[108:111]
  buffer_load_dwordx4 v13, s[44:47], s58 offen lds
  v_mfma_f32_16x16x32_bf16 v[108:111], v[44:47], a[156:159], v[108:111]
  s_waitcnt lgkmcnt(4)
  s_add_u32 m0, s63, 143360
  s_mul_i32 s58, s97, 589824
  v_mfma_f32_16x16x32_bf16 v[192:195], v[24:27], a[128:131], v[192:195]
  ds_read_b64_tr_b16 v[40:41], v18 offset:16384
  v_mfma_f32_16x16x32_bf16 v[192:195], v[28:31], a[144:147], v[192:195]
  ds_read_b64_tr_b16 v[42:43], v18 offset:17408
  v_mfma_f32_16x16x32_bf16 v[196:199], v[24:27], a[132:135], v[196:199]
  ds_read_b64_tr_b16 v[44:45], v18 offset:20480
  v_mfma_f32_16x16x32_bf16 v[196:199], v[28:31], a[148:151], v[196:199]
  ds_read_b64_tr_b16 v[46:47], v18 offset:21504
  v_mfma_f32_16x16x32_bf16 v[200:203], v[24:27], a[136:139], v[200:203]
  v_mfma_f32_16x16x32_bf16 v[200:203], v[28:31], a[152:155], v[200:203]
  v_mfma_f32_16x16x32_bf16 v[204:207], v[24:27], a[140:143], v[204:207]
  v_mfma_f32_16x16x32_bf16 v[204:207], v[28:31], a[156:159], v[204:207]
  s_waitcnt lgkmcnt(4)
  v_mfma_f32_16x16x32_bf16 v[208:211], v[32:35], a[128:131], v[208:211]
  ds_read_b64_tr_b16 v[24:25], v18 offset:18432
  v_mfma_f32_16x16x32_bf16 v[208:211], v[36:39], a[144:147], v[208:211]
  ds_read_b64_tr_b16 v[26:27], v18 offset:19456
  v_mfma_f32_16x16x32_bf16 v[212:215], v[32:35], a[132:135], v[212:215]
  ds_read_b64_tr_b16 v[28:29], v18 offset:22528
  v_mfma_f32_16x16x32_bf16 v[212:215], v[36:39], a[148:151], v[212:215]
  ds_read_b64_tr_b16 v[30:31], v18 offset:23552
  v_subrev_u32 v18, 24576, v18
  v_mfma_f32_16x16x32_bf16 v[216:219], v[32:35], a[136:139], v[216:219]
  v_mfma_f32_16x16x32_bf16 v[216:219], v[36:39], a[152:155], v[216:219]
  v_mfma_f32_16x16x32_bf16 v[220:223], v[32:35], a[140:143], v[220:223]
  v_mfma_f32_16x16x32_bf16 v[220:223], v[36:39], a[156:159], v[220:223]
  s_waitcnt lgkmcnt(4)
  v_mfma_f32_16x16x32_bf16 v[112:115], v[40:43], a[160:163], v[112:115]
  buffer_load_dwordx4 v13, s[44:47], s58 offen lds
  v_mfma_f32_16x16x32_bf16 v[112:115], v[44:47], a[176:179], v[112:115]
  ds_read_b64_tr_b16 v[32:33], v19 offset:16384
  v_mfma_f32_16x16x32_bf16 v[116:119], v[40:43], a[164:167], v[116:119]
  s_mov_b32 s59, 16384
  ds_read_b64_tr_b16 v[34:35], v19 offset:17408
  v_mfma_f32_16x16x32_bf16 v[116:119], v[44:47], a[180:183], v[116:119]
  ds_read_b64_tr_b16 v[36:37], v19 offset:20480
  v_mfma_f32_16x16x32_bf16 v[120:123], v[40:43], a[168:171], v[120:123]
  ds_read_b64_tr_b16 v[38:39], v19 offset:21504
  v_mfma_f32_16x16x32_bf16 v[120:123], v[44:47], a[184:187], v[120:123]
  v_mfma_f32_16x16x32_bf16 v[124:127], v[40:43], a[172:175], v[124:127]
  v_mfma_f32_16x16x32_bf16 v[124:127], v[44:47], a[188:191], v[124:127]
  s_waitcnt lgkmcnt(4)
  v_mfma_f32_16x16x32_bf16 v[96:99], v[24:27], a[160:163], v[96:99]
  ds_read_b64_tr_b16 v[40:41], v19 offset:18432
  v_mfma_f32_16x16x32_bf16 v[96:99], v[28:31], a[176:179], v[96:99]
  ds_read_b64_tr_b16 v[42:43], v19 offset:19456
  v_mfma_f32_16x16x32_bf16 v[100:103], v[24:27], a[164:167], v[100:103]
  ds_read_b64_tr_b16 v[44:45], v19 offset:22528
  v_mfma_f32_16x16x32_bf16 v[100:103], v[28:31], a[180:183], v[100:103]
  ds_read_b64_tr_b16 v[46:47], v19 offset:23552
  v_subrev_u32 v19, 24576, v19
  v_mfma_f32_16x16x32_bf16 v[104:107], v[24:27], a[168:171], v[104:107]
  v_mfma_f32_16x16x32_bf16 v[104:107], v[28:31], a[184:187], v[104:107]
  v_mfma_f32_16x16x32_bf16 v[108:111], v[24:27], a[172:175], v[108:111]
  v_mfma_f32_16x16x32_bf16 v[108:111], v[28:31], a[188:191], v[108:111]
  s_waitcnt lgkmcnt(4) vmcnt(11)
  s_barrier
  v_mfma_f32_16x16x32_bf16 v[192:195], v[32:35], a[160:163], v[192:195]
  buffer_store_dwordx4 v[128:131], v11, s[40:43], s59 offen sc1
  v_mfma_f32_16x16x32_bf16 v[192:195], v[36:39], a[176:179], v[192:195]
  ds_read_b64_tr_b16 v[24:25], v18 offset:0
  v_mfma_f32_16x16x32_bf16 v[196:199], v[32:35], a[164:167], v[196:199]
  ds_read_b64_tr_b16 v[26:27], v18 offset:1024
  v_mfma_f32_16x16x32_bf16 v[196:199], v[36:39], a[180:183], v[196:199]
  ds_read_b64_tr_b16 v[28:29], v18 offset:4096
  v_mfma_f32_16x16x32_bf16 v[200:203], v[32:35], a[168:171], v[200:203]
  ds_read_b64_tr_b16 v[30:31], v18 offset:5120
  v_mfma_f32_16x16x32_bf16 v[200:203], v[36:39], a[184:187], v[200:203]
  v_mfma_f32_16x16x32_bf16 v[204:207], v[32:35], a[172:175], v[204:207]
  v_mfma_f32_16x16x32_bf16 v[204:207], v[36:39], a[188:191], v[204:207]
  s_waitcnt lgkmcnt(4)
  v_mfma_f32_16x16x32_bf16 v[208:211], v[40:43], a[160:163], v[208:211]
  ds_read_b64_tr_b16 v[32:33], v18 offset:2048
  v_mfma_f32_16x16x32_bf16 v[208:211], v[44:47], a[176:179], v[208:211]
  ds_read_b64_tr_b16 v[34:35], v18 offset:3072
  v_mfma_f32_16x16x32_bf16 v[212:215], v[40:43], a[164:167], v[212:215]
  ds_read_b64_tr_b16 v[36:37], v18 offset:6144
  v_mfma_f32_16x16x32_bf16 v[212:215], v[44:47], a[180:183], v[212:215]
  ds_read_b64_tr_b16 v[38:39], v18 offset:7168
  v_mfma_f32_16x16x32_bf16 v[216:219], v[40:43], a[168:171], v[216:219]
  v_mfma_f32_16x16x32_bf16 v[216:219], v[44:47], a[184:187], v[216:219]
  v_mfma_f32_16x16x32_bf16 v[220:223], v[40:43], a[172:175], v[220:223]
  v_mfma_f32_16x16x32_bf16 v[220:223], v[44:47], a[188:191], v[220:223]
  s_waitcnt lgkmcnt(4)
  v_mfma_f32_16x16x32_bf16 v[112:115], v[24:27], a[192:195], v[112:115]
  ds_read_b64_tr_b16 v[40:41], v19 offset:0
  v_mfma_f32_16x16x32_bf16 v[112:115], v[28:31], a[208:211], v[112:115]
  s_mov_b32 s59, 57344
  buffer_store_dwordx4 v[132:135], v11, s[40:43], s59 offen sc1
  s_waitcnt vmcnt(4)
  v_mfma_f32_16x16x32_bf16 v[116:119], v[24:27], a[196:199], v[116:119]
  v_subrev_u32 v55, s85, v55
  v_add_u32 v55, -2, v55
  v_mfma_f32_16x16x32_bf16 v[116:119], v[28:31], a[212:215], v[116:119]
  ds_read_b64_tr_b16 v[42:43], v19 offset:1024
  v_cmp_gt_u32 s[22:23], 6, v55
  v_mfma_f32_16x16x32_bf16 v[120:123], v[24:27], a[200:203], v[120:123]
  s_and_b32 s29, s22, 0xff
  s_cmp_eq_u32 s29, 0xff
  s_cbranch_scc0 L_slow_12
L_ok_11:
  v_mfma_f32_16x16x32_bf16 v[120:123], v[28:31], a[216:219], v[120:123]
  s_add_u32 s59, s91, 21495808
  ds_read_b64_tr_b16 v[44:45], v19 offset:4096
  v_mfma_f32_16x16x32_bf16 v[124:127], v[24:27], a[204:207], v[124:127]
  ds_read_b64_tr_b16 v[46:47], v19 offset:5120
  v_mfma_f32_16x16x32_bf16 v[124:127], v[28:31], a[220:223], v[124:127]
  s_waitcnt lgkmcnt(4)
  v_mfma_f32_16x16x32_bf16 v[96:99], v[32:35], a[192:195], v[96:99]
  buffer_load_dwordx4 v[80:83], v15, s[40:43], s59 offen sc1
  v_mfma_f32_16x16x32_bf16 v[96:99], v[36:39], a[208:211], v[96:99]
  s_add_u32 s59, s91, 21499904
  ds_read_b64_tr_b16 v[24:25], v19 offset:2048
  v_mfma_f32_16x16x32_bf16 v[100:103], v[32:35], a[196:199], v[100:103]
  ds_read_b64_tr_b16 v[26:27], v19 offset:3072
  v_mfma_f32_16x16x32_bf16 v[100:103], v[36:39], a[212:215], v[100:103]
  ds_read_b64_tr_b16 v[28:29], v19 offset:6144
  v_mfma_f32_16x16x32_bf16 v[104:107], v[32:35], a[200:203], v[104:107]
  ds_read_b64_tr_b16 v[30:31], v19 offset:7168
  v_mfma_f32_16x16x32_bf16 v[104:107], v[36:39], a[216:219], v[104:107]
  v_mfma_f32_16x16x32_bf16 v[108:111], v[32:35], a[204:207], v[108:111]
  buffer_load_dwordx4 v[84:87], v15, s[40:43], s59 offen sc1
  v_mfma_f32_16x16x32_bf16 v[108:111], v[36:39], a[220:223], v[108:111]
  s_waitcnt lgkmcnt(4)
  s_add_u32 s59, s91, 21504000
  v_mfma_f32_16x16x32_bf16 v[192:195], v[40:43], a[192:195], v[192:195]
  ds_read_b64_tr_b16 v[32:33], v18 offset:8192
  v_mfma_f32_16x16x32_bf16 v[192:195], v[44:47], a[208:211], v[192:195]
  ds_read_b64_tr_b16 v[34:35], v18 offset:9216
  v_mfma_f32_16x16x32_bf16 v[196:199], v[40:43], a[196:199], v[196:199]
  ds_read_b64_tr_b16 v[36:37], v18 offset:12288
  v_mfma_f32_16x16x32_bf16 v[196:199], v[44:47], a[212:215], v[196:199]
  ds_read_b64_tr_b16 v[38:39], v18 offset:13312
  v_mfma_f32_16x16x32_bf16 v[200:203], v[40:43], a[200:203], v[200:203]
  buffer_load_dwordx4 v[88:91], v15, s[40:43], s59 offen sc1
  v_mfma_f32_16x16x32_bf16 v[200:203], v[44:47], a[216:219], v[200:203]
  s_add_u32 s59, s91, 21508096
  v_mfma_f32_16x16x32_bf16 v[204:207], v[40:43], a[204:207], v[204:207]
  v_mfma_f32_16x16x32_bf16 v[204:207], v[44:47], a[220:223], v[204:207]
  s_waitcnt lgkmcnt(4)
  v_mfma_f32_16x16x32_bf16 v[208:211], v[24:27], a[192:195], v[208:211]
  ds_read_b64_tr_b16 v[40:41], v18 offset:10240
  v_mfma_f32_16x16x32_bf16 v[208:211], v[28:31], a[208:211], v[208:211]
  s_mov_b32 s59, 98304
  ds_read_b64_tr_b16 v[42:43], v18 offset:11264
  v_mfma_f32_16x16x32_bf16 v[212:215], v[24:27], a[196:199], v[212:215]
  buffer_store_dwordx4 v[136:139], v11, s[40:43], s59 offen sc1
  v_mfma_f32_16x16x32_bf16 v[212:215], v[28:31], a[212:215], v[212:215]
  s_add_u32 s59, s91, 21508096
  ds_read_b64_tr_b16 v[44:45], v18 offset:14336
  v_mfma_f32_16x16x32_bf16 v[216:219], v[24:27], a[200:203], v[216:219]
  ds_read_b64_tr_b16 v[46:47], v18 offset:15360
  v_mfma_f32_16x16x32_bf16 v[216:219], v[28:31], a[216:219], v[216:219]
  v_mfma_f32_16x16x32_bf16 v[220:223], v[24:27], a[204:207], v[220:223]
  v_mfma_f32_16x16x32_bf16 v[220:223], v[28:31], a[220:223], v[220:223]
  s_waitcnt lgkmcnt(4)
  v_mfma_f32_16x16x32_bf16 v[112:115], v[32:35], a[224:227], v[112:115]
  ds_read_b64_tr_b16 v[24:25], v19 offset:8192
  v_mfma_f32_16x16x32_bf16 v[112:115], v[36:39], a[240:243], v[112:115]
  ds_read_b64_tr_b16 v[26:27], v19 offset:9216
  v_mfma_f32_16x16x32_bf16 v[116:119], v[32:35], a[228:231], v[116:119]
  ds_read_b64_tr_b16 v[28:29], v19 offset:12288
  v_mfma_f32_16x16x32_bf16 v[116:119], v[36:39], a[244:247], v[116:119]
  ds_read_b64_tr_b16 v[30:31], v19 offset:13312
  v_mfma_f32_16x16x32_bf16 v[120:123], v[32:35], a[232:235], v[120:123]
  v_mfma_f32_16x16x32_bf16 v[120:123], v[36:39], a[248:251], v[120:123]
  v_mfma_f32_16x16x32_bf16 v[124:127], v[32:35], a[236:239], v[124:127]
  v_mfma_f32_16x16x32_bf16 v[124:127], v[36:39], a[252:255], v[124:127]
  s_waitcnt lgkmcnt(4)
  v_mfma_f32_16x16x32_bf16 v[96:99], v[40:43], a[224:227], v[96:99]
  ds_read_b64_tr_b16 v[32:33], v19 offset:10240
  v_mfma_f32_16x16x32_bf16 v[96:99], v[44:47], a[240:243], v[96:99]
  buffer_load_dwordx4 v[92:95], v15, s[40:43], s59 offen sc1
  v_mfma_f32_16x16x32_bf16 v[100:103], v[40:43], a[228:231], v[100:103]
  s_add_u32 s59, s91, 21512192
  ds_read_b64_tr_b16 v[34:35], v19 offset:11264
  v_mfma_f32_16x16x32_bf16 v[100:103], v[44:47], a[244:247], v[100:103]
  ds_read_b64_tr_b16 v[36:37], v19 offset:14336
  v_mfma_f32_16x16x32_bf16 v[104:107], v[40:43], a[232:235], v[104:107]
  ds_read_b64_tr_b16 v[38:39], v19 offset:15360
  v_mfma_f32_16x16x32_bf16 v[104:107], v[44:47], a[248:251], v[104:107]
  v_mfma_f32_16x16x32_bf16 v[108:111], v[40:43], a[236:239], v[108:111]
  buffer_load_dwordx4 v[160:163], v15, s[40:43], s59 offen sc1
  v_mfma_f32_16x16x32_bf16 v[108:111], v[44:47], a[252:255], v[108:111]
  s_waitcnt lgkmcnt(4)
  s_add_u32 s59, s91, 21516288
  v_mfma_f32_16x16x32_bf16 v[192:195], v[24:27], a[224:227], v[192:195]
  ds_read_b64_tr_b16 v[40:41], v18 offset:16384
  v_mfma_f32_16x16x32_bf16 v[192:195], v[28:31], a[240:243], v[192:195]
  ds_read_b64_tr_b16 v[42:43], v18 offset:17408
  v_mfma_f32_16x16x32_bf16 v[196:199], v[24:27], a[228:231], v[196:199]
  s_mov_b32 s59, 139264
  ds_read_b64_tr_b16 v[44:45], v18 offset:20480
  v_mfma_f32_16x16x32_bf16 v[196:199], v[28:31], a[244:247], v[196:199]
  ds_read_b64_tr_b16 v[46:47], v18 offset:21504
  v_mfma_f32_16x16x32_bf16 v[200:203], v[24:27], a[232:235], v[200:203]
  buffer_store_dwordx4 v[140:143], v11, s[40:43], s59 offen sc1
  v_mfma_f32_16x16x32_bf16 v[200:203], v[28:31], a[248:251], v[200:203]
  s_add_u32 s59, s91, 21516288
  s_lshl_b32 s83, s51, 7
  s_lshl_b32 s84, s52, 3
  v_mfma_f32_16x16x32_bf16 v[204:207], v[24:27], a[236:239], v[204:207]
  s_add_u32 s83, s83, s84
  s_lshl_b32 s84, s48, 1
  s_add_u32 s83, s83, s84
  v_mfma_f32_16x16x32_bf16 v[204:207], v[28:31], a[252:255], v[204:207]
  s_waitcnt lgkmcnt(4)
  s_mul_i32 s83, s83, 40960
  v_add_u32 v12, s83, v15
  v_mfma_f32_16x16x32_bf16 v[208:211], v[32:35], a[224:227], v[208:211]
  ds_read_b64_tr_b16 v[24:25], v18 offset:18432
  v_mfma_f32_16x16x32_bf16 v[208:211], v[36:39], a[240:243], v[208:211]
  ds_read_b64_tr_b16 v[26:27], v18 offset:19456
  v_mfma_f32_16x16x32_bf16 v[212:215], v[32:35], a[228:231], v[212:215]
  ds_read_b64_tr_b16 v[28:29], v18 offset:22528
  v_mfma_f32_16x16x32_bf16 v[212:215], v[36:39], a[244:247], v[212:215]
  ds_read_b64_tr_b16 v[30:31], v18 offset:23552
  v_mfma_f32_16x16x32_bf16 v[216:219], v[32:35], a[232:235], v[216:219]
  v_mfma_f32_16x16x32_bf16 v[216:219], v[36:39], a[248:251], v[216:219]
  v_mfma_f32_16x16x32_bf16 v[220:223], v[32:35], a[236:239], v[220:223]
  v_mfma_f32_16x16x32_bf16 v[220:223], v[36:39], a[252:255], v[220:223]
  s_waitcnt lgkmcnt(4)
  v_mfma_f32_16x16x32_bf16 v[112:115], v[40:43], v[224:227], v[112:115]
  ds_read_b64_tr_b16 v[32:33], v19 offset:16384
  v_mfma_f32_16x16x32_bf16 v[112:115], v[44:47], v[240:243], v[112:115]
  ds_read_b64_tr_b16 v[34:35], v19 offset:17408
  v_mfma_f32_16x16x32_bf16 v[116:119], v[40:43], v[228:231], v[116:119]
  ds_read_b64_tr_b16 v[36:37], v19 offset:20480
  v_mfma_f32_16x16x32_bf16 v[116:119], v[44:47], v[244:247], v[116:119]
  buffer_load_dwordx4 v[164:167], v15, s[40:43], s59 offen sc1
  v_mfma_f32_16x16x32_bf16 v[120:123], v[40:43], v[232:235], v[120:123]
  s_add_u32 s59, s91, 21520384
  ds_read_b64_tr_b16 v[38:39], v19 offset:21504
  v_mfma_f32_16x16x32_bf16 v[120:123], v[44:47], v[248:251], v[120:123]
  v_mfma_f32_16x16x32_bf16 v[124:127], v[40:43], v[236:239], v[124:127]
  v_mfma_f32_16x16x32_bf16 v[124:127], v[44:47], v[252:255], v[124:127]
  s_waitcnt lgkmcnt(4)
  v_mfma_f32_16x16x32_bf16 v[96:99], v[24:27], v[224:227], v[96:99]
  ds_read_b64_tr_b16 v[40:41], v19 offset:18432
  v_mfma_f32_16x16x32_bf16 v[96:99], v[28:31], v[240:243], v[96:99]
  buffer_load_dwordx4 v[168:171], v15, s[40:43], s59 offen sc1
  v_mfma_f32_16x16x32_bf16 v[100:103], v[24:27], v[228:231], v[100:103]
  s_add_u32 s59, s91, 21524480
  ds_read_b64_tr_b16 v[42:43], v19 offset:19456
  v_mfma_f32_16x16x32_bf16 v[100:103], v[28:31], v[244:247], v[100:103]
  ds_read_b64_tr_b16 v[44:45], v19 offset:22528
  v_mfma_f32_16x16x32_bf16 v[104:107], v[24:27], v[232:235], v[104:107]
  ds_read_b64_tr_b16 v[46:47], v19 offset:23552
  v_mfma_f32_16x16x32_bf16 v[104:107], v[28:31], v[248:251], v[104:107]
  v_mfma_f32_16x16x32_bf16 v[108:111], v[24:27], v[236:239], v[108:111]
  v_mfma_f32_16x16x32_bf16 v[108:111], v[28:31], v[252:255], v[108:111]
  s_waitcnt lgkmcnt(4)
  s_waitcnt lgkmcnt(0) vmcnt(11)
  s_barrier
  v_mfma_f32_16x16x32_bf16 v[192:195], v[32:35], v[224:227], v[192:195]
  buffer_load_dwordx4 v[172:175], v15, s[40:43], s59 offen sc1
  v_mfma_f32_16x16x32_bf16 v[192:195], v[36:39], v[240:243], v[192:195]
  s_add_u32 m0, s64, 73728
  s_mov_b32 s56, s67
  v_mfma_f32_16x16x32_bf16 v[196:199], v[32:35], v[228:231], v[196:199]
  ds_read_b64_tr_b16 v[24:25], v16 offset:0
  v_mfma_f32_16x16x32_bf16 v[196:199], v[36:39], v[244:247], v[196:199]
  ds_read_b64_tr_b16 v[26:27], v16 offset:512
  v_mfma_f32_16x16x32_bf16 v[200:203], v[32:35], v[232:235], v[200:203]
  buffer_load_dwordx4 v1, s[24:27], s56 offen lds
  v_mfma_f32_16x16x32_bf16 v[200:203], v[36:39], v[248:251], v[200:203]
  ds_read_b64_tr_b16 v[28:29], v16 offset:2048
  v_mfma_f32_16x16x32_bf16 v[204:207], v[32:35], v[236:239], v[204:207]
  ds_read_b64_tr_b16 v[30:31], v16 offset:2560
  v_mfma_f32_16x16x32_bf16 v[204:207], v[36:39], v[252:255], v[204:207]
  s_waitcnt lgkmcnt(4)
  v_mfma_f32_16x16x32_bf16 v[208:211], v[40:43], v[224:227], v[208:211]
  ds_read_b64_tr_b16 v[32:33], v16 offset:1024
  v_mfma_f32_16x16x32_bf16 v[208:211], v[44:47], v[240:243], v[208:211]
  buffer_load_dwordx4 v2, s[24:27], s56 offen offset:1024 lds
  v_mfma_f32_16x16x32_bf16 v[212:215], v[40:43], v[228:231], v[212:215]
  ds_read_b64_tr_b16 v[34:35], v16 offset:1536
  v_mfma_f32_16x16x32_bf16 v[212:215], v[44:47], v[244:247], v[212:215]
  ds_read_b64_tr_b16 v[36:37], v16 offset:3072
  buffer_load_dwordx4 v3, s[24:27], s56 offen offset:2048 lds
  buffer_load_dwordx4 v4, s[24:27], s56 offen offset:3072 lds
  s_add_u32 m0, s64, 77824
  s_nop 0
  buffer_load_dwordx4 v5, s[24:27], s56 offen lds
  buffer_load_dwordx4 v6, s[24:27], s56 offen offset:1024 lds
  buffer_load_dwordx4 v7, s[24:27], s56 offen offset:2048 lds
  buffer_load_dwordx4 v8, s[24:27], s56 offen offset:3072 lds
  s_add_u32 m0, s64, 81920
  s_nop 0
  buffer_load_dwordx4 v9, s[24:27], s56 offen lds
  s_waitcnt vmcnt(9)
  v_mfma_f32_16x16x32_bf16 v[216:219], v[40:43], v[232:235], v[216:219]
  ds_read_b64_tr_b16 v[38:39], v16 offset:3584
  v_add_f32 v80, v80, v84
  v_mfma_f32_16x16x32_bf16 v[216:219], v[44:47], v[248:251], v[216:219]
  v_add_f32 v81, v81, v85
  v_add_f32 v82, v82, v86
  v_mfma_f32_16x16x32_bf16 v[220:223], v[40:43], v[236:239], v[220:223]
  v_add_f32 v83, v83, v87
  v_mfma_f32_16x16x32_bf16 v[220:223], v[44:47], v[252:255], v[220:223]
  s_waitcnt lgkmcnt(4)
  v_add_f32 v80, v80, v88
  v_add_f32 v81, v81, v89
  v_mfma_f32_16x16x32_bf16 v[144:147], v[24:27], a[0:3], 0
  ds_read_b64_tr_b16 v[40:41], v16 offset:4096
  v_add_f32 v82, v82, v90
  v_mfma_f32_16x16x32_bf16 v[144:147], v[28:31], a[16:19], v[144:147]
  ds_read_b64_tr_b16 v[42:43], v16 offset:4608
  v_add_f32 v83, v83, v91
  v_mfma_f32_16x16x32_bf16 v[148:151], v[24:27], a[4:7], 0
  v_mul_f32 v112, v112, v96
  v_mul_f32 v113, v113, v97
  v_mfma_f32_16x16x32_bf16 v[148:151], v[28:31], a[20:23], v[148:151]
  ds_read_b64_tr_b16 v[44:45], v16 offset:6144
  v_mul_f32 v114, v114, v98
  v_mfma_f32_16x16x32_bf16 v[152:155], v[24:27], a[8:11], 0
  v_mul_f32 v115, v115, v99
  v_cvt_pk_bf16_f32 v96, v112, v113
  v_mfma_f32_16x16x32_bf16 v[152:155], v[28:31], a[24:27], v[152:155]
  ds_read_b64_tr_b16 v[46:47], v16 offset:6656
  v_cvt_pk_bf16_f32 v97, v114, v115
  v_mfma_f32_16x16x32_bf16 v[156:159], v[24:27], a[12:15], 0
  v_mul_f32 v116, v116, v100
  v_mul_f32 v117, v117, v101
  v_mfma_f32_16x16x32_bf16 v[156:159], v[28:31], a[28:31], v[156:159]
  s_waitcnt lgkmcnt(4)
  v_mul_f32 v118, v118, v102
  v_mfma_f32_16x16x32_bf16 v[128:131], v[32:35], a[0:3], 0
  v_mul_f32 v119, v119, v103
  v_cvt_pk_bf16_f32 v100, v116, v117
  v_mfma_f32_16x16x32_bf16 v[128:131], v[36:39], a[16:19], v[128:131]
  ds_read_b64_tr_b16 v[24:25], v16 offset:5120
  v_cvt_pk_bf16_f32 v101, v118, v119
  v_mfma_f32_16x16x32_bf16 v[132:135], v[32:35], a[4:7], 0
  v_mul_f32 v120, v120, v104
  v_mul_f32 v121, v121, v105
  v_mfma_f32_16x16x32_bf16 v[132:135], v[36:39], a[20:23], v[132:135]
  ds_read_b64_tr_b16 v[26:27], v16 offset:5632
  v_mul_f32 v122, v122, v106
  v_mfma_f32_16x16x32_bf16 v[136:139], v[32:35], a[8:11], 0
  v_mul_f32 v123, v123, v107
  v_cvt_pk_bf16_f32 v104, v120, v121
  v_mfma_f32_16x16x32_bf16 v[136:139], v[36:39], a[24:27], v[136:139]
  ds_read_b64_tr_b16 v[28:29], v16 offset:7168
  v_cvt_pk_bf16_f32 v105, v122, v123
  v_mfma_f32_16x16x32_bf16 v[140:143], v[32:35], a[12:15], 0
  v_mul_f32 v124, v124, v108
  v_mul_f32 v125, v125, v109
  v_mfma_f32_16x16x32_bf16 v[140:143], v[36:39], a[28:31], v[140:143]
  s_waitcnt lgkmcnt(3)
  ds_read_b64_tr_b16 v[30:31], v16 offset:7680
  v_mul_f32 v126, v126, v110
  v_mfma_f32_16x16x32_bf16 v[144:147], v[40:43], a[32:35], v[144:147]
  v_mul_f32 v127, v127, v111
  v_cvt_pk_bf16_f32 v108, v124, v125
  v_mfma_f32_16x16x32_bf16 v[144:147], v[44:47], a[48:51], v[144:147]
  s_add_u32 s90, s69, 0
  ds_read_b64_tr_b16 v[32:33], v16 offset:8192
  v_cvt_pk_bf16_f32 v109, v126, v127
  v_mfma_f32_16x16x32_bf16 v[148:151], v[40:43], a[36:39], v[148:151]
  buffer_load_dwordx4 a[0:3], v12, s[40:43], s90 offen offset:0 sc1
  v_mfma_f32_16x16x32_bf16 v[148:151], v[44:47], a[52:55], v[148:151]
  buffer_load_dwordx4 a[4:7], v12, s[40:43], s90 offen offset:1024 sc1
  v_mfma_f32_16x16x32_bf16 v[152:155], v[40:43], a[40:43], v[152:155]
  v_mul_f32 v192, v192, v208
  v_mul_f32 v193, v193, v209
  v_mfma_f32_16x16x32_bf16 v[152:155], v[44:47], a[56:59], v[152:155]
  ds_read_b64_tr_b16 v[34:35], v16 offset:8704
  v_mul_f32 v194, v194, v210
  v_mfma_f32_16x16x32_bf16 v[156:159], v[40:43], a[44:47], v[156:159]
  ds_read_b64_tr_b16 v[36:37], v16 offset:10240
  buffer_load_dwordx4 a[8:11], v12, s[40:43], s90 offen offset:2048 sc1
  v_mfma_f32_16x16x32_bf16 v[156:159], v[44:47], a[60:63], v[156:159]
  s_waitcnt lgkmcnt(3)
  ds_read_b64_tr_b16 v[38:39], v16 offset:10752
  v_mul_f32 v195, v195, v211
  v_mfma_f32_16x16x32_bf16 v[128:131], v[24:27], a[32:35], v[128:131]
  v_cvt_pk_bf16_f32 v98, v192, v193
  v_cvt_pk_bf16_f32 v99, v194, v195
  v_mfma_f32_16x16x32_bf16 v[128:131], v[28:31], a[48:51], v[128:131]
  ds_read_b64_tr_b16 v[40:41], v16 offset:9216
  v_mul_f32 v196, v196, v212
  v_mfma_f32_16x16x32_bf16 v[132:135], v[24:27], a[36:39], v[132:135]
  buffer_load_dwordx4 a[12:15], v12, s[40:43], s90 offen offset:3072 sc1
  v_mfma_f32_16x16x32_bf16 v[132:135], v[28:31], a[52:55], v[132:135]
  s_mov_b32 s59, 24576
  v_mul_f32 v197, v197, v213
  v_mul_f32 v198, v198, v214
  v_mfma_f32_16x16x32_bf16 v[136:139], v[24:27], a[40:43], v[136:139]
  ds_read_b64_tr_b16 v[42:43], v16 offset:9728
  v_mul_f32 v199, v199, v215
  v_mfma_f32_16x16x32_bf16 v[136:139], v[28:31], a[56:59], v[136:139]
  v_cvt_pk_bf16_f32 v102, v196, v197
  v_cvt_pk_bf16_f32 v103, v198, v199
  v_mfma_f32_16x16x32_bf16 v[140:143], v[24:27], a[44:47], v[140:143]
  ds_read_b64_tr_b16 v[44:45], v16 offset:11264
  buffer_store_dwordx4 v[96:99], v11, s[40:43], s59 offen sc1
  v_mfma_f32_16x16x32_bf16 v[140:143], v[28:31], a[60:63], v[140:143]
  s_waitcnt lgkmcnt(3)
  ds_read_b64_tr_b16 v[46:47], v16 offset:11776
  v_mul_f32 v200, v200, v216
  v_mfma_f32_16x16x32_bf16 v[144:147], v[32:35], a[64:67], v[144:147]
  s_add_u32 s90, s69, 40960
  v_mul_f32 v201, v201, v217
  v_mul_f32 v202, v202, v218
  v_mfma_f32_16x16x32_bf16 v[144:147], v[36:39], a[80:83], v[144:147]
  ds_read_b64_tr_b16 v[24:25], v16 offset:12288
  v_mul_f32 v203, v203, v219
  v_mfma_f32_16x16x32_bf16 v[148:151], v[32:35], a[68:71], v[148:151]
  v_add_f32 v80, v80, v92
  v_add_f32 v81, v81, v93
  v_add_f32 v82, v82, v94
  v_add_f32 v83, v83, v95
  v_add_f32 v80, v80, v160
  v_add_f32 v81, v81, v161
  v_add_f32 v82, v82, v162
  v_add_f32 v83, v83, v163
  v_add_f32 v80, v80, v164
  v_add_f32 v81, v81, v165
  v_add_f32 v82, v82, v166
  v_add_f32 v83, v83, v167
  v_add_f32 v80, v80, v168
  v_add_f32 v81, v81, v169
  v_add_f32 v82, v82, v170
  v_add_f32 v83, v83, v171
  v_add_f32 v80, v80, v172
  v_add_f32 v81, v81, v173
  v_add_f32 v82, v82, v174
  v_add_f32 v83, v83, v175
  ds_write_b128 v22, v[80:83] offset:12288
  s_waitcnt lgkmcnt(0)
  s_barrier
  v_mfma_f32_16x16x32_bf16 v[148:151], v[36:39], a[84:87], v[148:151]
  v_cvt_pk_bf16_f32 v106, v200, v201
  v_cvt_pk_bf16_f32 v107, v202, v203
  v_mfma_f32_16x16x32_bf16 v[152:155], v[32:35], a[72:75], v[152:155]
  ds_read_b64_tr_b16 v[26:27], v16 offset:12800
  v_mul_f32 v204, v204, v220
  v_mfma_f32_16x16x32_bf16 v[152:155], v[36:39], a[88:91], v[152:155]
  v_mul_f32 v205, v205, v221
  v_mul_f32 v206, v206, v222
  v_mfma_f32_16x16x32_bf16 v[156:159], v[32:35], a[76:79], v[156:159]
  ds_read_b64_tr_b16 v[28:29], v16 offset:14336
  v_mul_f32 v207, v207, v223
  v_mfma_f32_16x16x32_bf16 v[156:159], v[36:39], a[92:95], v[156:159]
  s_waitcnt lgkmcnt(4)
  ds_read_b64_tr_b16 v[30:31], v16 offset:14848
  v_cvt_pk_bf16_f32 v110, v204, v205
  v_mfma_f32_16x16x32_bf16 v[128:131], v[40:43], a[64:67], v[128:131]
  s_waitcnt vmcnt(17)
  s_barrier
  v_mfma_f32_16x16x32_bf16 v[128:131], v[44:47], a[80:83], v[128:131]
  buffer_load_dwordx4 a[16:19], v12, s[40:43], s90 offen offset:0 sc1
  v_mfma_f32_16x16x32_bf16 v[132:135], v[40:43], a[68:71], v[132:135]
  s_add_u32 s28, s85, 3
  ds_read_b64_tr_b16 v[32:33], v16 offset:13312
  v_cvt_pk_bf16_f32 v111, v206, v207
  v_mfma_f32_16x16x32_bf16 v[132:135], v[44:47], a[84:87], v[132:135]
  buffer_load_dwordx4 a[20:23], v12, s[40:43], s90 offen offset:1024 sc1
  v_mfma_f32_16x16x32_bf16 v[136:139], v[40:43], a[72:75], v[136:139]
  ds_read_b64_tr_b16 v[34:35], v16 offset:13824
  v_add_u32 v23, 159744, v15
  v_mfma_f32_16x16x32_bf16 v[136:139], v[44:47], a[88:91], v[136:139]
  ds_read_b64_tr_b16 v[36:37], v16 offset:15360
  v_mov_b32 v51, s28
  v_mfma_f32_16x16x32_bf16 v[140:143], v[40:43], a[76:79], v[140:143]
  buffer_store_dword v51, v60, s[40:43], s55 offen sc1
  v_mfma_f32_16x16x32_bf16 v[140:143], v[44:47], a[92:95], v[140:143]
  s_waitcnt lgkmcnt(3)
  ds_read_b64_tr_b16 v[38:39], v16 offset:15872
  v_mfma_f32_16x16x32_bf16 v[144:147], v[24:27], a[96:99], v[144:147]
  buffer_load_dwordx4 a[24:27], v12, s[40:43], s90 offen offset:2048 sc1
  v_mfma_f32_16x16x32_bf16 v[144:147], v[28:31], a[112:115], v[144:147]
  s_lshl_b32 s83, s51, 7
  ds_read_b64_tr_b16 v[40:41], v16 offset:16384
  v_mfma_f32_16x16x32_bf16 v[148:151], v[24:27], a[100:103], v[148:151]
  s_lshl_b32 s84, s49, 4
  ds_read_b64_tr_b16 v[42:43], v16 offset:16896
  v_mfma_f32_16x16x32_bf16 v[148:151], v[28:31], a[116:119], v[148:151]
  s_add_u32 s83, s83, s84
  ds_read_b64_tr_b16 v[44:45], v16 offset:18432
  v_mfma_f32_16x16x32_bf16 v[152:155], v[24:27], a[104:107], v[152:155]
  buffer_load_dwordx4 a[28:31], v12, s[40:43], s90 offen offset:3072 sc1
  v_mfma_f32_16x16x32_bf16 v[152:155], v[28:31], a[120:123], v[152:155]
  s_add_u32 s90, s70, 0
  ds_read_b64_tr_b16 v[46:47], v16 offset:18944
  v_mfma_f32_16x16x32_bf16 v[156:159], v[24:27], a[108:111], v[156:159]
  s_mov_b32 s59, 65536
  ds_read_b128 v[176:179], v23 offset:0
  v_mfma_f32_16x16x32_bf16 v[156:159], v[28:31], a[124:127], v[156:159]
  s_waitcnt lgkmcnt(5)
  ds_read_b128 v[180:183], v23 offset:1024
  v_mfma_f32_16x16x32_bf16 v[128:131], v[32:35], a[96:99], v[128:131]
  buffer_store_dwordx4 v[100:103], v11, s[40:43], s59 offen sc1
  v_mfma_f32_16x16x32_bf16 v[128:131], v[36:39], a[112:115], v[128:131]
  s_lshl_b32 s84, s48, 2
  ds_read_b64_tr_b16 v[24:25], v16 offset:17408
  v_mfma_f32_16x16x32_bf16 v[132:135], v[32:35], a[100:103], v[132:135]
  s_add_u32 s83, s83, s84
  ds_read_b64_tr_b16 v[26:27], v16 offset:17920
  v_mfma_f32_16x16x32_bf16 v[132:135], v[36:39], a[116:119], v[132:135]
  s_lshl_b32 s83, s83, 9
  ds_read_b64_tr_b16 v[28:29], v16 offset:19456
  v_mfma_f32_16x16x32_bf16 v[136:139], v[32:35], a[104:107], v[136:139]
  s_bfe_u32 s84, s0, 0x20001
  ds_read_b64_tr_b16 v[30:31], v16 offset:19968
  v_mfma_f32_16x16x32_bf16 v[136:139], v[36:39], a[120:123], v[136:139]
  s_lshl_b32 s84, s84, 7
  ds_read_b128 v[184:187], v23 offset:2048
  v_mfma_f32_16x16x32_bf16 v[140:143], v[32:35], a[108:111], v[140:143]
  s_add_u32 s83, s83, s84
  ds_read_b128 v[188:191], v23 offset:3072
  v_and_b32 v23, 15, v0
  v_mfma_f32_16x16x32_bf16 v[140:143], v[36:39], a[124:127], v[140:143]
  s_waitcnt lgkmcnt(8)
  s_waitcnt lgkmcnt(0)
  v_cvt_pk_bf16_f32 v160, v176, v177
  v_mfma_f32_16x16x32_bf16 v[144:147], v[40:43], a[128:131], v[144:147]
  s_and_b32 s84, s0, 1
  ds_read_b64_tr_b16 v[32:33], v16 offset:20480
  v_cvt_pk_bf16_f32 v161, v178, v179
  v_mfma_f32_16x16x32_bf16 v[144:147], v[44:47], a[144:147], v[144:147]
  s_lshl_b32 s84, s84, 2
  ds_read_b64_tr_b16 v[34:35], v16 offset:20992
  v_cvt_pk_bf16_f32 v162, v184, v185
  v_mfma_f32_16x16x32_bf16 v[148:151], v[40:43], a[132:135], v[148:151]
  s_add_u32 s83, s83, s84
  ds_read_b64_tr_b16 v[36:37], v16 offset:22528
  v_cvt_pk_bf16_f32 v163, v186, v187
  v_mfma_f32_16x16x32_bf16 v[148:151], v[44:47], a[148:151], v[148:151]
  s_nop 0
  v_mfma_f32_16x16x32_bf16 v[80:83], v[160:163], v[64:67], 0
  v_mfma_f32_16x16x32_bf16 v[152:155], v[40:43], a[136:139], v[152:155]
  v_mfma_f32_16x16x32_bf16 v[84:87], v[160:163], v[68:71], 0
  v_mfma_f32_16x16x32_bf16 v[152:155], v[44:47], a[152:155], v[152:155]
  v_mfma_f32_16x16x32_bf16 v[88:91], v[160:163], v[72:75], 0
  v_mfma_f32_16x16x32_bf16 v[156:159], v[40:43], a[140:143], v[156:159]
  v_mfma_f32_16x16x32_bf16 v[92:95], v[160:163], v[76:79], 0
  v_mfma_f32_16x16x32_bf16 v[156:159], v[44:47], a[156:159], v[156:159]
  s_waitcnt lgkmcnt(5)
  ds_read_b64_tr_b16 v[38:39], v16 offset:23040
  v_cvt_pk_bf16_f32 v164, v180, v181
  v_mfma_f32_16x16x32_bf16 v[128:131], v[24:27], a[128:131], v[128:131]
  buffer_load_dwordx4 a[32:35], v12, s[40:43], s90 offen offset:0 sc1
  v_mfma_f32_16x16x32_bf16 v[128:131], v[28:31], a[144:147], v[128:131]
  buffer_load_dwordx4 a[36:39], v12, s[40:43], s90 offen offset:1024 sc1
  v_mfma_f32_16x16x32_bf16 v[132:135], v[24:27], a[132:135], v[132:135]
  s_add_u32 s83, s83, 20971520
  ds_read_b64_tr_b16 v[40:41], v16 offset:21504
  v_cvt_pk_bf16_f32 v165, v182, v183
  v_mfma_f32_16x16x32_bf16 v[132:135], v[28:31], a[148:151], v[132:135]
  ds_read_b64_tr_b16 v[42:43], v16 offset:22016
  v_cvt_pk_bf16_f32 v166, v188, v189
  v_mfma_f32_16x16x32_bf16 v[136:139], v[24:27], a[136:139], v[136:139]
  buffer_load_dwordx4 a[40:43], v12, s[40:43], s90 offen offset:2048 sc1
  v_mfma_f32_16x16x32_bf16 v[136:139], v[28:31], a[152:155], v[136:139]
  ds_read_b64_tr_b16 v[44:45], v16 offset:23552
  v_cvt_pk_bf16_f32 v167, v190, v191
  v_mfma_f32_16x16x32_bf16 v[140:143], v[24:27], a[140:143], v[140:143]
  s_nop 0
  v_mfma_f32_16x16x32_bf16 v[176:179], v[164:167], v[64:67], 0
  v_mfma_f32_16x16x32_bf16 v[140:143], v[28:31], a[156:159], v[140:143]
  ds_read_b64_tr_b16 v[46:47], v16 offset:24064
  s_waitcnt lgkmcnt(4) vmcnt(42)
  s_barrier
  v_mfma_f32_16x16x32_bf16 v[144:147], v[32:35], a[160:163], v[144:147]
  v_mfma_f32_16x16x32_bf16 v[180:183], v[164:167], v[68:71], 0
  v_mfma_f32_16x16x32_bf16 v[144:147], v[36:39], a[176:179], v[144:147]
  v_mfma_f32_16x16x32_bf16 v[184:187], v[164:167], v[72:75], 0
  v_mfma_f32_16x16x32_bf16 v[148:151], v[32:35], a[164:167], v[148:151]
  v_mfma_f32_16x16x32_bf16 v[188:191], v[164:167], v[76:79], 0
  v_mfma_f32_16x16x32_bf16 v[148:151], v[36:39], a[180:183], v[148:151]
  s_mov_b32 s59, 106496
  ds_read_b64_tr_b16 v[24:25], v16 offset:24576
  v_lshl_add_u32 v23, v23, 3, s83
  v_mfma_f32_16x16x32_bf16 v[152:155], v[32:35], a[168:171], v[152:155]
  buffer_store_dwordx4 v[104:107], v11, s[40:43], s59 offen sc1
  v_mfma_f32_16x16x32_bf16 v[152:155], v[36:39], a[184:187], v[152:155]
  ds_read_b64_tr_b16 v[26:27], v16 offset:25088
  v_add_f32 v179, 0x358637bd, v179
  v_mfma_f32_16x16x32_bf16 v[156:159], v[32:35], a[172:175], v[156:159]
  ds_read_b64_tr_b16 v[28:29], v16 offset:26624
  v_add_f32 v183, 0x358637bd, v183
  v_mfma_f32_16x16x32_bf16 v[156:159], v[36:39], a[188:191], v[156:159]
  s_waitcnt lgkmcnt(3)
  ds_read_b64_tr_b16 v[30:31], v16 offset:27136
  v_add_f32 v187, 0x358637bd, v187
  v_mfma_f32_16x16x32_bf16 v[128:131], v[40:43], a[160:163], v[128:131]
  ds_read_b64_tr_b16 v[32:33], v16 offset:25600
  v_add_f32 v191, 0x358637bd, v191
  v_mfma_f32_16x16x32_bf16 v[128:131], v[44:47], a[176:179], v[128:131]
  ds_read_b64_tr_b16 v[34:35], v16 offset:26112
  v_mfma_f32_16x16x32_bf16 v[132:135], v[40:43], a[164:167], v[132:135]
  ds_read_b64_tr_b16 v[36:37], v16 offset:27648
  v_mfma_f32_16x16x32_bf16 v[132:135], v[44:47], a[180:183], v[132:135]
  ds_read_b64_tr_b16 v[38:39], v16 offset:28160
  v_mfma_f32_16x16x32_bf16 v[136:139], v[40:43], a[168:171], v[136:139]
  v_rcp_f32 v179, v179
  v_mfma_f32_16x16x32_bf16 v[136:139], v[44:47], a[184:187], v[136:139]
  buffer_load_dwordx4 a[44:47], v12, s[40:43], s90 offen offset:3072 sc1
  v_mfma_f32_16x16x32_bf16 v[140:143], v[40:43], a[172:175], v[140:143]
  s_add_u32 s90, s70, 40960
  v_rcp_f32 v183, v183
  v_mfma_f32_16x16x32_bf16 v[140:143], v[44:47], a[188:191], v[140:143]
  s_waitcnt lgkmcnt(4)
  v_rcp_f32 v187, v187
  v_mfma_f32_16x16x32_bf16 v[144:147], v[24:27], a[192:195], v[144:147]
  ds_read_b64_tr_b16 v[40:41], v16 offset:28672
  v_mul_f32 v179, v179, v49
  v_mfma_f32_16x16x32_bf16 v[144:147], v[28:31], a[208:211], v[144:147]
  buffer_load_dwordx4 a[48:51], v12, s[40:43], s90 offen offset:0 sc1
  v_mfma_f32_16x16x32_bf16 v[148:151], v[24:27], a[196:199], v[148:151]
  ds_read_b64_tr_b16 v[42:43], v16 offset:29184
  v_mul_f32 v183, v183, v53
  v_mfma_f32_16x16x32_bf16 v[148:151], v[28:31], a[212:215], v[148:151]
  ds_read_b64_tr_b16 v[44:45], v16 offset:30720
  v_mul_f32 v187, v187, v57
  v_mfma_f32_16x16x32_bf16 v[152:155], v[24:27], a[200:203], v[152:155]
  ds_read_b64_tr_b16 v[46:47], v16 offset:31232
  v_mul_f32 v80, v80, v179
  v_mfma_f32_16x16x32_bf16 v[152:155], v[28:31], a[216:219], v[152:155]
  v_rcp_f32 v191, v191
  v_mfma_f32_16x16x32_bf16 v[156:159], v[24:27], a[204:207], v[156:159]
  buffer_load_dwordx4 a[52:55], v12, s[40:43], s90 offen offset:1024 sc1
  v_mfma_f32_16x16x32_bf16 v[156:159], v[28:31], a[220:223], v[156:159]
  s_waitcnt lgkmcnt(4)
  v_mul_f32 v191, v191, v61
  v_mul_f32 v81, v81, v179
  v_mfma_f32_16x16x32_bf16 v[128:131], v[32:35], a[192:195], v[128:131]
  ds_read_b64_tr_b16 v[24:25], v16 offset:29696
  v_mul_f32 v82, v82, v179
  v_mfma_f32_16x16x32_bf16 v[128:131], v[36:39], a[208:211], v[128:131]
  ds_read_b64_tr_b16 v[26:27], v16 offset:30208
  v_mul_f32 v83, v83, v179
  v_mfma_f32_16x16x32_bf16 v[132:135], v[32:35], a[196:199], v[132:135]
  buffer_load_dwordx4 a[56:59], v12, s[40:43], s90 offen offset:2048 sc1
  v_mfma_f32_16x16x32_bf16 v[132:135], v[36:39], a[212:215], v[132:135]
  ds_read_b64_tr_b16 v[28:29], v16 offset:31744
  v_mul_f32 v176, v176, v179
  v_mfma_f32_16x16x32_bf16 v[136:139], v[32:35], a[200:203], v[136:139]
  s_mov_b32 s59, 147456
  ds_read_b64_tr_b16 v[30:31], v16 offset:32256
  v_mul_f32 v177, v177, v179
  v_mfma_f32_16x16x32_bf16 v[136:139], v[36:39], a[216:219], v[136:139]
  v_cvt_pk_bf16_f32 v66, v80, v81
  v_cvt_pk_bf16_f32 v67, v82, v83
  v_mfma_f32_16x16x32_bf16 v[140:143], v[32:35], a[204:207], v[140:143]
  buffer_store_dwordx4 v[108:111], v11, s[40:43], s59 offen sc1
  v_mfma_f32_16x16x32_bf16 v[140:143], v[36:39], a[220:223], v[140:143]
  s_waitcnt lgkmcnt(4)
  v_cvt_pk_bf16_f32 v176, v176, v177
  v_mul_f32 v84, v84, v183
  v_mfma_f32_16x16x32_bf16 v[144:147], v[40:43], a[224:227], v[144:147]
  ds_read_b64_tr_b16 v[32:33], v16 offset:32768
  v_mul_f32 v85, v85, v183
  v_mfma_f32_16x16x32_bf16 v[144:147], v[44:47], a[240:243], v[144:147]
  ds_read_b64_tr_b16 v[34:35], v16 offset:33280
  v_mul_f32 v86, v86, v183
  v_mfma_f32_16x16x32_bf16 v[148:151], v[40:43], a[228:231], v[148:151]
  ds_read_b64_tr_b16 v[36:37], v16 offset:34816
  v_mul_f32 v87, v87, v183
  v_mfma_f32_16x16x32_bf16 v[148:151], v[44:47], a[244:247], v[148:151]
  ds_read_b64_tr_b16 v[38:39], v16 offset:35328
  v_mul_f32 v180, v180, v183
  v_mfma_f32_16x16x32_bf16 v[152:155], v[40:43], a[232:235], v[152:155]
  v_mul_f32 v181, v181, v183
  v_cvt_pk_bf16_f32 v70, v84, v85
  v_mfma_f32_16x16x32_bf16 v[152:155], v[44:47], a[248:251], v[152:155]
  v_cvt_pk_bf16_f32 v71, v86, v87
  v_mfma_f32_16x16x32_bf16 v[156:159], v[40:43], a[236:239], v[156:159]
  v_cvt_pk_bf16_f32 v180, v180, v181
  v_mul_f32 v88, v88, v187
  v_mfma_f32_16x16x32_bf16 v[156:159], v[44:47], a[252:255], v[156:159]
  s_waitcnt lgkmcnt(4)
  v_mul_f32 v89, v89, v187
  v_mfma_f32_16x16x32_bf16 v[128:131], v[24:27], a[224:227], v[128:131]
  ds_read_b64_tr_b16 v[40:41], v16 offset:33792
  v_mul_f32 v90, v90, v187
  v_mfma_f32_16x16x32_bf16 v[128:131], v[28:31], a[240:243], v[128:131]
  ds_read_b64_tr_b16 v[42:43], v16 offset:34304
  v_mul_f32 v91, v91, v187
  v_mfma_f32_16x16x32_bf16 v[132:135], v[24:27], a[228:231], v[132:135]
  ds_read_b64_tr_b16 v[44:45], v16 offset:35840
  v_mul_f32 v184, v184, v187
  v_mfma_f32_16x16x32_bf16 v[132:135], v[28:31], a[244:247], v[132:135]
  ds_read_b64_tr_b16 v[46:47], v16 offset:36352
  v_mul_f32 v185, v185, v187
  v_mfma_f32_16x16x32_bf16 v[136:139], v[24:27], a[232:235], v[136:139]
  v_cvt_pk_bf16_f32 v74, v88, v89
  v_cvt_pk_bf16_f32 v75, v90, v91
  v_mfma_f32_16x16x32_bf16 v[136:139], v[28:31], a[248:251], v[136:139]
  buffer_load_dwordx4 a[60:63], v12, s[40:43], s90 offen offset:3072 sc1
  v_mfma_f32_16x16x32_bf16 v[140:143], v[24:27], a[236:239], v[140:143]
  s_add_u32 s90, s76, 0
  v_cvt_pk_bf16_f32 v184, v184, v185
  v_mul_f32 v92, v92, v191
  v_mfma_f32_16x16x32_bf16 v[140:143], v[28:31], a[252:255], v[140:143]
  s_waitcnt lgkmcnt(4)
  s_waitcnt lgkmcnt(0) vmcnt(63)
  s_barrier
  v_mfma_f32_16x16x32_bf16 v[144:147], v[32:35], v[224:227], v[144:147]
  ds_read_b64_tr_b16 a[192:193], v10 offset:0
  v_mul_f32 v93, v93, v191
  v_mfma_f32_16x16x32_bf16 v[144:147], v[36:39], v[240:243], v[144:147]
  buffer_load_dwordx4 a[64:67], v12, s[40:43], s90 offen offset:0 sc1
  v_mfma_f32_16x16x32_bf16 v[148:151], v[32:35], v[228:231], v[148:151]
  ds_read_b64_tr_b16 a[194:195], v10 offset:4608
  v_mul_f32 v94, v94, v191
  v_mfma_f32_16x16x32_bf16 v[148:151], v[36:39], v[244:247], v[148:151]
  ds_read_b64_tr_b16 a[196:197], v10 offset:9216
  v_mul_f32 v95, v95, v191
  v_mfma_f32_16x16x32_bf16 v[152:155], v[32:35], v[232:235], v[152:155]
  ds_read_b64_tr_b16 a[198:199], v10 offset:13824
  v_mul_f32 v188, v188, v191
  v_mfma_f32_16x16x32_bf16 v[152:155], v[36:39], v[248:251], v[152:155]
  buffer_load_dwordx4 a[68:71], v12, s[40:43], s90 offen offset:1024 sc1
  v_mfma_f32_16x16x32_bf16 v[156:159], v[32:35], v[236:239], v[156:159]
  ds_read_b64_tr_b16 a[200:201], v10 offset:18432
  v_mul_f32 v189, v189, v191
  v_mfma_f32_16x16x32_bf16 v[156:159], v[36:39], v[252:255], v[156:159]
  s_waitcnt lgkmcnt(5)
  ds_read_b64_tr_b16 a[202:203], v10 offset:23040
  v_cvt_pk_bf16_f32 v78, v92, v93
  v_mfma_f32_16x16x32_bf16 v[128:131], v[40:43], v[224:227], v[128:131]
  ds_read_b64_tr_b16 a[204:205], v10 offset:27648
  v_cvt_pk_bf16_f32 v79, v94, v95
  v_mfma_f32_16x16x32_bf16 v[128:131], v[44:47], v[240:243], v[128:131]
  ds_read_b64_tr_b16 a[206:207], v10 offset:32256
  v_cvt_pk_bf16_f32 v188, v188, v189
  v_mfma_f32_16x16x32_bf16 v[132:135], v[40:43], v[228:231], v[132:135]
  ds_read_b64_tr_b16 a[208:209], v10 offset:32
  s_mov_b32 exec_lo, 0xffff0000
  s_mov_b32 exec_hi, 0
  buffer_store_dword v176, v23, s[40:43], 0 offen offset:0 sc1
  buffer_store_dword v180, v23, s[40:43], 0 offen offset:512 sc1
  buffer_store_dword v184, v23, s[40:43], 0 offen offset:1024 sc1
  buffer_store_dword v188, v23, s[40:43], 0 offen offset:1536 sc1
  s_mov_b64 exec, -1
  v_mfma_f32_16x16x32_bf16 v[132:135], v[44:47], v[244:247], v[132:135]
  ds_read_b64_tr_b16 a[210:211], v10 offset:4640
  v_mfma_f32_16x16x32_bf16 v[136:139], v[40:43], v[232:235], v[136:139]
  ds_read_b64_tr_b16 a[212:213], v10 offset:9248
  v_mfma_f32_16x16x32_bf16 v[136:139], v[44:47], v[248:251], v[136:139]
  ds_read_b64_tr_b16 a[214:215], v10 offset:13856
  v_mfma_f32_16x16x32_bf16 v[140:143], v[40:43], v[236:239], v[140:143]
  s_waitcnt vmcnt(17)
  ds_read_b64_tr_b16 a[216:217], v10 offset:18464
  v_mfma_f32_16x16x32_bf16 v[140:143], v[44:47], v[252:255], v[140:143]
  s_waitcnt lgkmcnt(5)
  ds_read_b64_tr_b16 a[218:219], v10 offset:23072
  v_mfma_f32_16x16x32_bf16 v[224:227], a[192:195], a[0:3], 0
  ds_read_b64_tr_b16 a[220:221], v10 offset:27680
  v_mfma_f32_16x16x32_bf16 v[224:227], a[196:199], a[4:7], v[224:227]
  ds_read_b64_tr_b16 a[222:223], v10 offset:32288
  v_mfma_f32_16x16x32_bf16 v[224:227], a[200:203], a[8:11], v[224:227]
  ds_read_b64_tr_b16 a[224:225], v10 offset:64
  buffer_load_dwordx4 a[72:75], v12, s[40:43], s90 offen offset:2048 sc1
  v_mfma_f32_16x16x32_bf16 v[224:227], a[204:207], a[12:15], v[224:227]
  v_mul_f32 v144, v144, v128
  v_mul_f32 v145, v145, v129
  v_mfma_f32_16x16x32_bf16 v[228:231], a[192:195], a[16:19], 0
  ds_read_b64_tr_b16 a[226:227], v10 offset:4672
  v_mul_f32 v146, v146, v130
  v_mfma_f32_16x16x32_bf16 v[228:231], a[196:199], a[20:23], v[228:231]
  ds_read_b64_tr_b16 a[228:229], v10 offset:9280
  buffer_load_dwordx4 a[76:79], v12, s[40:43], s90 offen offset:3072 sc1
  v_mfma_f32_16x16x32_bf16 v[228:231], a[200:203], a[24:27], v[228:231]
  s_add_u32 s90, s76, 40960
  v_mul_f32 v147, v147, v131
  v_mul_f32 v144, v144, v50
  v_mfma_f32_16x16x32_bf16 v[228:231], a[204:207], a[28:31], v[228:231]
  s_waitcnt lgkmcnt(3)
  ds_read_b64_tr_b16 a[230:231], v10 offset:13888
  v_mul_f32 v145, v145, v50
  v_mfma_f32_16x16x32_bf16 v[232:235], a[208:211], a[0:3], 0
  v_mul_f32 v146, v146, v50
  v_mul_f32 v147, v147, v50
  v_mfma_f32_16x16x32_bf16 v[232:235], a[212:215], a[4:7], v[232:235]
  ds_read_b64_tr_b16 a[232:233], v10 offset:18496
  ds_read_b64_tr_b16 a[234:235], v10 offset:23104
  ds_read_b64_tr_b16 a[236:237], v10 offset:27712
  ds_read_b64_tr_b16 a[238:239], v10 offset:32320
  v_mfma_f32_16x16x32_bf16 v[232:235], a[216:219], a[8:11], v[232:235]
  ds_read_b64_tr_b16 a[192:193], v10 offset:96
  buffer_load_dwordx4 a[80:83], v12, s[40:43], s90 offen offset:0 sc1
  v_mfma_f32_16x16x32_bf16 v[232:235], a[220:223], a[12:15], v[232:235]
  v_cvt_pk_bf16_f32 v64, v144, v145
  v_cvt_pk_bf16_f32 v65, v146, v147
  v_mfma_f32_16x16x32_bf16 v[236:239], a[208:211], a[16:19], 0
  s_mov_b32 s59, 32768
  ds_read_b64_tr_b16 a[194:195], v10 offset:4704
  v_mul_f32 v148, v148, v132
  v_mfma_f32_16x16x32_bf16 v[236:239], a[212:215], a[20:23], v[236:239]
  ds_read_b64_tr_b16 a[196:197], v10 offset:9312
  buffer_store_dwordx4 v[64:67], v11, s[40:43], s59 offen sc1
  v_mfma_f32_16x16x32_bf16 v[236:239], a[216:219], a[24:27], v[236:239]
  v_mul_f32 v149, v149, v133
  v_mul_f32 v150, v150, v134
  v_mfma_f32_16x16x32_bf16 v[236:239], a[220:223], a[28:31], v[236:239]
  s_waitcnt lgkmcnt(3)
  ds_read_b64_tr_b16 a[198:199], v10 offset:13920
  v_mul_f32 v151, v151, v135
  v_mfma_f32_16x16x32_bf16 v[240:243], a[224:227], a[0:3], 0
  v_mul_f32 v148, v148, v54
  v_mul_f32 v149, v149, v54
  v_mfma_f32_16x16x32_bf16 v[240:243], a[228:231], a[4:7], v[240:243]
  ds_read_b64_tr_b16 a[200:201], v10 offset:18528
  ds_read_b64_tr_b16 a[202:203], v10 offset:23136
  ds_read_b64_tr_b16 a[204:205], v10 offset:27744
  ds_read_b64_tr_b16 a[206:207], v10 offset:32352
  v_mfma_f32_16x16x32_bf16 v[240:243], a[232:235], a[8:11], v[240:243]
  v_mul_f32 v150, v150, v54
  v_mul_f32 v151, v151, v54
  v_mfma_f32_16x16x32_bf16 v[240:243], a[236:239], a[12:15], v[240:243]
  ds_read_b64_tr_b16 a[208:209], v10 offset:128
  v_cvt_pk_bf16_f32 v68, v148, v149
  v_mfma_f32_16x16x32_bf16 v[244:247], a[224:227], a[16:19], 0
  s_lshl_b32 s83, s51, 4
  v_cvt_pk_bf16_f32 v69, v150, v151
  v_mul_f32 v152, v152, v136
  v_mfma_f32_16x16x32_bf16 v[244:247], a[228:231], a[20:23], v[244:247]
  s_add_u32 s83, s83, s52
  ds_read_b64_tr_b16 a[210:211], v10 offset:4736
  v_mul_f32 v153, v153, v137
  v_mfma_f32_16x16x32_bf16 v[244:247], a[232:235], a[24:27], v[244:247]
  ds_read_b64_tr_b16 a[212:213], v10 offset:9344
  buffer_load_dword v20, v21, s[40:43], 0 offen sc1
  v_mfma_f32_16x16x32_bf16 v[244:247], a[236:239], a[28:31], v[244:247]
  s_waitcnt lgkmcnt(3)
  v_mul_f32 v154, v154, v138
  v_mul_f32 v155, v155, v139
  v_mfma_f32_16x16x32_bf16 v[248:251], a[192:195], a[0:3], 0
  ds_read_b64_tr_b16 a[214:215], v10 offset:13952
  buffer_load_dwordx4 a[84:87], v12, s[40:43], s90 offen offset:1024 sc1
  v_mfma_f32_16x16x32_bf16 v[248:251], a[196:199], a[4:7], v[248:251]
  ds_read_b64_tr_b16 a[216:217], v10 offset:18560
  ds_read_b64_tr_b16 a[218:219], v10 offset:23168
  ds_read_b64_tr_b16 a[220:221], v10 offset:27776
  ds_read_b64_tr_b16 a[222:223], v10 offset:32384
  v_mfma_f32_16x16x32_bf16 v[248:251], a[200:203], a[8:11], v[248:251]
  s_lshl_b32 s83, s83, 2
  v_mul_f32 v152, v152, v58
  v_mul_f32 v153, v153, v58
  v_mfma_f32_16x16x32_bf16 v[248:251], a[204:207], a[12:15], v[248:251]
  s_add_u32 s83, s83, s48
  ds_read_b64_tr_b16 a[224:225], v10 offset:160
  v_mul_f32 v154, v154, v58
  v_mfma_f32_16x16x32_bf16 v[252:255], a[192:195], a[16:19], 0
  ds_read_b64_tr_b16 a[226:227], v10 offset:4768
  buffer_load_dwordx4 a[88:91], v12, s[40:43], s90 offen offset:2048 sc1
  v_mfma_f32_16x16x32_bf16 v[252:255], a[196:199], a[20:23], v[252:255]
  s_lshl_b32 s83, s83, 7
  v_mul_f32 v155, v155, v58
  v_cvt_pk_bf16_f32 v72, v152, v153
  v_mfma_f32_16x16x32_bf16 v[252:255], a[200:203], a[24:27], v[252:255]
  s_add_u32 s83, s83, 22609920
  ds_read_b64_tr_b16 a[228:229], v10 offset:9376
  v_cvt_pk_bf16_f32 v73, v154, v155
  v_mfma_f32_16x16x32_bf16 v[252:255], a[204:207], a[28:31], v[252:255]
  s_waitcnt lgkmcnt(3)
  v_mul_f32 v156, v156, v140
  v_mul_f32 v157, v157, v141
  v_mfma_f32_16x16x32_bf16 v[24:27], a[208:211], a[0:3], 0
  ds_read_b64_tr_b16 a[230:231], v10 offset:13984
  buffer_load_dwordx4 a[92:95], v12, s[40:43], s90 offen offset:3072 sc1
  v_mfma_f32_16x16x32_bf16 v[24:27], a[212:215], a[4:7], v[24:27]
  ds_read_b64_tr_b16 a[232:233], v10 offset:18592
  ds_read_b64_tr_b16 a[234:235], v10 offset:23200
  ds_read_b64_tr_b16 a[236:237], v10 offset:27808
  ds_read_b64_tr_b16 a[238:239], v10 offset:32416
  v_mfma_f32_16x16x32_bf16 v[24:27], a[216:219], a[8:11], v[24:27]
  s_add_u32 m0, s64, 122880
  s_mov_b32 s56, s68
  v_mul_f32 v158, v158, v142
  v_mfma_f32_16x16x32_bf16 v[24:27], a[220:223], a[12:15], v[24:27]
  v_mul_f32 v159, v159, v143
  v_mul_f32 v156, v156, v62
  v_mfma_f32_16x16x32_bf16 v[28:31], a[208:211], a[16:19], 0
  ds_read_b64_tr_b16 a[192:193], v10 offset:192
  buffer_load_dwordx4 v1, s[24:27], s56 offen lds
  v_mfma_f32_16x16x32_bf16 v[28:31], a[212:215], a[20:23], v[28:31]
  s_mov_b32 s59, 73728
  v_mul_f32 v157, v157, v62
  v_mul_f32 v158, v158, v62
  v_mfma_f32_16x16x32_bf16 v[28:31], a[216:219], a[24:27], v[28:31]
  ds_read_b64_tr_b16 a[194:195], v10 offset:4800
  v_mul_f32 v159, v159, v62
  v_mfma_f32_16x16x32_bf16 v[28:31], a[220:223], a[28:31], v[28:31]
  s_waitcnt lgkmcnt(2)
  v_cvt_pk_bf16_f32 v76, v156, v157
  v_cvt_pk_bf16_f32 v77, v158, v159
  v_mfma_f32_16x16x32_bf16 v[32:35], a[224:227], a[0:3], 0
  ds_read_b64_tr_b16 a[196:197], v10 offset:9408
  buffer_store_dwordx4 v[68:71], v11, s[40:43], s59 offen sc1
  v_mfma_f32_16x16x32_bf16 v[32:35], a[228:231], a[4:7], v[32:35]
  ds_read_b64_tr_b16 a[198:199], v10 offset:14016
  ds_read_b64_tr_b16 a[200:201], v10 offset:18624
  ds_read_b64_tr_b16 a[202:203], v10 offset:23232
  ds_read_b64_tr_b16 a[204:205], v10 offset:27840
  ds_read_b64_tr_b16 a[206:207], v10 offset:32448
  v_mfma_f32_16x16x32_bf16 v[32:35], a[232:235], a[8:11], v[32:35]
  ds_read_b64_tr_b16 a[208:209], v10 offset:224
  v_and_b32 v19, 15, v0
  v_mfma_f32_16x16x32_bf16 v[32:35], a[236:239], a[12:15], v[32:35]
  ds_read_b64_tr_b16 a[210:211], v10 offset:4832
  v_lshl_add_u32 v19, v19, 2, s83
  v_mfma_f32_16x16x32_bf16 v[36:39], a[224:227], a[16:19], 0
  ds_read_b64_tr_b16 a[212:213], v10 offset:9440
  v_mfma_f32_16x16x32_bf16 v[36:39], a[228:231], a[20:23], v[36:39]
  ds_read_b64_tr_b16 a[214:215], v10 offset:14048
  v_mfma_f32_16x16x32_bf16 v[36:39], a[232:235], a[24:27], v[36:39]
  ds_read_b64_tr_b16 a[216:217], v10 offset:18656
  v_mfma_f32_16x16x32_bf16 v[36:39], a[236:239], a[28:31], v[36:39]
  s_waitcnt lgkmcnt(5)
  ds_read_b64_tr_b16 a[218:219], v10 offset:23264
  v_mfma_f32_16x16x32_bf16 v[40:43], a[192:195], a[0:3], 0
  ds_read_b64_tr_b16 a[220:221], v10 offset:27872
  v_mfma_f32_16x16x32_bf16 v[40:43], a[196:199], a[4:7], v[40:43]
  ds_read_b64_tr_b16 a[222:223], v10 offset:32480
  v_mfma_f32_16x16x32_bf16 v[40:43], a[200:203], a[8:11], v[40:43]
  ds_read_b64_tr_b16 a[224:225], v10 offset:256
  v_mfma_f32_16x16x32_bf16 v[40:43], a[204:207], a[12:15], v[40:43]
  ds_read_b64_tr_b16 a[226:227], v10 offset:4864
  v_mfma_f32_16x16x32_bf16 v[44:47], a[192:195], a[16:19], 0
  ds_read_b64_tr_b16 a[228:229], v10 offset:9472
  v_mfma_f32_16x16x32_bf16 v[44:47], a[196:199], a[20:23], v[44:47]
  ds_read_b64_tr_b16 a[230:231], v10 offset:14080
  v_mfma_f32_16x16x32_bf16 v[44:47], a[200:203], a[24:27], v[44:47]
  ds_read_b64_tr_b16 a[232:233], v10 offset:18688
  buffer_load_dwordx4 v2, s[24:27], s56 offen offset:1024 lds
  v_mfma_f32_16x16x32_bf16 v[44:47], a[204:207], a[28:31], v[44:47]
  s_waitcnt lgkmcnt(5) vmcnt(63)
  s_barrier
  v_mfma_f32_16x16x32_bf16 v[160:163], a[208:211], a[0:3], 0
  ds_read_b64_tr_b16 a[234:235], v10 offset:23296
  v_mfma_f32_16x16x32_bf16 v[160:163], a[212:215], a[4:7], v[160:163]
  ds_read_b64_tr_b16 a[236:237], v10 offset:27904
  ds_read_b64_tr_b16 a[238:239], v10 offset:32512
  v_mfma_f32_16x16x32_bf16 v[160:163], a[216:219], a[8:11], v[160:163]
  buffer_load_dwordx4 v3, s[24:27], s56 offen offset:2048 lds
  v_mfma_f32_16x16x32_bf16 v[160:163], a[220:223], a[12:15], v[160:163]
  v_add_u32 v10, 36864, v10
  v_mfma_f32_16x16x32_bf16 v[164:167], a[208:211], a[16:19], 0
  ds_read_b64_tr_b16 a[192:193], v10 offset:0
  v_mfma_f32_16x16x32_bf16 v[164:167], a[212:215], a[20:23], v[164:167]
  ds_read_b64_tr_b16 a[194:195], v10 offset:4608
  v_mfma_f32_16x16x32_bf16 v[164:167], a[216:219], a[24:27], v[164:167]
  ds_read_b64_tr_b16 a[196:197], v10 offset:9216
  v_mfma_f32_16x16x32_bf16 v[164:167], a[220:223], a[28:31], v[164:167]
  s_waitcnt lgkmcnt(3)
  ds_read_b64_tr_b16 a[198:199], v10 offset:13824
  v_mfma_f32_16x16x32_bf16 v[168:171], a[224:227], a[0:3], 0
  s_mov_b32 s59, 114688
  ds_read_b64_tr_b16 a[200:201], v10 offset:18432
  v_mfma_f32_16x16x32_bf16 v[168:171], a[228:231], a[4:7], v[168:171]
  ds_read_b64_tr_b16 a[202:203], v10 offset:23040
  ds_read_b64_tr_b16 a[204:205], v10 offset:27648
  ds_read_b64_tr_b16 a[206:207], v10 offset:32256
  v_mfma_f32_16x16x32_bf16 v[168:171], a[232:235], a[8:11], v[168:171]
  ds_read_b64_tr_b16 a[208:209], v10 offset:32
  buffer_store_dwordx4 v[72:75], v11, s[40:43], s59 offen sc1
  v_mfma_f32_16x16x32_bf16 v[168:171], a[236:239], a[12:15], v[168:171]
  ds_read_b64_tr_b16 a[210:211], v10 offset:4640
  v_mfma_f32_16x16x32_bf16 v[172:175], a[224:227], a[16:19], 0
  ds_read_b64_tr_b16 a[212:213], v10 offset:9248
  v_mfma_f32_16x16x32_bf16 v[172:175], a[228:231], a[20:23], v[172:175]
  ds_read_b64_tr_b16 a[214:215], v10 offset:13856
  v_mfma_f32_16x16x32_bf16 v[172:175], a[232:235], a[24:27], v[172:175]
  s_waitcnt vmcnt(19)
  ds_read_b64_tr_b16 a[216:217], v10 offset:18464
  v_mfma_f32_16x16x32_bf16 v[172:175], a[236:239], a[28:31], v[172:175]
  s_waitcnt lgkmcnt(5)
  s_barrier
  v_mfma_f32_16x16x32_bf16 v[224:227], a[192:195], a[32:35], v[224:227]
  ds_read_b64_tr_b16 a[218:219], v10 offset:23072
  s_mov_b32 s59, 155648
  buffer_store_dwordx4 v[76:79], v11, s[40:43], s59 offen sc1
  buffer_load_dwordx4 v4, s[24:27], s56 offen offset:3072 lds
  s_waitcnt vmcnt(10)
  v_mfma_f32_16x16x32_bf16 v[224:227], a[196:199], a[36:39], v[224:227]
  ds_read_b64_tr_b16 a[220:221], v10 offset:27680
  ds_read_b64_tr_b16 a[222:223], v10 offset:32288
  v_mfma_f32_16x16x32_bf16 v[224:227], a[200:203], a[40:43], v[224:227]
  v_subrev_u32 v20, s85, v20
  v_add_u32 v20, -3, v20
  v_cmp_gt_u32 s[22:23], 5, v20
  v_mfma_f32_16x16x32_bf16 v[224:227], a[204:207], a[44:47], v[224:227]
  ds_read_b64_tr_b16 a[224:225], v10 offset:64
  s_and_b32 s29, s22, 0xff
  s_cmp_eq_u32 s29, 0xff
  s_cbranch_scc0 L_slow_15
L_ok_14:
  v_mfma_f32_16x16x32_bf16 v[228:231], a[192:195], a[48:51], v[228:231]
  s_add_u32 m0, s64, 126976
  ds_read_b64_tr_b16 a[226:227], v10 offset:4672
  v_mfma_f32_16x16x32_bf16 v[228:231], a[196:199], a[52:55], v[228:231]
  ds_read_b64_tr_b16 a[228:229], v10 offset:9280
  buffer_load_dwordx4 v5, s[24:27], s56 offen lds
  v_mfma_f32_16x16x32_bf16 v[228:231], a[200:203], a[56:59], v[228:231]
  ds_read_b64_tr_b16 a[230:231], v10 offset:13888
  buffer_load_dwordx4 v6, s[24:27], s56 offen offset:1024 lds
  v_mfma_f32_16x16x32_bf16 v[228:231], a[204:207], a[60:63], v[228:231]
  s_waitcnt lgkmcnt(4)
  ds_read_b64_tr_b16 a[232:233], v10 offset:18496
  v_mfma_f32_16x16x32_bf16 v[232:235], a[208:211], a[32:35], v[232:235]
  ds_read_b64_tr_b16 a[234:235], v10 offset:23104
  v_mfma_f32_16x16x32_bf16 v[232:235], a[212:215], a[36:39], v[232:235]
  ds_read_b64_tr_b16 a[236:237], v10 offset:27712
  ds_read_b64_tr_b16 a[238:239], v10 offset:32320
  v_mfma_f32_16x16x32_bf16 v[232:235], a[216:219], a[40:43], v[232:235]
  ds_read_b64_tr_b16 a[192:193], v10 offset:96
  buffer_load_dwordx4 v7, s[24:27], s56 offen offset:2048 lds
  v_mfma_f32_16x16x32_bf16 v[232:235], a[220:223], a[44:47], v[232:235]
  ds_read_b64_tr_b16 a[194:195], v10 offset:4704
  v_mfma_f32_16x16x32_bf16 v[236:239], a[208:211], a[48:51], v[236:239]
  ds_read_b64_tr_b16 a[196:197], v10 offset:9312
  v_mfma_f32_16x16x32_bf16 v[236:239], a[212:215], a[52:55], v[236:239]
  ds_read_b64_tr_b16 a[198:199], v10 offset:13920
  v_mfma_f32_16x16x32_bf16 v[236:239], a[216:219], a[56:59], v[236:239]
  ds_read_b64_tr_b16 a[200:201], v10 offset:18528
  buffer_load_dwordx4 v8, s[24:27], s56 offen offset:3072 lds
  v_mfma_f32_16x16x32_bf16 v[236:239], a[220:223], a[60:63], v[236:239]
  s_waitcnt lgkmcnt(5)
  s_add_u32 m0, s64, 131072
  v_mfma_f32_16x16x32_bf16 v[240:243], a[224:227], a[32:35], v[240:243]
  ds_read_b64_tr_b16 a[202:203], v10 offset:23136
  v_mfma_f32_16x16x32_bf16 v[240:243], a[228:231], a[36:39], v[240:243]
  ds_read_b64_tr_b16 a[204:205], v10 offset:27744
  ds_read_b64_tr_b16 a[206:207], v10 offset:32352
  v_mfma_f32_16x16x32_bf16 v[240:243], a[232:235], a[40:43], v[240:243]
  ds_read_b64_tr_b16 a[208:209], v10 offset:128
  buffer_load_dwordx4 v9, s[24:27], s56 offen lds
  v_mfma_f32_16x16x32_bf16 v[240:243], a[236:239], a[44:47], v[240:243]
  s_add_u32 s90, s4, 0
  ds_read_b64_tr_b16 a[210:211], v10 offset:4736
  v_mfma_f32_16x16x32_bf16 v[244:247], a[224:227], a[48:51], v[244:247]
  ds_read_b64_tr_b16 a[212:213], v10 offset:9344
  v_mfma_f32_16x16x32_bf16 v[244:247], a[228:231], a[52:55], v[244:247]
  ds_read_b64_tr_b16 a[214:215], v10 offset:13952
  v_mfma_f32_16x16x32_bf16 v[244:247], a[232:235], a[56:59], v[244:247]
  ds_read_b64_tr_b16 a[216:217], v10 offset:18560
  v_mfma_f32_16x16x32_bf16 v[244:247], a[236:239], a[60:63], v[244:247]
  s_waitcnt lgkmcnt(5) vmcnt(27)
  s_barrier
  v_mfma_f32_16x16x32_bf16 v[248:251], a[192:195], a[32:35], v[248:251]
  ds_read_b64_tr_b16 a[218:219], v10 offset:23168
  buffer_load_dwordx4 a[96:99], v12, s[40:43], s90 offen offset:0 sc1
  v_mfma_f32_16x16x32_bf16 v[248:251], a[196:199], a[36:39], v[248:251]
  ds_read_b64_tr_b16 a[220:221], v10 offset:27776
  ds_read_b64_tr_b16 a[222:223], v10 offset:32384
  v_mfma_f32_16x16x32_bf16 v[248:251], a[200:203], a[40:43], v[248:251]
  s_add_u32 s28, s85, 4
  ds_read_b64_tr_b16 a[224:225], v10 offset:160
  v_mov_b32 v51, s28
  v_mfma_f32_16x16x32_bf16 v[248:251], a[204:207], a[44:47], v[248:251]
  ds_read_b64_tr_b16 a[226:227], v10 offset:4768
  buffer_store_dword v51, v60, s[40:43], s55 offen sc1
  v_mfma_f32_16x16x32_bf16 v[252:255], a[192:195], a[48:51], v[252:255]
  ds_read_b64_tr_b16 a[228:229], v10 offset:9376
  buffer_load_dwordx4 a[100:103], v12, s[40:43], s90 offen offset:1024 sc1
  v_mfma_f32_16x16x32_bf16 v[252:255], a[196:199], a[52:55], v[252:255]
  ds_read_b64_tr_b16 a[230:231], v10 offset:13984
  v_mfma_f32_16x16x32_bf16 v[252:255], a[200:203], a[56:59], v[252:255]
  ds_read_b64_tr_b16 a[232:233], v10 offset:18592
  v_mfma_f32_16x16x32_bf16 v[252:255], a[204:207], a[60:63], v[252:255]
  s_waitcnt lgkmcnt(5)
  ds_read_b64_tr_b16 a[234:235], v10 offset:23200
  v_mfma_f32_16x16x32_bf16 v[24:27], a[208:211], a[32:35], v[24:27]
  ds_read_b64_tr_b16 a[236:237], v10 offset:27808
  buffer_load_dwordx4 a[104:107], v12, s[40:43], s90 offen offset:2048 sc1
  v_mfma_f32_16x16x32_bf16 v[24:27], a[212:215], a[36:39], v[24:27]
  ds_read_b64_tr_b16 a[238:239], v10 offset:32416
  v_mfma_f32_16x16x32_bf16 v[24:27], a[216:219], a[40:43], v[24:27]
  ds_read_b64_tr_b16 a[192:193], v10 offset:192
  v_mfma_f32_16x16x32_bf16 v[24:27], a[220:223], a[44:47], v[24:27]
  ds_read_b64_tr_b16 a[194:195], v10 offset:4800
  buffer_load_dwordx4 a[108:111], v12, s[40:43], s90 offen offset:3072 sc1
  v_mfma_f32_16x16x32_bf16 v[28:31], a[208:211], a[48:51], v[28:31]
  s_add_u32 s90, s4, 40960
  ds_read_b64_tr_b16 a[196:197], v10 offset:9408
  v_mfma_f32_16x16x32_bf16 v[28:31], a[212:215], a[52:55], v[28:31]
  ds_read_b64_tr_b16 a[198:199], v10 offset:14016
  v_mfma_f32_16x16x32_bf16 v[28:31], a[216:219], a[56:59], v[28:31]
  ds_read_b64_tr_b16 a[200:201], v10 offset:18624
  v_mfma_f32_16x16x32_bf16 v[28:31], a[220:223], a[60:63], v[28:31]
  s_waitcnt lgkmcnt(5)
  ds_read_b64_tr_b16 a[202:203], v10 offset:23232
  v_mfma_f32_16x16x32_bf16 v[32:35], a[224:227], a[32:35], v[32:35]
  ds_read_b64_tr_b16 a[204:205], v10 offset:27840
  buffer_load_dwordx4 a[112:115], v12, s[40:43], s90 offen offset:0 sc1
  v_mfma_f32_16x16x32_bf16 v[32:35], a[228:231], a[36:39], v[32:35]
  ds_read_b64_tr_b16 a[206:207], v10 offset:32448
  v_mfma_f32_16x16x32_bf16 v[32:35], a[232:235], a[40:43], v[32:35]
  ds_read_b64_tr_b16 a[208:209], v10 offset:224
  v_mfma_f32_16x16x32_bf16 v[32:35], a[236:239], a[44:47], v[32:35]
  ds_read_b64_tr_b16 a[210:211], v10 offset:4832
  buffer_load_dwordx4 a[116:119], v12, s[40:43], s90 offen offset:1024 sc1
  v_mfma_f32_16x16x32_bf16 v[36:39], a[224:227], a[48:51], v[36:39]
  ds_read_b64_tr_b16 a[212:213], v10 offset:9440
  v_mfma_f32_16x16x32_bf16 v[36:39], a[228:231], a[52:55], v[36:39]
  ds_read_b64_tr_b16 a[214:215], v10 offset:14048
  v_mfma_f32_16x16x32_bf16 v[36:39], a[232:235], a[56:59], v[36:39]
  ds_read_b64_tr_b16 a[216:217], v10 offset:18656
  v_mfma_f32_16x16x32_bf16 v[36:39], a[236:239], a[60:63], v[36:39]
  s_waitcnt lgkmcnt(5)
  ds_read_b64_tr_b16 a[218:219], v10 offset:23264
  v_mfma_f32_16x16x32_bf16 v[40:43], a[192:195], a[32:35], v[40:43]
  ds_read_b64_tr_b16 a[220:221], v10 offset:27872
  buffer_load_dwordx4 a[120:123], v12, s[40:43], s90 offen offset:2048 sc1
  v_mfma_f32_16x16x32_bf16 v[40:43], a[196:199], a[36:39], v[40:43]
  ds_read_b64_tr_b16 a[222:223], v10 offset:32480
  v_mfma_f32_16x16x32_bf16 v[40:43], a[200:203], a[40:43], v[40:43]
  ds_read_b64_tr_b16 a[224:225], v10 offset:256
  v_mfma_f32_16x16x32_bf16 v[40:43], a[204:207], a[44:47], v[40:43]
  ds_read_b64_tr_b16 a[226:227], v10 offset:4864
  buffer_load_dwordx4 a[124:127], v12, s[40:43], s90 offen offset:3072 sc1
  v_mfma_f32_16x16x32_bf16 v[44:47], a[192:195], a[48:51], v[44:47]
  s_add_u32 m0, s64, 0
  s_add_u32 s56, s5, 73728
  v_mfma_f32_16x16x32_bf16 v[44:47], a[196:199], a[52:55], v[44:47]
  ds_read_b64_tr_b16 a[228:229], v10 offset:9472
  v_mfma_f32_16x16x32_bf16 v[44:47], a[200:203], a[56:59], v[44:47]
  ds_read_b64_tr_b16 a[230:231], v10 offset:14080
  v_mfma_f32_16x16x32_bf16 v[44:47], a[204:207], a[60:63], v[44:47]
  s_waitcnt lgkmcnt(4) vmcnt(56)
  s_barrier
  v_mfma_f32_16x16x32_bf16 v[160:163], a[208:211], a[32:35], v[160:163]
  ds_read_b64_tr_b16 a[232:233], v10 offset:18688
  buffer_load_dwordx4 v1, s[24:27], s56 offen lds
  v_mfma_f32_16x16x32_bf16 v[160:163], a[212:215], a[36:39], v[160:163]
  ds_read_b64_tr_b16 a[234:235], v10 offset:23296
  ds_read_b64_tr_b16 a[236:237], v10 offset:27904
  ds_read_b64_tr_b16 a[238:239], v10 offset:32512
  buffer_load_dwordx4 v2, s[24:27], s56 offen offset:1024 lds
  s_waitcnt vmcnt(17)
  s_barrier
  v_mfma_f32_16x16x32_bf16 v[160:163], a[216:219], a[40:43], v[160:163]
  buffer_load_dwordx4 v3, s[24:27], s56 offen offset:2048 lds
  v_mfma_f32_16x16x32_bf16 v[160:163], a[220:223], a[44:47], v[160:163]
  s_add_u32 s83, s71, 2
  s_cmp_ge_u32 s83, 9
  s_cselect_b32 s84, 9, 0
  s_sub_u32 s83, s83, s84
  v_mfma_f32_16x16x32_bf16 v[164:167], a[208:211], a[48:51], v[164:167]
  s_cmp_eq_u32 s51, 0
  s_cselect_b32 s69, 0, 0x7f000000
  v_mfma_f32_16x16x32_bf16 v[164:167], a[212:215], a[52:55], v[164:167]
  buffer_load_dwordx4 v4, s[24:27], s56 offen offset:3072 lds
  v_mfma_f32_16x16x32_bf16 v[164:167], a[216:219], a[56:59], v[164:167]
  s_add_u32 m0, s64, 4096
  s_add_u32 s28, s85, 5
  v_add_u32 v10, 36864, v10
  v_mfma_f32_16x16x32_bf16 v[164:167], a[220:223], a[60:63], v[164:167]
  s_waitcnt lgkmcnt(0)
  ds_read_b64_tr_b16 a[192:193], v10 offset:0
  v_mov_b32 v51, s28
  v_mfma_f32_16x16x32_bf16 v[168:171], a[224:227], a[32:35], v[168:171]
  ds_read_b64_tr_b16 a[194:195], v10 offset:4608
  buffer_store_dword v51, v60, s[40:43], s55 offen sc1
  v_mfma_f32_16x16x32_bf16 v[168:171], a[228:231], a[36:39], v[168:171]
  ds_read_b64_tr_b16 a[196:197], v10 offset:9216
  ds_read_b64_tr_b16 a[198:199], v10 offset:13824
  ds_read_b64_tr_b16 a[200:201], v10 offset:18432
  ds_read_b64_tr_b16 a[202:203], v10 offset:23040
  ds_read_b64_tr_b16 a[204:205], v10 offset:27648
  ds_read_b64_tr_b16 a[206:207], v10 offset:32256
  v_mfma_f32_16x16x32_bf16 v[168:171], a[232:235], a[40:43], v[168:171]
  ds_read_b64_tr_b16 a[208:209], v10 offset:32
  buffer_load_dwordx4 v5, s[24:27], s56 offen lds
  v_mfma_f32_16x16x32_bf16 v[168:171], a[236:239], a[44:47], v[168:171]
  s_lshl_b32 s89, s52, 2
  ds_read_b64_tr_b16 a[210:211], v10 offset:4640
  v_cmp_gt_u32 vcc, 4, v0
  v_mfma_f32_16x16x32_bf16 v[172:175], a[224:227], a[48:51], v[172:175]
  ds_read_b64_tr_b16 a[212:213], v10 offset:9248
  buffer_load_dwordx4 v6, s[24:27], s56 offen offset:1024 lds
  v_mfma_f32_16x16x32_bf16 v[172:175], a[228:231], a[52:55], v[172:175]
  s_add_u32 s89, s89, s53
  ds_read_b64_tr_b16 a[214:215], v10 offset:13856
  v_or_b32 v198, 0x7f000000, v60
  v_mfma_f32_16x16x32_bf16 v[172:175], a[232:235], a[56:59], v[172:175]
  s_waitcnt vmcnt(28)
  ds_read_b64_tr_b16 a[216:217], v10 offset:18464
  v_lshrrev_b32 v199, 4, v0
  v_mfma_f32_16x16x32_bf16 v[172:175], a[236:239], a[60:63], v[172:175]
  s_waitcnt lgkmcnt(5)
  s_barrier
  v_mfma_f32_16x16x32_bf16 v[224:227], a[192:195], a[64:67], v[224:227]
  ds_read_b64_tr_b16 a[218:219], v10 offset:23072
  buffer_load_dwordx4 v7, s[24:27], s56 offen offset:2048 lds
  v_mfma_f32_16x16x32_bf16 v[224:227], a[196:199], a[68:71], v[224:227]
  ds_read_b64_tr_b16 a[220:221], v10 offset:27680
  ds_read_b64_tr_b16 a[222:223], v10 offset:32288
  v_mfma_f32_16x16x32_bf16 v[224:227], a[200:203], a[72:75], v[224:227]
  s_lshl_b32 s89, s89, 2
  ds_read_b64_tr_b16 a[224:225], v10 offset:64
  v_mov_b32 v200, 0x3f80
  v_mfma_f32_16x16x32_bf16 v[224:227], a[204:207], a[76:79], v[224:227]
  s_max_u32 s84, s83, 1
  ds_read_b64_tr_b16 a[226:227], v10 offset:4672
  v_add_u32 v205, 0, v0
  v_mfma_f32_16x16x32_bf16 v[228:231], a[192:195], a[80:83], v[228:231]
  s_sub_u32 s84, s84, 1
  ds_read_b64_tr_b16 a[228:229], v10 offset:9280
  v_mul_u32_u24 v206, 10923, v205
  v_mfma_f32_16x16x32_bf16 v[228:231], a[196:199], a[84:87], v[228:231]
  ds_read_b64_tr_b16 a[230:231], v10 offset:13888
  buffer_load_dwordx4 v8, s[24:27], s56 offen offset:3072 lds
  v_mfma_f32_16x16x32_bf16 v[228:231], a[200:203], a[88:91], v[228:231]
  s_add_u32 m0, s64, 8192
  ds_read_b64_tr_b16 a[232:233], v10 offset:18496
  v_lshrrev_b32 v206, 16, v206
  v_mfma_f32_16x16x32_bf16 v[228:231], a[204:207], a[92:95], v[228:231]
  s_waitcnt lgkmcnt(5)
  ds_read_b64_tr_b16 a[234:235], v10 offset:23104
  v_mul_u32_u24 v207, 6, v206
  v_mfma_f32_16x16x32_bf16 v[232:235], a[208:211], a[64:67], v[232:235]
  s_lshr_b32 s84, s84, 1
  ds_read_b64_tr_b16 a[236:237], v10 offset:27712
  v_sub_u32 v205, v205, v207
  v_mfma_f32_16x16x32_bf16 v[232:235], a[212:215], a[68:71], v[232:235]
  s_lshl_b32 s68, s84, 1
  ds_read_b64_tr_b16 a[238:239], v10 offset:32320
  v_mul_u32_u24 v207, 112, v206
  v_mfma_f32_16x16x32_bf16 v[232:235], a[216:219], a[72:75], v[232:235]
  ds_read_b64_tr_b16 a[192:193], v10 offset:96
  buffer_load_dwordx4 v9, s[24:27], s56 offen lds
  v_mfma_f32_16x16x32_bf16 v[232:235], a[220:223], a[76:79], v[232:235]
  s_add_u32 s90, s11, 16384
  ds_read_b64_tr_b16 a[194:195], v10 offset:4704
  v_mov_b32 v98, 0
  v_mfma_f32_16x16x32_bf16 v[236:239], a[208:211], a[80:83], v[236:239]
  s_sub_u32 s83, s83, s68
  ds_read_b64_tr_b16 a[196:197], v10 offset:9312
  v_mov_b32 v99, 0
  v_mfma_f32_16x16x32_bf16 v[236:239], a[212:215], a[84:87], v[236:239]
  s_min_u32 s68, s84, 1
  ds_read_b64_tr_b16 a[198:199], v10 offset:13920
  v_mov_b32 v100, 0
  v_mfma_f32_16x16x32_bf16 v[236:239], a[216:219], a[88:91], v[236:239]
  ds_read_b64_tr_b16 a[200:201], v10 offset:18528
  buffer_load_dwordx4 a[128:131], v12, s[40:43], s90 offen offset:0 sc1
  v_mfma_f32_16x16x32_bf16 v[236:239], a[220:223], a[92:95], v[236:239]
  s_waitcnt lgkmcnt(5)
  ds_read_b64_tr_b16 a[202:203], v10 offset:23136
  v_mov_b32 v101, 0
  v_mfma_f32_16x16x32_bf16 v[240:243], a[224:227], a[64:67], v[240:243]
  s_sub_u32 s83, s83, s68
  ds_read_b64_tr_b16 a[204:205], v10 offset:27744
  v_mfma_f32_16x16x32_bf16 v[240:243], a[228:231], a[68:71], v[240:243]
  s_add_u32 s86, s89, s84
  ds_read_b64_tr_b16 a[206:207], v10 offset:32352
  v_mfma_f32_16x16x32_bf16 v[240:243], a[232:235], a[72:75], v[240:243]
  ds_read_b64_tr_b16 a[208:209], v10 offset:128
  buffer_load_dwordx4 a[132:135], v12, s[40:43], s90 offen offset:1024 sc1
  v_mfma_f32_16x16x32_bf16 v[240:243], a[236:239], a[76:79], v[240:243]
  s_mul_i32 s86, s86, 49152
  ds_read_b64_tr_b16 a[210:211], v10 offset:4736
  v_mfma_f32_16x16x32_bf16 v[244:247], a[224:227], a[80:83], v[244:247]
  s_lshl_b32 s83, s83, 10
  ds_read_b64_tr_b16 a[212:213], v10 offset:9344
  v_mfma_f32_16x16x32_bf16 v[244:247], a[228:231], a[84:87], v[244:247]
  s_add_u32 s86, s86, s83
  ds_read_b64_tr_b16 a[214:215], v10 offset:13952
  v_mfma_f32_16x16x32_bf16 v[244:247], a[232:235], a[88:91], v[244:247]
  ds_read_b64_tr_b16 a[216:217], v10 offset:18560
  s_cmp_eq_u32 s84, s51
  s_cselect_b32 s86, 0x7f000000, s86
  v_mfma_f32_16x16x32_bf16 v[244:247], a[236:239], a[92:95], v[244:247]
  s_waitcnt lgkmcnt(5)
  ds_read_b64_tr_b16 a[218:219], v10 offset:23168
  v_mfma_f32_16x16x32_bf16 v[248:251], a[192:195], a[64:67], v[248:251]
  ds_read_b64_tr_b16 a[220:221], v10 offset:27776
  s_add_u32 s83, s71, 3
  s_cmp_ge_u32 s83, 9
  s_cselect_b32 s84, 9, 0
  s_sub_u32 s83, s83, s84
  v_mfma_f32_16x16x32_bf16 v[248:251], a[196:199], a[68:71], v[248:251]
  s_max_u32 s84, s83, 1
  ds_read_b64_tr_b16 a[222:223], v10 offset:32384
  v_mfma_f32_16x16x32_bf16 v[248:251], a[200:203], a[72:75], v[248:251]
  ds_read_b64_tr_b16 a[224:225], v10 offset:160
  buffer_load_dwordx4 a[136:139], v12, s[40:43], s90 offen offset:2048 sc1
  v_mfma_f32_16x16x32_bf16 v[248:251], a[204:207], a[76:79], v[248:251]
  ds_read_b64_tr_b16 a[226:227], v10 offset:4768
  buffer_load_dwordx4 a[140:143], v12, s[40:43], s90 offen offset:3072 sc1
  v_mfma_f32_16x16x32_bf16 v[252:255], a[192:195], a[80:83], v[252:255]
  s_add_u32 s90, s11, 57344
  ds_read_b64_tr_b16 a[228:229], v10 offset:9376
  v_mfma_f32_16x16x32_bf16 v[252:255], a[196:199], a[84:87], v[252:255]
  s_sub_u32 s84, s84, 1
  ds_read_b64_tr_b16 a[230:231], v10 offset:13984
  v_mfma_f32_16x16x32_bf16 v[252:255], a[200:203], a[88:91], v[252:255]
  ds_read_b64_tr_b16 a[232:233], v10 offset:18592
  buffer_load_dwordx4 a[144:147], v12, s[40:43], s90 offen offset:0 sc1
  v_mfma_f32_16x16x32_bf16 v[252:255], a[204:207], a[92:95], v[252:255]
  s_waitcnt lgkmcnt(5)
  ds_read_b64_tr_b16 a[234:235], v10 offset:23200
  v_mfma_f32_16x16x32_bf16 v[24:27], a[208:211], a[64:67], v[24:27]
  s_lshr_b32 s84, s84, 1
  ds_read_b64_tr_b16 a[236:237], v10 offset:27808
  v_mfma_f32_16x16x32_bf16 v[24:27], a[212:215], a[68:71], v[24:27]
  s_lshl_b32 s68, s84, 1
  ds_read_b64_tr_b16 a[238:239], v10 offset:32416
  v_mfma_f32_16x16x32_bf16 v[24:27], a[216:219], a[72:75], v[24:27]
  ds_read_b64_tr_b16 a[192:193], v10 offset:192
  buffer_load_dwordx4 a[148:151], v12, s[40:43], s90 offen offset:1024 sc1
  v_mfma_f32_16x16x32_bf16 v[24:27], a[220:223], a[76:79], v[24:27]
  s_sub_u32 s83, s83, s68
  ds_read_b64_tr_b16 a[194:195], v10 offset:4800
  v_mfma_f32_16x16x32_bf16 v[28:31], a[208:211], a[80:83], v[28:31]
  s_min_u32 s68, s84, 1
  ds_read_b64_tr_b16 a[196:197], v10 offset:9408
  v_mfma_f32_16x16x32_bf16 v[28:31], a[212:215], a[84:87], v[28:31]
  s_sub_u32 s83, s83, s68
  ds_read_b64_tr_b16 a[198:199], v10 offset:14016
  v_mfma_f32_16x16x32_bf16 v[28:31], a[216:219], a[88:91], v[28:31]
  ds_read_b64_tr_b16 a[200:201], v10 offset:18624
  buffer_load_dwordx4 a[152:155], v12, s[40:43], s90 offen offset:2048 sc1
  v_mfma_f32_16x16x32_bf16 v[28:31], a[220:223], a[92:95], v[28:31]
  s_waitcnt lgkmcnt(5)
  ds_read_b64_tr_b16 a[202:203], v10 offset:23232
  v_mfma_f32_16x16x32_bf16 v[32:35], a[224:227], a[64:67], v[32:35]
  s_add_u32 s87, s89, s84
  ds_read_b64_tr_b16 a[204:205], v10 offset:27840
  v_mfma_f32_16x16x32_bf16 v[32:35], a[228:231], a[68:71], v[32:35]
  s_mul_i32 s87, s87, 49152
  ds_read_b64_tr_b16 a[206:207], v10 offset:32448
  v_mfma_f32_16x16x32_bf16 v[32:35], a[232:235], a[72:75], v[32:35]
  s_lshl_b32 s83, s83, 10
  ds_read_b64_tr_b16 a[208:209], v10 offset:224
  v_mfma_f32_16x16x32_bf16 v[32:35], a[236:239], a[76:79], v[32:35]
  ds_read_b64_tr_b16 a[210:211], v10 offset:4832
  buffer_load_dwordx4 a[156:159], v12, s[40:43], s90 offen offset:3072 sc1
  v_mfma_f32_16x16x32_bf16 v[36:39], a[224:227], a[80:83], v[36:39]
  s_add_u32 m0, s64, 36864
  s_add_u32 s56, s6, 73728
  s_add_u32 s87, s87, s83
  v_mfma_f32_16x16x32_bf16 v[36:39], a[228:231], a[84:87], v[36:39]
  ds_read_b64_tr_b16 a[212:213], v10 offset:9440
  s_add_u32 s83, s71, 4
  s_cmp_ge_u32 s83, 9
  s_cselect_b32 s84, 9, 0
  s_sub_u32 s83, s83, s84
  v_mfma_f32_16x16x32_bf16 v[36:39], a[232:235], a[88:91], v[36:39]
  ds_read_b64_tr_b16 a[214:215], v10 offset:14048
  buffer_load_dwordx4 v1, s[24:27], s56 offen lds
  v_mfma_f32_16x16x32_bf16 v[36:39], a[236:239], a[92:95], v[36:39]
  s_waitcnt lgkmcnt(4)
  ds_read_b64_tr_b16 a[216:217], v10 offset:18656
  v_mfma_f32_16x16x32_bf16 v[40:43], a[192:195], a[64:67], v[40:43]
  s_max_u32 s84, s83, 1
  ds_read_b64_tr_b16 a[218:219], v10 offset:23264
  v_mfma_f32_16x16x32_bf16 v[40:43], a[196:199], a[68:71], v[40:43]
  ds_read_b64_tr_b16 a[220:221], v10 offset:27872
  ds_read_b64_tr_b16 a[222:223], v10 offset:32480
  v_mfma_f32_16x16x32_bf16 v[40:43], a[200:203], a[72:75], v[40:43]
  s_sub_u32 s84, s84, 1
  ds_read_b64_tr_b16 a[224:225], v10 offset:256
  v_mfma_f32_16x16x32_bf16 v[40:43], a[204:207], a[76:79], v[40:43]
  ds_read_b64_tr_b16 a[226:227], v10 offset:4864
  buffer_load_dwordx4 v2, s[24:27], s56 offen offset:1024 lds
  v_mfma_f32_16x16x32_bf16 v[44:47], a[192:195], a[80:83], v[44:47]
  s_lshr_b32 s84, s84, 1
  ds_read_b64_tr_b16 a[228:229], v10 offset:9472
  v_mfma_f32_16x16x32_bf16 v[44:47], a[196:199], a[84:87], v[44:47]
  s_lshl_b32 s68, s84, 1
  ds_read_b64_tr_b16 a[230:231], v10 offset:14080
  v_mfma_f32_16x16x32_bf16 v[44:47], a[200:203], a[88:91], v[44:47]
  s_sub_u32 s83, s83, s68
  ds_read_b64_tr_b16 a[232:233], v10 offset:18688
  v_mfma_f32_16x16x32_bf16 v[44:47], a[204:207], a[92:95], v[44:47]
  s_waitcnt lgkmcnt(5) vmcnt(29)
  s_barrier
  v_mfma_f32_16x16x32_bf16 v[160:163], a[208:211], a[64:67], v[160:163]
  ds_read_b64_tr_b16 a[234:235], v10 offset:23296
  buffer_load_dwordx4 v3, s[24:27], s56 offen offset:2048 lds
  v_mfma_f32_16x16x32_bf16 v[160:163], a[212:215], a[68:71], v[160:163]
  ds_read_b64_tr_b16 a[236:237], v10 offset:27904
  ds_read_b64_tr_b16 a[238:239], v10 offset:32512
  v_mfma_f32_16x16x32_bf16 v[160:163], a[216:219], a[72:75], v[160:163]
  s_min_u32 s68, s84, 1
  s_sub_u32 s83, s83, s68
  v_add_u32 v10, 49152, v10
  v_mfma_f32_16x16x32_bf16 v[160:163], a[220:223], a[76:79], v[160:163]
  s_add_u32 s3, s89, s84
  ds_read_b64_tr_b16 a[192:193], v10 offset:0
  v_mfma_f32_16x16x32_bf16 v[164:167], a[208:211], a[80:83], v[164:167]
  ds_read_b64_tr_b16 a[194:195], v10 offset:4608
  buffer_load_dwordx4 v4, s[24:27], s56 offen offset:3072 lds
  v_mfma_f32_16x16x32_bf16 v[164:167], a[212:215], a[84:87], v[164:167]
  s_add_u32 m0, s64, 40960
  ds_read_b64_tr_b16 a[196:197], v10 offset:9216
  v_mfma_f32_16x16x32_bf16 v[164:167], a[216:219], a[88:91], v[164:167]
  s_mul_i32 s3, s3, 49152
  ds_read_b64_tr_b16 a[198:199], v10 offset:13824
  v_mfma_f32_16x16x32_bf16 v[164:167], a[220:223], a[92:95], v[164:167]
  s_waitcnt lgkmcnt(4)
  ds_read_b64_tr_b16 a[200:201], v10 offset:18432
  v_mfma_f32_16x16x32_bf16 v[168:171], a[224:227], a[64:67], v[168:171]
  s_lshl_b32 s83, s83, 10
  ds_read_b64_tr_b16 a[202:203], v10 offset:23040
  v_mfma_f32_16x16x32_bf16 v[168:171], a[228:231], a[68:71], v[168:171]
  ds_read_b64_tr_b16 a[204:205], v10 offset:27648
  ds_read_b64_tr_b16 a[206:207], v10 offset:32256
  v_mfma_f32_16x16x32_bf16 v[168:171], a[232:235], a[72:75], v[168:171]
  ds_read_b64_tr_b16 a[208:209], v10 offset:32
  buffer_load_dwordx4 v5, s[24:27], s56 offen lds
  v_mfma_f32_16x16x32_bf16 v[168:171], a[236:239], a[76:79], v[168:171]
  s_add_u32 s3, s3, s83
  ds_read_b64_tr_b16 a[210:211], v10 offset:4640
  v_mfma_f32_16x16x32_bf16 v[172:175], a[224:227], a[80:83], v[172:175]
  ds_read_b64_tr_b16 a[212:213], v10 offset:9248
  s_add_u32 s83, s71, 5
  s_cmp_ge_u32 s83, 9
  s_cselect_b32 s84, 9, 0
  s_sub_u32 s83, s83, s84
  v_mfma_f32_16x16x32_bf16 v[172:175], a[228:231], a[84:87], v[172:175]
  ds_read_b64_tr_b16 a[214:215], v10 offset:13856
  buffer_load_dwordx4 v6, s[24:27], s56 offen offset:1024 lds
  v_mfma_f32_16x16x32_bf16 v[172:175], a[232:235], a[88:91], v[172:175]
  s_waitcnt vmcnt(24)
  ds_read_b64_tr_b16 a[216:217], v10 offset:18464
  v_mfma_f32_16x16x32_bf16 v[172:175], a[236:239], a[92:95], v[172:175]
  s_waitcnt lgkmcnt(5)
  s_barrier
  v_mfma_f32_16x16x32_bf16 v[224:227], a[192:195], a[96:99], v[224:227]
  s_max_u32 s84, s83, 1
  ds_read_b64_tr_b16 a[218:219], v10 offset:23072
  v_mfma_f32_16x16x32_bf16 v[224:227], a[196:199], a[100:103], v[224:227]
  ds_read_b64_tr_b16 a[220:221], v10 offset:27680
  ds_read_b64_tr_b16 a[222:223], v10 offset:32288
  v_mfma_f32_16x16x32_bf16 v[224:227], a[200:203], a[104:107], v[224:227]
  ds_read_b64_tr_b16 a[224:225], v10 offset:64
  buffer_load_dwordx4 v7, s[24:27], s56 offen offset:2048 lds
  v_mfma_f32_16x16x32_bf16 v[224:227], a[204:207], a[108:111], v[224:227]
  s_sub_u32 s84, s84, 1
  ds_read_b64_tr_b16 a[226:227], v10 offset:4672
  v_mfma_f32_16x16x32_bf16 v[228:231], a[192:195], a[112:115], v[228:231]
  s_lshr_b32 s84, s84, 1
  ds_read_b64_tr_b16 a[228:229], v10 offset:9280
  v_mfma_f32_16x16x32_bf16 v[228:231], a[196:199], a[116:119], v[228:231]
  s_lshl_b32 s68, s84, 1
  ds_read_b64_tr_b16 a[230:231], v10 offset:13888
  v_mfma_f32_16x16x32_bf16 v[228:231], a[200:203], a[120:123], v[228:231]
  ds_read_b64_tr_b16 a[232:233], v10 offset:18496
  buffer_load_dwordx4 v8, s[24:27], s56 offen offset:3072 lds
  v_mfma_f32_16x16x32_bf16 v[228:231], a[204:207], a[124:127], v[228:231]
  s_waitcnt lgkmcnt(5)
  s_add_u32 m0, s64, 45056
  s_sub_u32 s83, s83, s68
  v_mfma_f32_16x16x32_bf16 v[232:235], a[208:211], a[96:99], v[232:235]
  s_min_u32 s68, s84, 1
  ds_read_b64_tr_b16 a[234:235], v10 offset:23104
  v_mfma_f32_16x16x32_bf16 v[232:235], a[212:215], a[100:103], v[232:235]
  ds_read_b64_tr_b16 a[236:237], v10 offset:27712
  ds_read_b64_tr_b16 a[238:239], v10 offset:32320
  v_mfma_f32_16x16x32_bf16 v[232:235], a[216:219], a[104:107], v[232:235]
  s_sub_u32 s83, s83, s68
  ds_read_b64_tr_b16 a[192:193], v10 offset:96
  v_mfma_f32_16x16x32_bf16 v[232:235], a[220:223], a[108:111], v[232:235]
  ds_read_b64_tr_b16 a[194:195], v10 offset:4704
  buffer_load_dwordx4 v9, s[24:27], s56 offen lds
  v_mfma_f32_16x16x32_bf16 v[236:239], a[208:211], a[112:115], v[236:239]
  s_add_u32 s90, s72, 16384
  ds_read_b64_tr_b16 a[196:197], v10 offset:9312
  v_mfma_f32_16x16x32_bf16 v[236:239], a[212:215], a[116:119], v[236:239]
  s_add_u32 s100, s89, s84
  ds_read_b64_tr_b16 a[198:199], v10 offset:13920
  v_mfma_f32_16x16x32_bf16 v[236:239], a[216:219], a[120:123], v[236:239]
  s_mul_i32 s100, s100, 49152
  ds_read_b64_tr_b16 a[200:201], v10 offset:18528
  v_mfma_f32_16x16x32_bf16 v[236:239], a[220:223], a[124:127], v[236:239]
  s_waitcnt lgkmcnt(5)
  ds_read_b64_tr_b16 a[202:203], v10 offset:23136
  v_mfma_f32_16x16x32_bf16 v[240:243], a[224:227], a[96:99], v[240:243]
  ds_read_b64_tr_b16 a[204:205], v10 offset:27744
  buffer_load_dwordx4 a[160:163], v12, s[40:43], s90 offen offset:0 sc1
  v_mfma_f32_16x16x32_bf16 v[240:243], a[228:231], a[100:103], v[240:243]
  s_lshl_b32 s83, s83, 10
  ds_read_b64_tr_b16 a[206:207], v10 offset:32352
  v_mfma_f32_16x16x32_bf16 v[240:243], a[232:235], a[104:107], v[240:243]
  s_add_u32 s100, s100, s83
  ds_read_b64_tr_b16 a[208:209], v10 offset:128
  v_mfma_f32_16x16x32_bf16 v[240:243], a[236:239], a[108:111], v[240:243]
  ds_read_b64_tr_b16 a[210:211], v10 offset:4736
  s_add_u32 s83, s71, 6
  s_cmp_ge_u32 s83, 9
  s_cselect_b32 s84, 9, 0
  s_sub_u32 s83, s83, s84
  v_mfma_f32_16x16x32_bf16 v[244:247], a[224:227], a[112:115], v[244:247]
  ds_read_b64_tr_b16 a[212:213], v10 offset:9344
  buffer_load_dwordx4 a[164:167], v12, s[40:43], s90 offen offset:1024 sc1
  v_mfma_f32_16x16x32_bf16 v[244:247], a[228:231], a[116:119], v[244:247]
  s_max_u32 s84, s83, 1
  ds_read_b64_tr_b16 a[214:215], v10 offset:13952
  v_mfma_f32_16x16x32_bf16 v[244:247], a[232:235], a[120:123], v[244:247]
  s_sub_u32 s84, s84, 1
  ds_read_b64_tr_b16 a[216:217], v10 offset:18560
  v_mfma_f32_16x16x32_bf16 v[244:247], a[236:239], a[124:127], v[244:247]
  s_waitcnt lgkmcnt(5)
  ds_read_b64_tr_b16 a[218:219], v10 offset:23168
  v_mfma_f32_16x16x32_bf16 v[248:251], a[192:195], a[96:99], v[248:251]
  ds_read_b64_tr_b16 a[220:221], v10 offset:27776
  buffer_load_dwordx4 a[168:171], v12, s[40:43], s90 offen offset:2048 sc1
  v_mfma_f32_16x16x32_bf16 v[248:251], a[196:199], a[100:103], v[248:251]
  s_lshr_b32 s84, s84, 1
  ds_read_b64_tr_b16 a[222:223], v10 offset:32384
  v_mfma_f32_16x16x32_bf16 v[248:251], a[200:203], a[104:107], v[248:251]
  s_lshl_b32 s68, s84, 1
  ds_read_b64_tr_b16 a[224:225], v10 offset:160
  v_mfma_f32_16x16x32_bf16 v[248:251], a[204:207], a[108:111], v[248:251]
  ds_read_b64_tr_b16 a[226:227], v10 offset:4768
  buffer_load_dwordx4 a[172:175], v12, s[40:43], s90 offen offset:3072 sc1
  v_mfma_f32_16x16x32_bf16 v[252:255], a[192:195], a[112:115], v[252:255]
  s_add_u32 s90, s72, 57344
  ds_read_b64_tr_b16 a[228:229], v10 offset:9376
  v_mfma_f32_16x16x32_bf16 v[252:255], a[196:199], a[116:119], v[252:255]
  s_sub_u32 s83, s83, s68
  ds_read_b64_tr_b16 a[230:231], v10 offset:13984
  v_mfma_f32_16x16x32_bf16 v[252:255], a[200:203], a[120:123], v[252:255]
  s_min_u32 s68, s84, 1
  ds_read_b64_tr_b16 a[232:233], v10 offset:18592
  v_mfma_f32_16x16x32_bf16 v[252:255], a[204:207], a[124:127], v[252:255]
  s_waitcnt lgkmcnt(5)
  ds_read_b64_tr_b16 a[234:235], v10 offset:23200
  v_mfma_f32_16x16x32_bf16 v[24:27], a[208:211], a[96:99], v[24:27]
  ds_read_b64_tr_b16 a[236:237], v10 offset:27808
  buffer_load_dwordx4 a[176:179], v12, s[40:43], s90 offen offset:0 sc1
  v_mfma_f32_16x16x32_bf16 v[24:27], a[212:215], a[100:103], v[24:27]
  s_sub_u32 s83, s83, s68
  ds_read_b64_tr_b16 a[238:239], v10 offset:32416
  v_mfma_f32_16x16x32_bf16 v[24:27], a[216:219], a[104:107], v[24:27]
  s_add_u32 s101, s89, s84
  ds_read_b64_tr_b16 a[192:193], v10 offset:192
  v_mfma_f32_16x16x32_bf16 v[24:27], a[220:223], a[108:111], v[24:27]
  ds_read_b64_tr_b16 a[194:195], v10 offset:4800
  buffer_load_dwordx4 a[180:183], v12, s[40:43], s90 offen offset:1024 sc1
  v_mfma_f32_16x16x32_bf16 v[28:31], a[208:211], a[112:115], v[28:31]
  s_mul_i32 s101, s101, 49152
  ds_read_b64_tr_b16 a[196:197], v10 offset:9408
  v_mfma_f32_16x16x32_bf16 v[28:31], a[212:215], a[116:119], v[28:31]
  s_lshl_b32 s83, s83, 10
  ds_read_b64_tr_b16 a[198:199], v10 offset:14016
  v_mfma_f32_16x16x32_bf16 v[28:31], a[216:219], a[120:123], v[28:31]
  s_add_u32 s101, s101, s83
  ds_read_b64_tr_b16 a[200:201], v10 offset:18624
  v_mfma_f32_16x16x32_bf16 v[28:31], a[220:223], a[124:127], v[28:31]
  s_waitcnt lgkmcnt(5)
  ds_read_b64_tr_b16 a[202:203], v10 offset:23232
  v_mfma_f32_16x16x32_bf16 v[32:35], a[224:227], a[96:99], v[32:35]
  ds_read_b64_tr_b16 a[204:205], v10 offset:27840
  s_add_u32 s83, s71, 7
  s_cmp_ge_u32 s83, 9
  s_cselect_b32 s84, 9, 0
  s_sub_u32 s83, s83, s84
  v_mfma_f32_16x16x32_bf16 v[32:35], a[228:231], a[100:103], v[32:35]
  s_max_u32 s84, s83, 1
  ds_read_b64_tr_b16 a[206:207], v10 offset:32448
  v_mfma_f32_16x16x32_bf16 v[32:35], a[232:235], a[104:107], v[32:35]
  ds_read_b64_tr_b16 a[208:209], v10 offset:224
  buffer_load_dwordx4 a[184:187], v12, s[40:43], s90 offen offset:2048 sc1
  v_mfma_f32_16x16x32_bf16 v[32:35], a[236:239], a[108:111], v[32:35]
  ds_read_b64_tr_b16 a[210:211], v10 offset:4832
  buffer_load_dwordx4 a[188:191], v12, s[40:43], s90 offen offset:3072 sc1
  v_mfma_f32_16x16x32_bf16 v[36:39], a[224:227], a[112:115], v[36:39]
  s_add_u32 m0, s64, 73728
  s_add_u32 s56, s5, 110592
  s_sub_u32 s84, s84, 1
  v_mfma_f32_16x16x32_bf16 v[36:39], a[228:231], a[116:119], v[36:39]
  s_lshr_b32 s84, s84, 1
  ds_read_b64_tr_b16 a[212:213], v10 offset:9440
  v_mfma_f32_16x16x32_bf16 v[36:39], a[232:235], a[120:123], v[36:39]
  s_lshl_b32 s68, s84, 1
  ds_read_b64_tr_b16 a[214:215], v10 offset:14048
  v_mfma_f32_16x16x32_bf16 v[36:39], a[236:239], a[124:127], v[36:39]
  s_waitcnt lgkmcnt(4)
  ds_read_b64_tr_b16 a[216:217], v10 offset:18656
  v_mfma_f32_16x16x32_bf16 v[40:43], a[192:195], a[96:99], v[40:43]
  ds_read_b64_tr_b16 a[218:219], v10 offset:23264
  buffer_load_dwordx4 v1, s[24:27], s56 offen lds
  v_mfma_f32_16x16x32_bf16 v[40:43], a[196:199], a[100:103], v[40:43]
  ds_read_b64_tr_b16 a[220:221], v10 offset:27872
  ds_read_b64_tr_b16 a[222:223], v10 offset:32480
  v_mfma_f32_16x16x32_bf16 v[40:43], a[200:203], a[104:107], v[40:43]
  ds_read_b64_tr_b16 a[224:225], v10 offset:256
  buffer_load_dword v20, v21, s[40:43], 0 offen sc1
  v_mfma_f32_16x16x32_bf16 v[40:43], a[204:207], a[108:111], v[40:43]
  s_sub_u32 s83, s83, s68
  ds_read_b64_tr_b16 a[226:227], v10 offset:4864
  v_mfma_f32_16x16x32_bf16 v[44:47], a[192:195], a[112:115], v[44:47]
  ds_read_b64_tr_b16 a[228:229], v10 offset:9472
  buffer_load_dwordx4 v2, s[24:27], s56 offen offset:1024 lds
  v_mfma_f32_16x16x32_bf16 v[44:47], a[196:199], a[116:119], v[44:47]
  s_min_u32 s68, s84, 1
  ds_read_b64_tr_b16 a[230:231], v10 offset:14080
  v_mfma_f32_16x16x32_bf16 v[44:47], a[200:203], a[120:123], v[44:47]
  s_sub_u32 s83, s83, s68
  ds_read_b64_tr_b16 a[232:233], v10 offset:18688
  v_mfma_f32_16x16x32_bf16 v[44:47], a[204:207], a[124:127], v[44:47]
  s_waitcnt lgkmcnt(5) vmcnt(28)
  s_barrier
  v_mfma_f32_16x16x32_bf16 v[160:163], a[208:211], a[96:99], v[160:163]
  s_add_u32 s97, s89, s84
  ds_read_b64_tr_b16 a[234:235], v10 offset:23296
  v_mfma_f32_16x16x32_bf16 v[160:163], a[212:215], a[100:103], v[160:163]
  ds_read_b64_tr_b16 a[236:237], v10 offset:27904
  ds_read_b64_tr_b16 a[238:239], v10 offset:32512
  v_mfma_f32_16x16x32_bf16 v[160:163], a[216:219], a[104:107], v[160:163]
  buffer_load_dwordx4 v3, s[24:27], s56 offen offset:2048 lds
  v_mfma_f32_16x16x32_bf16 v[160:163], a[220:223], a[108:111], v[160:163]
  s_mul_i32 s97, s97, 49152
  s_lshl_b32 s83, s83, 10
  v_subrev_u32 v10, 122880, v10
  v_mfma_f32_16x16x32_bf16 v[164:167], a[208:211], a[112:115], v[164:167]
  s_add_u32 s97, s97, s83
  ds_read_b64_tr_b16 a[192:193], v10 offset:0
  v_mfma_f32_16x16x32_bf16 v[164:167], a[212:215], a[116:119], v[164:167]
  ds_read_b64_tr_b16 a[194:195], v10 offset:4608
  s_add_u32 s83, s71, 8
  s_cmp_ge_u32 s83, 9
  s_cselect_b32 s84, 9, 0
  s_sub_u32 s83, s83, s84
  v_mfma_f32_16x16x32_bf16 v[164:167], a[216:219], a[120:123], v[164:167]
  ds_read_b64_tr_b16 a[196:197], v10 offset:9216
  buffer_load_dwordx4 v4, s[24:27], s56 offen offset:3072 lds
  v_mfma_f32_16x16x32_bf16 v[164:167], a[220:223], a[124:127], v[164:167]
  s_waitcnt lgkmcnt(3)
  s_add_u32 m0, s64, 77824
  s_max_u32 s84, s83, 1
  v_mfma_f32_16x16x32_bf16 v[168:171], a[224:227], a[96:99], v[168:171]
  s_sub_u32 s84, s84, 1
  ds_read_b64_tr_b16 a[198:199], v10 offset:13824
  v_mfma_f32_16x16x32_bf16 v[168:171], a[228:231], a[100:103], v[168:171]
  ds_read_b64_tr_b16 a[200:201], v10 offset:18432
  ds_read_b64_tr_b16 a[202:203], v10 offset:23040
  ds_read_b64_tr_b16 a[204:205], v10 offset:27648
  ds_read_b64_tr_b16 a[206:207], v10 offset:32256
  v_mfma_f32_16x16x32_bf16 v[168:171], a[232:235], a[104:107], v[168:171]
  ds_read_b64_tr_b16 a[208:209], v10 offset:32
  buffer_load_dwordx4 v5, s[24:27], s56 offen lds
  v_mfma_f32_16x16x32_bf16 v[168:171], a[236:239], a[108:111], v[168:171]
  s_lshr_b32 s84, s84, 1
  ds_read_b64_tr_b16 a[210:211], v10 offset:4640
  v_mfma_f32_16x16x32_bf16 v[172:175], a[224:227], a[112:115], v[172:175]
  s_lshl_b32 s68, s84, 1
  ds_read_b64_tr_b16 a[212:213], v10 offset:9248
  v_mfma_f32_16x16x32_bf16 v[172:175], a[228:231], a[116:119], v[172:175]
  s_sub_u32 s83, s83, s68
  ds_read_b64_tr_b16 a[214:215], v10 offset:13856
  v_mfma_f32_16x16x32_bf16 v[172:175], a[232:235], a[120:123], v[172:175]
  ds_read_b64_tr_b16 a[216:217], v10 offset:18464
  buffer_load_dwordx4 v6, s[24:27], s56 offen offset:1024 lds
  v_mfma_f32_16x16x32_bf16 v[172:175], a[236:239], a[124:127], v[172:175]
  s_waitcnt vmcnt(24) lgkmcnt(5)
  s_barrier
  v_mfma_f32_16x16x32_bf16 v[224:227], a[192:195], a[128:131], v[224:227]
  s_min_u32 s68, s84, 1
  ds_read_b64_tr_b16 a[218:219], v10 offset:23072
  v_mfma_f32_16x16x32_bf16 v[224:227], a[196:199], a[132:135], v[224:227]
  ds_read_b64_tr_b16 a[220:221], v10 offset:27680
  ds_read_b64_tr_b16 a[222:223], v10 offset:32288
  v_mfma_f32_16x16x32_bf16 v[224:227], a[200:203], a[136:139], v[224:227]
  ds_read_b64_tr_b16 a[224:225], v10 offset:64
  buffer_load_dwordx4 v7, s[24:27], s56 offen offset:2048 lds
  v_mfma_f32_16x16x32_bf16 v[224:227], a[204:207], a[140:143], v[224:227]
  s_sub_u32 s83, s83, s68
  ds_read_b64_tr_b16 a[226:227], v10 offset:4672
  v_mfma_f32_16x16x32_bf16 v[228:231], a[192:195], a[144:147], v[228:231]
  s_add_u32 s88, s89, s84
  ds_read_b64_tr_b16 a[228:229], v10 offset:9280
  v_mfma_f32_16x16x32_bf16 v[228:231], a[196:199], a[148:151], v[228:231]
  s_mul_i32 s88, s88, 49152
  ds_read_b64_tr_b16 a[230:231], v10 offset:13888
  v_mfma_f32_16x16x32_bf16 v[228:231], a[200:203], a[152:155], v[228:231]
  s_lshl_b32 s83, s83, 10
  ds_read_b64_tr_b16 a[232:233], v10 offset:18496
  v_mfma_f32_16x16x32_bf16 v[228:231], a[204:207], a[156:159], v[228:231]
  s_waitcnt lgkmcnt(5)
  ds_read_b64_tr_b16 a[234:235], v10 offset:23104
  v_mfma_f32_16x16x32_bf16 v[232:235], a[208:211], a[128:131], v[232:235]
  ds_read_b64_tr_b16 a[236:237], v10 offset:27712
  buffer_load_dwordx4 v8, s[24:27], s56 offen offset:3072 lds
  v_mfma_f32_16x16x32_bf16 v[232:235], a[212:215], a[132:135], v[232:235]
  s_add_u32 m0, s64, 81920
  ds_read_b64_tr_b16 a[238:239], v10 offset:32320
  v_mfma_f32_16x16x32_bf16 v[232:235], a[216:219], a[136:139], v[232:235]
  s_add_u32 s88, s88, s83
  ds_read_b64_tr_b16 a[192:193], v10 offset:96
  v_mfma_f32_16x16x32_bf16 v[232:235], a[220:223], a[140:143], v[232:235]
  s_mul_i32 s83, s48, 3072
  ds_read_b64_tr_b16 a[194:195], v10 offset:4704
  v_mfma_f32_16x16x32_bf16 v[236:239], a[208:211], a[144:147], v[236:239]
  ds_read_b64_tr_b16 a[196:197], v10 offset:9312
  buffer_load_dwordx4 v9, s[24:27], s56 offen lds
  v_mfma_f32_16x16x32_bf16 v[236:239], a[212:215], a[148:151], v[236:239]
  s_add_u32 m0, s64, 122880
  s_add_u32 s56, s6, 110592
  s_add_u32 s83, s83, 23068672
  v_mfma_f32_16x16x32_bf16 v[236:239], a[216:219], a[152:155], v[236:239]
  s_mul_i32 s84, s51, 12288
  ds_read_b64_tr_b16 a[198:199], v10 offset:13920
  v_mfma_f32_16x16x32_bf16 v[236:239], a[220:223], a[156:159], v[236:239]
  s_waitcnt lgkmcnt(4)
  ds_read_b64_tr_b16 a[200:201], v10 offset:18528
  v_mfma_f32_16x16x32_bf16 v[240:243], a[224:227], a[128:131], v[240:243]
  ds_read_b64_tr_b16 a[202:203], v10 offset:23136
  buffer_load_dwordx4 v1, s[24:27], s56 offen lds
  v_mfma_f32_16x16x32_bf16 v[240:243], a[228:231], a[132:135], v[240:243]
  ds_read_b64_tr_b16 a[204:205], v10 offset:27744
  ds_read_b64_tr_b16 a[206:207], v10 offset:32352
  v_mfma_f32_16x16x32_bf16 v[240:243], a[232:235], a[136:139], v[240:243]
  s_add_u32 s84, s84, s83
  ds_read_b64_tr_b16 a[208:209], v10 offset:128
  v_add_u32 v11, s84, v15
  v_mfma_f32_16x16x32_bf16 v[240:243], a[236:239], a[140:143], v[240:243]
  s_add_u32 s84, s89, s51
  ds_read_b64_tr_b16 a[210:211], v10 offset:4736
  v_mfma_f32_16x16x32_bf16 v[244:247], a[224:227], a[144:147], v[244:247]
  s_mul_i32 s84, s84, 49152
  ds_read_b64_tr_b16 a[212:213], v10 offset:9344
  v_mfma_f32_16x16x32_bf16 v[244:247], a[228:231], a[148:151], v[244:247]
  ds_read_b64_tr_b16 a[214:215], v10 offset:13952
  buffer_load_dwordx4 v2, s[24:27], s56 offen offset:1024 lds
  v_mfma_f32_16x16x32_bf16 v[244:247], a[232:235], a[152:155], v[244:247]
  s_add_u32 s84, s84, s83
  ds_read_b64_tr_b16 a[216:217], v10 offset:18560
  v_add_u32 v56, s84, v15
  v_mfma_f32_16x16x32_bf16 v[244:247], a[236:239], a[156:159], v[244:247]
  s_waitcnt lgkmcnt(5)
  ds_read_b64_tr_b16 a[218:219], v10 offset:23168
  v_add_u32 v14, s69, v56
  v_mfma_f32_16x16x32_bf16 v[248:251], a[192:195], a[128:131], v[248:251]
  s_lshl_b32 s83, s49, 5
  ds_read_b64_tr_b16 a[220:221], v10 offset:27776
  v_mfma_f32_16x16x32_bf16 v[248:251], a[196:199], a[132:135], v[248:251]
  s_and_b32 s68, s50, 7
  ds_read_b64_tr_b16 a[222:223], v10 offset:32384
  v_mfma_f32_16x16x32_bf16 v[248:251], a[200:203], a[136:139], v[248:251]
  ds_read_b64_tr_b16 a[224:225], v10 offset:160
  buffer_load_dwordx4 v3, s[24:27], s56 offen offset:2048 lds
  v_mfma_f32_16x16x32_bf16 v[248:251], a[204:207], a[140:143], v[248:251]
  s_waitcnt vmcnt(11)
  v_subrev_u32 v20, s85, v20
  v_add_u32 v20, -4, v20
  v_mfma_f32_16x16x32_bf16 v[252:255], a[192:195], a[144:147], v[252:255]
  ds_read_b64_tr_b16 a[226:227], v10 offset:4768
  buffer_load_dwordx4 v4, s[24:27], s56 offen offset:3072 lds
  v_mfma_f32_16x16x32_bf16 v[252:255], a[196:199], a[148:151], v[252:255]
  s_add_u32 m0, s64, 126976
  ds_read_b64_tr_b16 a[228:229], v10 offset:9376
  v_cmp_gt_u32 s[22:23], 4, v20
  v_mfma_f32_16x16x32_bf16 v[252:255], a[200:203], a[152:155], v[252:255]
  ds_read_b64_tr_b16 a[230:231], v10 offset:13984
  s_and_b32 s29, s22, 0xff
  s_cmp_eq_u32 s29, 0xff
  s_cbranch_scc0 L_slow_18
L_ok_17:
  v_mfma_f32_16x16x32_bf16 v[252:255], a[204:207], a[156:159], v[252:255]
  s_waitcnt lgkmcnt(4)
  s_add_u32 s90, s11, 24576
  s_add_u32 s83, s83, s68
  v_mfma_f32_16x16x32_bf16 v[24:27], a[208:211], a[128:131], v[24:27]
  ds_read_b64_tr_b16 a[232:233], v10 offset:18592
  buffer_load_dwordx4 a[0:3], v12, s[40:43], s90 offen offset:0 sc1
  v_mfma_f32_16x16x32_bf16 v[24:27], a[212:215], a[132:135], v[24:27]
  ds_read_b64_tr_b16 a[234:235], v10 offset:23200
  ds_read_b64_tr_b16 a[236:237], v10 offset:27808
  ds_read_b64_tr_b16 a[238:239], v10 offset:32416
  v_mfma_f32_16x16x32_bf16 v[24:27], a[216:219], a[136:139], v[24:27]
  s_lshl_b32 s83, s83, 7
  ds_read_b64_tr_b16 a[192:193], v10 offset:192
  v_mfma_f32_16x16x32_bf16 v[24:27], a[220:223], a[140:143], v[24:27]
  ds_read_b64_tr_b16 a[194:195], v10 offset:4800
  buffer_load_dwordx4 a[4:7], v12, s[40:43], s90 offen offset:1024 sc1
  v_mfma_f32_16x16x32_bf16 v[28:31], a[208:211], a[144:147], v[28:31]
  s_add_u32 s83, s83, 22544384
  ds_read_b64_tr_b16 a[196:197], v10 offset:9408
  v_mfma_f32_16x16x32_bf16 v[28:31], a[212:215], a[148:151], v[28:31]
  s_lshl_b32 s68, s48, 2
  ds_read_b64_tr_b16 a[198:199], v10 offset:14016
  v_mfma_f32_16x16x32_bf16 v[28:31], a[216:219], a[152:155], v[28:31]
  s_add_u32 s83, s83, s68
  ds_read_b64_tr_b16 a[200:201], v10 offset:18624
  v_lshl_add_u32 v59, v0, 10, s83
  v_mfma_f32_16x16x32_bf16 v[28:31], a[220:223], a[156:159], v[28:31]
  s_waitcnt lgkmcnt(5)
  ds_read_b64_tr_b16 a[202:203], v10 offset:23232
  v_cndmask_b32 v59, v198, v59, vcc
  v_mfma_f32_16x16x32_bf16 v[32:35], a[224:227], a[128:131], v[32:35]
  ds_read_b64_tr_b16 a[204:205], v10 offset:27840
  buffer_load_dwordx4 a[8:11], v12, s[40:43], s90 offen offset:2048 sc1
  v_mfma_f32_16x16x32_bf16 v[32:35], a[228:231], a[132:135], v[32:35]
  s_add_u32 s55, s55, s68
  ds_read_b64_tr_b16 a[206:207], v10 offset:32448
  v_bfe_u32 v198, v0, 2, 2
  v_mfma_f32_16x16x32_bf16 v[32:35], a[232:235], a[136:139], v[32:35]
  s_lshl_b32 s83, s48, 12
  ds_read_b64_tr_b16 a[208:209], v10 offset:224
  v_cmp_eq_u32 vcc, v198, v199
  v_mfma_f32_16x16x32_bf16 v[32:35], a[236:239], a[140:143], v[32:35]
  ds_read_b64_tr_b16 a[210:211], v10 offset:4832
  buffer_load_dword v20, v21, s[40:43], 0 offen sc1
  v_mfma_f32_16x16x32_bf16 v[36:39], a[224:227], a[144:147], v[36:39]
  s_add_u32 s83, s83, 0
  ds_read_b64_tr_b16 a[212:213], v10 offset:9440
  v_and_b32 v198, 1, v0
  v_mfma_f32_16x16x32_bf16 v[36:39], a[228:231], a[148:151], v[36:39]
  ds_read_b64_tr_b16 a[214:215], v10 offset:14048
  buffer_load_dwordx4 a[12:15], v12, s[40:43], s90 offen offset:3072 sc1
  v_mfma_f32_16x16x32_bf16 v[36:39], a[232:235], a[152:155], v[36:39]
  s_add_u32 s90, s11, 65536
  ds_read_b64_tr_b16 a[216:217], v10 offset:18656
  v_lshlrev_b32 v198, 4, v198
  v_mfma_f32_16x16x32_bf16 v[36:39], a[236:239], a[156:159], v[36:39]
  s_waitcnt lgkmcnt(5)
  ds_read_b64_tr_b16 a[218:219], v10 offset:23264
  v_lshlrev_b32 v200, v198, v200
  v_mfma_f32_16x16x32_bf16 v[40:43], a[192:195], a[128:131], v[40:43]
  s_lshl_b32 s68, s52, 2
  ds_read_b64_tr_b16 a[220:221], v10 offset:27872
  v_cndmask_b32 v200, 0, v200, vcc
  v_mfma_f32_16x16x32_bf16 v[40:43], a[196:199], a[132:135], v[40:43]
  s_add_u32 s68, s68, s48
  ds_read_b64_tr_b16 a[222:223], v10 offset:32480
  v_and_b32 v198, 2, v0
  v_mfma_f32_16x16x32_bf16 v[40:43], a[200:203], a[136:139], v[40:43]
  ds_read_b64_tr_b16 a[224:225], v10 offset:256
  buffer_load_dwordx4 a[16:19], v12, s[40:43], s90 offen offset:0 sc1
  v_mfma_f32_16x16x32_bf16 v[40:43], a[204:207], a[140:143], v[40:43]
  s_mul_i32 s68, s68, 36864
  ds_read_b64_tr_b16 a[226:227], v10 offset:4864
  v_cmp_eq_u32 vcc, 0, v198
  v_mfma_f32_16x16x32_bf16 v[44:47], a[192:195], a[144:147], v[44:47]
  s_mul_i32 s84, s53, 288
  ds_read_b64_tr_b16 a[228:229], v10 offset:9472
  v_cndmask_b32 v96, 0, v200, vcc
  v_mfma_f32_16x16x32_bf16 v[44:47], a[196:199], a[148:151], v[44:47]
  s_add_u32 s68, s68, s84
  ds_read_b64_tr_b16 a[230:231], v10 offset:14080
  v_cndmask_b32 v97, v200, 0, vcc
  v_mfma_f32_16x16x32_bf16 v[44:47], a[200:203], a[152:155], v[44:47]
  ds_read_b64_tr_b16 a[232:233], v10 offset:18688
  buffer_load_dwordx4 a[20:23], v12, s[40:43], s90 offen offset:1024 sc1
  v_mfma_f32_16x16x32_bf16 v[44:47], a[204:207], a[156:159], v[44:47]
  s_waitcnt lgkmcnt(5) vmcnt(29)
  s_barrier
  v_mfma_f32_16x16x32_bf16 v[160:163], a[208:211], a[128:131], v[160:163]
  s_lshl_b32 s84, s71, 5
  ds_read_b64_tr_b16 a[234:235], v10 offset:23296
  v_and_b32 v198, 15, v0
  v_mfma_f32_16x16x32_bf16 v[160:163], a[212:215], a[132:135], v[160:163]
  ds_read_b64_tr_b16 a[236:237], v10 offset:27904
  ds_read_b64_tr_b16 a[238:239], v10 offset:32512
  v_mfma_f32_16x16x32_bf16 v[160:163], a[216:219], a[136:139], v[160:163]
  buffer_load_dwordx4 a[24:27], v12, s[40:43], s90 offen offset:2048 sc1
  v_mfma_f32_16x16x32_bf16 v[160:163], a[220:223], a[140:143], v[160:163]
  s_add_u32 s68, s68, s84
  v_add_u32 v10, 36864, v10
  v_mul_u32_u24 v198, 112, v198
  v_mfma_f32_16x16x32_bf16 v[164:167], a[208:211], a[144:147], v[164:167]
  s_add_u32 s65, s51, 1
  ds_read_b64_tr_b16 a[192:193], v10 offset:0
  v_lshl_add_u32 v198, v199, 3, v198
  v_mfma_f32_16x16x32_bf16 v[164:167], a[212:215], a[148:151], v[164:167]
  s_and_b32 s65, s65, 3
  ds_read_b64_tr_b16 a[194:195], v10 offset:4608
  v_add_u32 v198, s83, v198
  v_mfma_f32_16x16x32_bf16 v[164:167], a[216:219], a[152:155], v[164:167]
  ds_read_b64_tr_b16 a[196:197], v10 offset:9216
  buffer_load_dwordx4 a[28:31], v12, s[40:43], s90 offen offset:3072 sc1
  v_mfma_f32_16x16x32_bf16 v[164:167], a[220:223], a[156:159], v[164:167]
  s_waitcnt lgkmcnt(3)
  ds_read_b64_tr_b16 a[198:199], v10 offset:13824
  v_cmp_lt_u32 vcc, 3, v205
  v_mfma_f32_16x16x32_bf16 v[168:171], a[224:227], a[128:131], v[168:171]
  s_mul_i32 s65, s65, 12288
  ds_read_b64_tr_b16 a[200:201], v10 offset:18432
  v_lshlrev_b32 v205, 4, v205
  v_mfma_f32_16x16x32_bf16 v[168:171], a[228:231], a[132:135], v[168:171]
  ds_read_b64_tr_b16 a[202:203], v10 offset:23040
  ds_read_b64_tr_b16 a[204:205], v10 offset:27648
  ds_read_b64_tr_b16 a[206:207], v10 offset:32256
  v_mfma_f32_16x16x32_bf16 v[168:171], a[232:235], a[136:139], v[168:171]
  ds_read_b64_tr_b16 a[208:209], v10 offset:32
  buffer_load_dwordx4 v5, s[24:27], s56 offen lds
  v_mfma_f32_16x16x32_bf16 v[168:171], a[236:239], a[140:143], v[168:171]
  s_add_u32 s66, s51, 2
  ds_read_b64_tr_b16 a[210:211], v10 offset:4640
  v_add3_u32 v199, v207, v205, s83
  v_mfma_f32_16x16x32_bf16 v[172:175], a[224:227], a[144:147], v[172:175]
  s_and_b32 s66, s66, 3
  ds_read_b64_tr_b16 a[212:213], v10 offset:9248
  v_mul_u32_u24 v207, 1152, v206
  v_mfma_f32_16x16x32_bf16 v[172:175], a[228:231], a[148:151], v[172:175]
  s_mul_i32 s66, s66, 12288
  ds_read_b64_tr_b16 a[214:215], v10 offset:13856
  v_add3_u32 v202, v207, v205, s68
  v_mfma_f32_16x16x32_bf16 v[172:175], a[232:235], a[152:155], v[172:175]
  s_waitcnt vmcnt(24)
  ds_read_b64_tr_b16 a[216:217], v10 offset:18464
  v_add_u32 v207, s69, v202
  v_mfma_f32_16x16x32_bf16 v[172:175], a[236:239], a[156:159], v[172:175]
  s_waitcnt lgkmcnt(5)
  s_barrier
  v_mfma_f32_16x16x32_bf16 v[224:227], a[192:195], a[160:163], v[224:227]
  ds_read_b64_tr_b16 a[218:219], v10 offset:23072
  buffer_load_dwordx4 v6, s[24:27], s56 offen offset:1024 lds
  v_mfma_f32_16x16x32_bf16 v[224:227], a[196:199], a[164:167], v[224:227]
  ds_read_b64_tr_b16 a[220:221], v10 offset:27680
  ds_read_b64_tr_b16 a[222:223], v10 offset:32288
  v_mfma_f32_16x16x32_bf16 v[224:227], a[200:203], a[168:171], v[224:227]
  s_lshl_b32 s84, s52, 3
  ds_read_b64_tr_b16 a[224:225], v10 offset:64
  v_cndmask_b32 v202, v202, v207, vcc
  v_mfma_f32_16x16x32_bf16 v[224:227], a[204:207], a[172:175], v[224:227]
  ds_read_b64_tr_b16 a[226:227], v10 offset:4672
  buffer_load_dwordx4 v7, s[24:27], s56 offen offset:2048 lds
  v_mfma_f32_16x16x32_bf16 v[228:231], a[192:195], a[176:179], v[228:231]
  s_add_u32 s67, s51, 3
  ds_read_b64_tr_b16 a[228:229], v10 offset:9280
  v_add_u32 v205, 64, v0
  v_mfma_f32_16x16x32_bf16 v[228:231], a[196:199], a[180:183], v[228:231]
  s_and_b32 s67, s67, 3
  ds_read_b64_tr_b16 a[230:231], v10 offset:13888
  v_mul_u32_u24 v206, 10923, v205
  v_mfma_f32_16x16x32_bf16 v[228:231], a[200:203], a[184:187], v[228:231]
  s_mul_i32 s67, s67, 12288
  ds_read_b64_tr_b16 a[232:233], v10 offset:18496
  v_lshrrev_b32 v206, 16, v206
  v_mfma_f32_16x16x32_bf16 v[228:231], a[204:207], a[188:191], v[228:231]
  s_waitcnt lgkmcnt(5)
  ds_read_b64_tr_b16 a[234:235], v10 offset:23104
  v_mul_u32_u24 v207, 6, v206
  v_mfma_f32_16x16x32_bf16 v[232:235], a[208:211], a[160:163], v[232:235]
  ds_read_b64_tr_b16 a[236:237], v10 offset:27712
  buffer_load_dwordx4 v8, s[24:27], s56 offen offset:3072 lds
  v_mfma_f32_16x16x32_bf16 v[232:235], a[212:215], a[164:167], v[232:235]
  s_add_u32 m0, s64, 131072
  ds_read_b64_tr_b16 a[238:239], v10 offset:32320
  v_sub_u32 v205, v205, v207
  v_mfma_f32_16x16x32_bf16 v[232:235], a[216:219], a[168:171], v[232:235]
  ds_read_b64_tr_b16 a[192:193], v10 offset:96
  v_cmp_lt_u32 vcc, 3, v205
  v_mfma_f32_16x16x32_bf16 v[232:235], a[220:223], a[172:175], v[232:235]
  ds_read_b64_tr_b16 a[194:195], v10 offset:4704
  v_lshlrev_b32 v205, 4, v205
  v_mfma_f32_16x16x32_bf16 v[236:239], a[208:211], a[176:179], v[236:239]
  ds_read_b64_tr_b16 a[196:197], v10 offset:9312
  buffer_load_dwordx4 v9, s[24:27], s56 offen lds
  v_mfma_f32_16x16x32_bf16 v[236:239], a[212:215], a[180:183], v[236:239]
  s_add_u32 s90, s72, 24576
  ds_read_b64_tr_b16 a[198:199], v10 offset:13920
  v_mul_u32_u24 v207, 112, v206
  v_mfma_f32_16x16x32_bf16 v[236:239], a[216:219], a[184:187], v[236:239]
  ds_read_b64_tr_b16 a[200:201], v10 offset:18528
  v_add3_u32 v200, v207, v205, s83
  v_mfma_f32_16x16x32_bf16 v[236:239], a[220:223], a[188:191], v[236:239]
  s_waitcnt lgkmcnt(5)
  ds_read_b64_tr_b16 a[202:203], v10 offset:23136
  v_mul_u32_u24 v207, 1152, v206
  v_mfma_f32_16x16x32_bf16 v[240:243], a[224:227], a[160:163], v[240:243]
  ds_read_b64_tr_b16 a[204:205], v10 offset:27744
  v_add3_u32 v203, v207, v205, s68
  v_mfma_f32_16x16x32_bf16 v[240:243], a[228:231], a[164:167], v[240:243]
  ds_read_b64_tr_b16 a[206:207], v10 offset:32352
  v_add_u32 v207, s69, v203
  v_mfma_f32_16x16x32_bf16 v[240:243], a[232:235], a[168:171], v[240:243]
  ds_read_b64_tr_b16 a[208:209], v10 offset:128
  buffer_load_dwordx4 a[32:35], v12, s[40:43], s90 offen offset:0 sc1
  v_mfma_f32_16x16x32_bf16 v[240:243], a[236:239], a[172:175], v[240:243]
  ds_read_b64_tr_b16 a[210:211], v10 offset:4736
  v_cndmask_b32 v203, v203, v207, vcc
  v_mfma_f32_16x16x32_bf16 v[244:247], a[224:227], a[176:179], v[244:247]
  ds_read_b64_tr_b16 a[212:213], v10 offset:9344
  v_add_u32 v205, 128, v0
  v_mfma_f32_16x16x32_bf16 v[244:247], a[228:231], a[180:183], v[244:247]
  ds_read_b64_tr_b16 a[214:215], v10 offset:13952
  buffer_load_dwordx4 a[36:39], v12, s[40:43], s90 offen offset:1024 sc1
  v_mfma_f32_16x16x32_bf16 v[244:247], a[232:235], a[184:187], v[244:247]
  s_waitcnt vmcnt(12)
  v_subrev_u32 v20, s85, v20
  v_add_u32 v20, -5, v20
  v_mfma_f32_16x16x32_bf16 v[244:247], a[236:239], a[188:191], v[244:247]
  s_waitcnt lgkmcnt(4)
  ds_read_b64_tr_b16 a[216:217], v10 offset:18560
  v_cmp_gt_u32 s[22:23], 3, v20
  v_mfma_f32_16x16x32_bf16 v[248:251], a[192:195], a[160:163], v[248:251]
  ds_read_b64_tr_b16 a[218:219], v10 offset:23168
  s_and_b32 s29, s22, 0xff
  s_cmp_eq_u32 s29, 0xff
  s_cbranch_scc0 L_slow_21
L_ok_20:
  v_mfma_f32_16x16x32_bf16 v[248:251], a[196:199], a[164:167], v[248:251]
  ds_read_b64_tr_b16 a[220:221], v10 offset:27776
  ds_read_b64_tr_b16 a[222:223], v10 offset:32384
  v_mfma_f32_16x16x32_bf16 v[248:251], a[200:203], a[168:171], v[248:251]
  ds_read_b64_tr_b16 a[224:225], v10 offset:160
  buffer_load_dwordx4 a[40:43], v12, s[40:43], s90 offen offset:2048 sc1
  v_mfma_f32_16x16x32_bf16 v[248:251], a[204:207], a[172:175], v[248:251]
  ds_read_b64_tr_b16 a[226:227], v10 offset:4768
  buffer_load_dwordx4 a[44:47], v12, s[40:43], s90 offen offset:3072 sc1
  v_mfma_f32_16x16x32_bf16 v[252:255], a[192:195], a[176:179], v[252:255]
  s_add_u32 s90, s72, 65536
  ds_read_b64_tr_b16 a[228:229], v10 offset:9376
  v_mul_u32_u24 v206, 10923, v205
  v_mfma_f32_16x16x32_bf16 v[252:255], a[196:199], a[180:183], v[252:255]
  ds_read_b64_tr_b16 a[230:231], v10 offset:13984
  v_lshrrev_b32 v206, 16, v206
  v_mfma_f32_16x16x32_bf16 v[252:255], a[200:203], a[184:187], v[252:255]
  ds_read_b64_tr_b16 a[232:233], v10 offset:18592
  v_mul_u32_u24 v207, 6, v206
  v_mfma_f32_16x16x32_bf16 v[252:255], a[204:207], a[188:191], v[252:255]
  s_waitcnt lgkmcnt(5)
  ds_read_b64_tr_b16 a[234:235], v10 offset:23200
  v_sub_u32 v205, v205, v207
  v_mfma_f32_16x16x32_bf16 v[24:27], a[208:211], a[160:163], v[24:27]
  ds_read_b64_tr_b16 a[236:237], v10 offset:27808
  buffer_load_dwordx4 a[48:51], v12, s[40:43], s90 offen offset:0 sc1
  v_mfma_f32_16x16x32_bf16 v[24:27], a[212:215], a[164:167], v[24:27]
  ds_read_b64_tr_b16 a[238:239], v10 offset:32416
  v_cmp_lt_u32 vcc, 3, v205
  v_mfma_f32_16x16x32_bf16 v[24:27], a[216:219], a[168:171], v[24:27]
  ds_read_b64_tr_b16 a[192:193], v10 offset:192
  v_lshlrev_b32 v205, 4, v205
  v_mfma_f32_16x16x32_bf16 v[24:27], a[220:223], a[172:175], v[24:27]
  ds_read_b64_tr_b16 a[194:195], v10 offset:4800
  buffer_load_dwordx4 a[52:55], v12, s[40:43], s90 offen offset:1024 sc1
  v_mfma_f32_16x16x32_bf16 v[28:31], a[208:211], a[176:179], v[28:31]
  ds_read_b64_tr_b16 a[196:197], v10 offset:9408
  v_mul_u32_u24 v207, 112, v206
  v_mfma_f32_16x16x32_bf16 v[28:31], a[212:215], a[180:183], v[28:31]
  ds_read_b64_tr_b16 a[198:199], v10 offset:14016
  v_add3_u32 v201, v207, v205, s83
  v_mfma_f32_16x16x32_bf16 v[28:31], a[216:219], a[184:187], v[28:31]
  ds_read_b64_tr_b16 a[200:201], v10 offset:18624
  v_lshlrev_b32 v16, 3, v0
  v_mfma_f32_16x16x32_bf16 v[28:31], a[220:223], a[188:191], v[28:31]
  s_waitcnt lgkmcnt(5)
  ds_read_b64_tr_b16 a[202:203], v10 offset:23232
  v_mov_b32 v102, v96
  v_mfma_f32_16x16x32_bf16 v[32:35], a[224:227], a[160:163], v[32:35]
  ds_read_b64_tr_b16 a[204:205], v10 offset:27840
  s_mul_i32 s83, s48, 1152
  s_mov_b32 exec_hi, 15
  s_add_u32 m0, s83, 110592
  s_add_u32 s59, s82, 36864
  buffer_load_dwordx4 v1, s[12:15], s59 offen lds
  s_add_u32 m0, s83, 111168
  s_add_u32 s59, s82, 57600
  buffer_load_dwordx4 v1, s[12:15], s59 offen lds
  s_mov_b32 exec_hi, -1
  v_mfma_f32_16x16x32_bf16 v[32:35], a[228:231], a[164:167], v[32:35]
  s_lshl_b32 s83, s51, 7
  ds_read_b64_tr_b16 a[206:207], v10 offset:32448
  v_mov_b32 v103, v97
  v_mfma_f32_16x16x32_bf16 v[32:35], a[232:235], a[168:171], v[32:35]
  s_add_u32 s83, s83, s84
  ds_read_b64_tr_b16 a[208:209], v10 offset:224
  v_mul_u32_u24 v207, 1152, v206
  v_mfma_f32_16x16x32_bf16 v[32:35], a[236:239], a[172:175], v[32:35]
  s_lshl_b32 s84, s48, 1
  ds_read_b64_tr_b16 a[210:211], v10 offset:4832
  v_add3_u32 v204, v207, v205, s68
  v_mfma_f32_16x16x32_bf16 v[36:39], a[224:227], a[176:179], v[36:39]
  ds_read_b64_tr_b16 a[212:213], v10 offset:9440
  buffer_load_dwordx4 a[56:59], v12, s[40:43], s90 offen offset:2048 sc1
  v_mfma_f32_16x16x32_bf16 v[36:39], a[228:231], a[180:183], v[36:39]
  s_add_u32 s83, s83, s84
  ds_read_b64_tr_b16 a[214:215], v10 offset:14048
  v_add_u32 v207, s69, v204
  v_mfma_f32_16x16x32_bf16 v[36:39], a[232:235], a[184:187], v[36:39]
  s_lshl_b32 s83, s83, 9
  ds_read_b64_tr_b16 a[216:217], v10 offset:18656
  v_cndmask_b32 v204, v204, v207, vcc
  v_mfma_f32_16x16x32_bf16 v[36:39], a[236:239], a[188:191], v[36:39]
  s_waitcnt lgkmcnt(5)
  ds_read_b64_tr_b16 a[218:219], v10 offset:23264
  v_mfma_f32_16x16x32_bf16 v[40:43], a[192:195], a[160:163], v[40:43]
  ds_read_b64_tr_b16 a[220:221], v10 offset:27872
  buffer_load_dwordx4 a[60:63], v12, s[40:43], s90 offen offset:3072 sc1
  v_mfma_f32_16x16x32_bf16 v[40:43], a[196:199], a[164:167], v[40:43]
  s_add_u32 s91, s83, 20971520
  ds_read_b64_tr_b16 a[222:223], v10 offset:32480
  v_mfma_f32_16x16x32_bf16 v[40:43], a[200:203], a[168:171], v[40:43]
  ds_read_b64_tr_b16 a[224:225], v10 offset:256
  v_mfma_f32_16x16x32_bf16 v[40:43], a[204:207], a[172:175], v[40:43]
  ds_read_b64_tr_b16 a[226:227], v10 offset:4864
  v_mfma_f32_16x16x32_bf16 v[44:47], a[192:195], a[176:179], v[44:47]
  ds_read_b64_tr_b16 a[228:229], v10 offset:9472
  buffer_load_dword v17, v19, s[40:43], 0 offen offset:0 sc1
  v_mfma_f32_16x16x32_bf16 v[44:47], a[196:199], a[180:183], v[44:47]
  ds_read_b64_tr_b16 a[230:231], v10 offset:14080
  buffer_load_dword v18, v19, s[40:43], 0 offen offset:64 sc1
  v_mfma_f32_16x16x32_bf16 v[44:47], a[200:203], a[184:187], v[44:47]
  s_add_u32 m0, s64, 0
  s_add_u32 s56, s7, 589824
  v_mfma_f32_16x16x32_bf16 v[44:47], a[204:207], a[188:191], v[44:47]
  s_waitcnt lgkmcnt(4) vmcnt(30)
  s_barrier
  v_mfma_f32_16x16x32_bf16 v[160:163], a[208:211], a[160:163], v[160:163]
  ds_read_b64_tr_b16 a[232:233], v10 offset:18688
  buffer_load_dwordx4 v1, s[24:27], s56 offen lds
  v_mfma_f32_16x16x32_bf16 v[160:163], a[212:215], a[164:167], v[160:163]
  ds_read_b64_tr_b16 a[234:235], v10 offset:23296
  ds_read_b64_tr_b16 a[236:237], v10 offset:27904
  ds_read_b64_tr_b16 a[238:239], v10 offset:32512
  v_mfma_f32_16x16x32_bf16 v[160:163], a[216:219], a[168:171], v[160:163]
  buffer_load_dwordx4 v2, s[24:27], s56 offen offset:1024 lds
  v_mfma_f32_16x16x32_bf16 v[160:163], a[220:223], a[172:175], v[160:163]
  v_add_u32 v10, 36864, v10
  v_mfma_f32_16x16x32_bf16 v[164:167], a[208:211], a[176:179], v[164:167]
  ds_read_b64_tr_b16 a[192:193], v10 offset:64
  v_mfma_f32_16x16x32_bf16 v[164:167], a[212:215], a[180:183], v[164:167]
  ds_read_b64_tr_b16 a[194:195], v10 offset:4672
  v_mfma_f32_16x16x32_bf16 v[164:167], a[216:219], a[184:187], v[164:167]
  ds_read_b64_tr_b16 a[196:197], v10 offset:9280
  v_mfma_f32_16x16x32_bf16 v[164:167], a[220:223], a[188:191], v[164:167]
  s_waitcnt lgkmcnt(3)
  ds_read_b64_tr_b16 a[198:199], v10 offset:13888
  v_mfma_f32_16x16x32_bf16 v[168:171], a[224:227], a[160:163], v[168:171]
  ds_read_b64_tr_b16 a[200:201], v10 offset:18496
  buffer_load_dwordx4 v3, s[24:27], s56 offen offset:2048 lds
  v_mfma_f32_16x16x32_bf16 v[168:171], a[228:231], a[164:167], v[168:171]
  ds_read_b64_tr_b16 a[202:203], v10 offset:23104
  ds_read_b64_tr_b16 a[204:205], v10 offset:27712
  ds_read_b64_tr_b16 a[206:207], v10 offset:32320
  v_mfma_f32_16x16x32_bf16 v[168:171], a[232:235], a[168:171], v[168:171]
  ds_read_b64_tr_b16 a[208:209], v10 offset:96
  v_mfma_f32_16x16x32_bf16 v[168:171], a[236:239], a[172:175], v[168:171]
  ds_read_b64_tr_b16 a[210:211], v10 offset:4704
  buffer_load_dwordx4 v4, s[24:27], s56 offen offset:3072 lds
  v_mfma_f32_16x16x32_bf16 v[172:175], a[224:227], a[176:179], v[172:175]
  s_add_u32 m0, s64, 4096
  s_mov_b32 s57, s9
  v_mfma_f32_16x16x32_bf16 v[172:175], a[228:231], a[180:183], v[172:175]
  ds_read_b64_tr_b16 a[212:213], v10 offset:9312
  v_mfma_f32_16x16x32_bf16 v[172:175], a[232:235], a[184:187], v[172:175]
  s_waitcnt vmcnt(21)
  ds_read_b64_tr_b16 a[214:215], v10 offset:13920
  v_mfma_f32_16x16x32_bf16 v[172:175], a[236:239], a[188:191], v[172:175]
  s_waitcnt lgkmcnt(4)
  s_barrier
  v_mfma_f32_16x16x32_bf16 v[240:243], a[192:195], a[0:3], v[240:243]
  ds_read_b64_tr_b16 a[216:217], v10 offset:18528
  s_mov_b32 exec_hi, 0
  buffer_load_dwordx4 v5, s[24:27], s56 offen lds
  s_mov_b32 exec_hi, -1
  s_mov_b32 exec_lo, 0
  buffer_load_dwordx4 v5, s[12:15], s57 offen lds
  s_mov_b32 exec_lo, -1
  v_mfma_f32_16x16x32_bf16 v[240:243], a[196:199], a[4:7], v[240:243]
  ds_read_b64_tr_b16 a[218:219], v10 offset:23136
  ds_read_b64_tr_b16 a[220:221], v10 offset:27744
  ds_read_b64_tr_b16 a[222:223], v10 offset:32352
  v_mfma_f32_16x16x32_bf16 v[240:243], a[200:203], a[8:11], v[240:243]
  ds_read_b64_tr_b16 a[224:225], v10 offset:128
  v_mfma_f32_16x16x32_bf16 v[240:243], a[204:207], a[12:15], v[240:243]
  ds_read_b64_tr_b16 a[226:227], v10 offset:4736
  v_mfma_f32_16x16x32_bf16 v[244:247], a[192:195], a[16:19], v[244:247]
  ds_read_b64_tr_b16 a[228:229], v10 offset:9344
  buffer_load_dwordx4 v6, s[12:15], s57 offen offset:1024 lds
  v_mfma_f32_16x16x32_bf16 v[244:247], a[196:199], a[20:23], v[244:247]
  ds_read_b64_tr_b16 a[230:231], v10 offset:13952
  v_mfma_f32_16x16x32_bf16 v[244:247], a[200:203], a[24:27], v[244:247]
  ds_read_b64_tr_b16 a[232:233], v10 offset:18560
  v_mfma_f32_16x16x32_bf16 v[244:247], a[204:207], a[28:31], v[244:247]
  s_waitcnt lgkmcnt(5)
  ds_read_b64_tr_b16 a[234:235], v10 offset:23168
  v_mfma_f32_16x16x32_bf16 v[248:251], a[208:211], a[0:3], v[248:251]
  ds_read_b64_tr_b16 a[236:237], v10 offset:27776
  v_mfma_f32_16x16x32_bf16 v[248:251], a[212:215], a[4:7], v[248:251]
  ds_read_b64_tr_b16 a[238:239], v10 offset:32384
  v_mfma_f32_16x16x32_bf16 v[248:251], a[216:219], a[8:11], v[248:251]
  ds_read_b64_tr_b16 a[192:193], v10 offset:160
  buffer_load_dwordx4 v7, s[12:15], s57 offen offset:2048 lds
  v_mfma_f32_16x16x32_bf16 v[248:251], a[220:223], a[12:15], v[248:251]
  ds_read_b64_tr_b16 a[194:195], v10 offset:4768
  v_mfma_f32_16x16x32_bf16 v[252:255], a[208:211], a[16:19], v[252:255]
  ds_read_b64_tr_b16 a[196:197], v10 offset:9376
  v_mfma_f32_16x16x32_bf16 v[252:255], a[212:215], a[20:23], v[252:255]
  ds_read_b64_tr_b16 a[198:199], v10 offset:13984
  v_mfma_f32_16x16x32_bf16 v[252:255], a[216:219], a[24:27], v[252:255]
  ds_read_b64_tr_b16 a[200:201], v10 offset:18592
  buffer_load_dwordx4 v8, s[12:15], s57 offen offset:3072 lds
  v_mfma_f32_16x16x32_bf16 v[252:255], a[220:223], a[28:31], v[252:255]
  s_waitcnt lgkmcnt(5)
  s_add_u32 m0, s64, 8192
  v_mfma_f32_16x16x32_bf16 v[24:27], a[224:227], a[0:3], v[24:27]
  ds_read_b64_tr_b16 a[202:203], v10 offset:23200
  v_mfma_f32_16x16x32_bf16 v[24:27], a[228:231], a[4:7], v[24:27]
  ds_read_b64_tr_b16 a[204:205], v10 offset:27808
  ds_read_b64_tr_b16 a[206:207], v10 offset:32416
  v_mfma_f32_16x16x32_bf16 v[24:27], a[232:235], a[8:11], v[24:27]
  ds_read_b64_tr_b16 a[208:209], v10 offset:192
  buffer_load_dwordx4 v9, s[12:15], s57 offen lds
  v_mfma_f32_16x16x32_bf16 v[24:27], a[236:239], a[12:15], v[24:27]
  s_add_u32 s90, s11, 32768
  ds_read_b64_tr_b16 a[210:211], v10 offset:4800
  v_mfma_f32_16x16x32_bf16 v[28:31], a[224:227], a[16:19], v[28:31]
  ds_read_b64_tr_b16 a[212:213], v10 offset:9408
  v_mfma_f32_16x16x32_bf16 v[28:31], a[228:231], a[20:23], v[28:31]
  ds_read_b64_tr_b16 a[214:215], v10 offset:14016
  v_mfma_f32_16x16x32_bf16 v[28:31], a[232:235], a[24:27], v[28:31]
  ds_read_b64_tr_b16 a[216:217], v10 offset:18624
  v_mfma_f32_16x16x32_bf16 v[28:31], a[236:239], a[28:31], v[28:31]
  s_waitcnt lgkmcnt(5)
  ds_read_b64_tr_b16 a[218:219], v10 offset:23232
  v_mfma_f32_16x16x32_bf16 v[32:35], a[192:195], a[0:3], v[32:35]
  ds_read_b64_tr_b16 a[220:221], v10 offset:27840
  buffer_load_dwordx4 a[64:67], v12, s[40:43], s90 offen offset:0 sc1
  v_mfma_f32_16x16x32_bf16 v[32:35], a[196:199], a[4:7], v[32:35]
  ds_read_b64_tr_b16 a[222:223], v10 offset:32448
  v_mfma_f32_16x16x32_bf16 v[32:35], a[200:203], a[8:11], v[32:35]
  ds_read_b64_tr_b16 a[224:225], v10 offset:224
  v_mfma_f32_16x16x32_bf16 v[32:35], a[204:207], a[12:15], v[32:35]
  ds_read_b64_tr_b16 a[226:227], v10 offset:4832
  buffer_load_dwordx4 a[68:71], v12, s[40:43], s90 offen offset:1024 sc1
  v_mfma_f32_16x16x32_bf16 v[36:39], a[192:195], a[16:19], v[36:39]
  ds_read_b64_tr_b16 a[228:229], v10 offset:9440
  v_mfma_f32_16x16x32_bf16 v[36:39], a[196:199], a[20:23], v[36:39]
  ds_read_b64_tr_b16 a[230:231], v10 offset:14048
  v_mfma_f32_16x16x32_bf16 v[36:39], a[200:203], a[24:27], v[36:39]
  ds_read_b64_tr_b16 a[232:233], v10 offset:18656
  v_mfma_f32_16x16x32_bf16 v[36:39], a[204:207], a[28:31], v[36:39]
  s_waitcnt lgkmcnt(5)
  ds_read_b64_tr_b16 a[234:235], v10 offset:23264
  v_mfma_f32_16x16x32_bf16 v[40:43], a[208:211], a[0:3], v[40:43]
  ds_read_b64_tr_b16 a[236:237], v10 offset:27872
  buffer_load_dwordx4 a[72:75], v12, s[40:43], s90 offen offset:2048 sc1
  v_mfma_f32_16x16x32_bf16 v[40:43], a[212:215], a[4:7], v[40:43]
  ds_read_b64_tr_b16 a[238:239], v10 offset:32480
  v_mfma_f32_16x16x32_bf16 v[40:43], a[216:219], a[8:11], v[40:43]
  ds_read_b64_tr_b16 a[192:193], v10 offset:256
  v_mfma_f32_16x16x32_bf16 v[40:43], a[220:223], a[12:15], v[40:43]
  ds_read_b64_tr_b16 a[194:195], v10 offset:4864
  v_mfma_f32_16x16x32_bf16 v[44:47], a[208:211], a[16:19], v[44:47]
  ds_read_b64_tr_b16 a[196:197], v10 offset:9472
  buffer_load_dwordx4 a[76:79], v12, s[40:43], s90 offen offset:3072 sc1
  v_mfma_f32_16x16x32_bf16 v[44:47], a[212:215], a[20:23], v[44:47]
  s_add_u32 s90, s11, 73728
  ds_read_b64_tr_b16 a[198:199], v10 offset:14080
  v_mfma_f32_16x16x32_bf16 v[44:47], a[216:219], a[24:27], v[44:47]
  ds_read_b64_tr_b16 a[200:201], v10 offset:18688
  v_mfma_f32_16x16x32_bf16 v[44:47], a[220:223], a[28:31], v[44:47]
  s_waitcnt lgkmcnt(5) vmcnt(18)
  s_barrier
  v_mfma_f32_16x16x32_bf16 v[160:163], a[224:227], a[0:3], v[160:163]
  ds_read_b64_tr_b16 a[202:203], v10 offset:23296
  buffer_load_dwordx4 a[80:83], v12, s[40:43], s90 offen offset:0 sc1
  v_mfma_f32_16x16x32_bf16 v[160:163], a[228:231], a[4:7], v[160:163]
  ds_read_b64_tr_b16 a[204:205], v10 offset:27904
  ds_read_b64_tr_b16 a[206:207], v10 offset:32512
  v_mfma_f32_16x16x32_bf16 v[160:163], a[232:235], a[8:11], v[160:163]
  v_add_u32 v10, 49152, v10
  v_mfma_f32_16x16x32_bf16 v[160:163], a[236:239], a[12:15], v[160:163]
  ds_read_b64_tr_b16 a[208:209], v10 offset:64
  v_mfma_f32_16x16x32_bf16 v[164:167], a[224:227], a[16:19], v[164:167]
  ds_read_b64_tr_b16 a[210:211], v10 offset:4672
  buffer_load_dwordx4 a[84:87], v12, s[40:43], s90 offen offset:1024 sc1
  v_mfma_f32_16x16x32_bf16 v[164:167], a[228:231], a[20:23], v[164:167]
  ds_read_b64_tr_b16 a[212:213], v10 offset:9280
  v_mfma_f32_16x16x32_bf16 v[164:167], a[232:235], a[24:27], v[164:167]
  ds_read_b64_tr_b16 a[214:215], v10 offset:13888
  v_mfma_f32_16x16x32_bf16 v[164:167], a[236:239], a[28:31], v[164:167]
  s_waitcnt lgkmcnt(4)
  ds_read_b64_tr_b16 a[216:217], v10 offset:18496
  v_mfma_f32_16x16x32_bf16 v[168:171], a[192:195], a[0:3], v[168:171]
  ds_read_b64_tr_b16 a[218:219], v10 offset:23104
  buffer_load_dwordx4 a[88:91], v12, s[40:43], s90 offen offset:2048 sc1
  v_mfma_f32_16x16x32_bf16 v[168:171], a[196:199], a[4:7], v[168:171]
  ds_read_b64_tr_b16 a[220:221], v10 offset:27712
  ds_read_b64_tr_b16 a[222:223], v10 offset:32320
  v_mfma_f32_16x16x32_bf16 v[168:171], a[200:203], a[8:11], v[168:171]
  ds_read_b64_tr_b16 a[224:225], v10 offset:96
  v_mfma_f32_16x16x32_bf16 v[168:171], a[204:207], a[12:15], v[168:171]
  ds_read_b64_tr_b16 a[226:227], v10 offset:4704
  v_mfma_f32_16x16x32_bf16 v[172:175], a[192:195], a[16:19], v[172:175]
  ds_read_b64_tr_b16 a[228:229], v10 offset:9312
  buffer_load_dwordx4 a[92:95], v12, s[40:43], s90 offen offset:3072 sc1
  v_mfma_f32_16x16x32_bf16 v[172:175], a[196:199], a[20:23], v[172:175]
  ds_read_b64_tr_b16 a[230:231], v10 offset:13920
  v_lshrrev_b32 v22, 2, v0
  v_mfma_f32_16x16x32_bf16 v[172:175], a[200:203], a[24:27], v[172:175]
  s_waitcnt vmcnt(20)
  ds_read_b64_tr_b16 a[232:233], v10 offset:18528
  v_mul_u32_u24 v22, 288, v22
  v_mfma_f32_16x16x32_bf16 v[172:175], a[204:207], a[28:31], v[172:175]
  s_waitcnt lgkmcnt(5)
  ds_read_b64_tr_b16 a[234:235], v10 offset:23136
  v_and_b32 v23, 3, v0
  v_mfma_f32_16x16x32_bf16 v[240:243], a[208:211], a[32:35], v[240:243]
  ds_read_b64_tr_b16 a[236:237], v10 offset:27744
  buffer_load_dwordx2 v[112:113], v16, s[40:43], s91 offen offset:0 sc1
  v_mfma_f32_16x16x32_bf16 v[240:243], a[212:215], a[36:39], v[240:243]
  ds_read_b64_tr_b16 a[238:239], v10 offset:32352
  v_lshl_add_u32 v22, v23, 3, v22
  v_mfma_f32_16x16x32_bf16 v[240:243], a[216:219], a[40:43], v[240:243]
  ds_read_b64_tr_b16 a[192:193], v10 offset:128
  v_add_u32 v22, 110592, v22
  v_mfma_f32_16x16x32_bf16 v[240:243], a[220:223], a[44:47], v[240:243]
  ds_read_b64_tr_b16 a[194:195], v10 offset:4736
  buffer_load_dwordx2 v[114:115], v16, s[40:43], s91 offen offset:512 sc1
  v_mfma_f32_16x16x32_bf16 v[244:247], a[208:211], a[48:51], v[244:247]
  s_add_u32 m0, s64, 36864
  s_add_u32 s56, s8, 589824
  v_mfma_f32_16x16x32_bf16 v[244:247], a[212:215], a[52:55], v[244:247]
  ds_read_b64_tr_b16 a[196:197], v10 offset:9344
  buffer_load_dwordx4 v1, s[24:27], s56 offen lds
  v_mfma_f32_16x16x32_bf16 v[244:247], a[216:219], a[56:59], v[244:247]
  ds_read_b64_tr_b16 a[198:199], v10 offset:13952
  v_mfma_f32_16x16x32_bf16 v[244:247], a[220:223], a[60:63], v[244:247]
  s_waitcnt lgkmcnt(4)
  ds_read_b64_tr_b16 a[200:201], v10 offset:18560
  v_mfma_f32_16x16x32_bf16 v[248:251], a[224:227], a[32:35], v[248:251]
  ds_read_b64_tr_b16 a[202:203], v10 offset:23168
  v_mfma_f32_16x16x32_bf16 v[248:251], a[228:231], a[36:39], v[248:251]
  ds_read_b64_tr_b16 a[204:205], v10 offset:27776
  ds_read_b64_tr_b16 a[206:207], v10 offset:32384
  v_mfma_f32_16x16x32_bf16 v[248:251], a[232:235], a[40:43], v[248:251]
  ds_read_b64_tr_b16 a[208:209], v10 offset:160
  buffer_load_dwordx4 v2, s[24:27], s56 offen offset:1024 lds
  v_mfma_f32_16x16x32_bf16 v[248:251], a[236:239], a[44:47], v[248:251]
  s_waitcnt vmcnt(22)
  ds_read_b64_tr_b16 a[210:211], v10 offset:4768
  v_mul_f32 v240, v240, v17
  v_mfma_f32_16x16x32_bf16 v[252:255], a[224:227], a[48:51], v[252:255]
  ds_read_b64_tr_b16 a[212:213], v10 offset:9376
  v_mul_f32 v241, v241, v17
  v_mfma_f32_16x16x32_bf16 v[252:255], a[228:231], a[52:55], v[252:255]
  ds_read_b64_tr_b16 a[214:215], v10 offset:13984
  v_mul_f32 v242, v242, v17
  v_mfma_f32_16x16x32_bf16 v[252:255], a[232:235], a[56:59], v[252:255]
  ds_read_b64_tr_b16 a[216:217], v10 offset:18592
  v_mul_f32 v243, v243, v17
  v_mfma_f32_16x16x32_bf16 v[252:255], a[236:239], a[60:63], v[252:255]
  s_waitcnt lgkmcnt(5)
  ds_read_b64_tr_b16 a[218:219], v10 offset:23200
  v_mul_f32 v244, v244, v18
  v_mfma_f32_16x16x32_bf16 v[24:27], a[192:195], a[32:35], v[24:27]
  ds_read_b64_tr_b16 a[220:221], v10 offset:27808
  buffer_load_dwordx4 v3, s[24:27], s56 offen offset:2048 lds
  v_mfma_f32_16x16x32_bf16 v[24:27], a[196:199], a[36:39], v[24:27]
  ds_read_b64_tr_b16 a[222:223], v10 offset:32416
  v_mul_f32 v245, v245, v18
  v_mfma_f32_16x16x32_bf16 v[24:27], a[200:203], a[40:43], v[24:27]
  ds_read_b64_tr_b16 a[224:225], v10 offset:192
  v_mul_f32 v246, v246, v18
  v_mfma_f32_16x16x32_bf16 v[24:27], a[204:207], a[44:47], v[24:27]
  ds_read_b64_tr_b16 a[226:227], v10 offset:4800
  buffer_load_dwordx4 v4, s[24:27], s56 offen offset:3072 lds
  v_mfma_f32_16x16x32_bf16 v[28:31], a[192:195], a[48:51], v[28:31]
  s_add_u32 m0, s64, 40960
  s_mov_b32 s57, s10
  v_mul_f32 v247, v247, v18
  v_mfma_f32_16x16x32_bf16 v[28:31], a[196:199], a[52:55], v[28:31]
  ds_read_b64_tr_b16 a[228:229], v10 offset:9408
  v_mul_f32 v248, v248, v17
  v_mfma_f32_16x16x32_bf16 v[28:31], a[200:203], a[56:59], v[28:31]
  ds_read_b64_tr_b16 a[230:231], v10 offset:14016
  v_mul_f32 v249, v249, v17
  v_mfma_f32_16x16x32_bf16 v[28:31], a[204:207], a[60:63], v[28:31]
  s_waitcnt lgkmcnt(4)
  ds_read_b64_tr_b16 a[232:233], v10 offset:18624
  v_mul_f32 v250, v250, v17
  v_mfma_f32_16x16x32_bf16 v[32:35], a[208:211], a[32:35], v[32:35]
  ds_read_b64_tr_b16 a[234:235], v10 offset:23232
  s_mov_b32 exec_hi, 0
  buffer_load_dwordx4 v5, s[24:27], s56 offen lds
  s_mov_b32 exec_hi, -1
  s_mov_b32 exec_lo, 0
  buffer_load_dwordx4 v5, s[12:15], s57 offen lds
  s_mov_b32 exec_lo, -1
  v_mfma_f32_16x16x32_bf16 v[32:35], a[212:215], a[36:39], v[32:35]
  ds_read_b64_tr_b16 a[236:237], v10 offset:27840
  ds_read_b64_tr_b16 a[238:239], v10 offset:32448
  v_mfma_f32_16x16x32_bf16 v[32:35], a[216:219], a[40:43], v[32:35]
  ds_read_b64_tr_b16 a[192:193], v10 offset:224
  v_mul_f32 v251, v251, v17
  v_mfma_f32_16x16x32_bf16 v[32:35], a[220:223], a[44:47], v[32:35]
  ds_read_b64_tr_b16 a[194:195], v10 offset:4832
  v_mul_f32 v252, v252, v18
  v_mfma_f32_16x16x32_bf16 v[36:39], a[208:211], a[48:51], v[36:39]
  ds_read_b64_tr_b16 a[196:197], v10 offset:9440
  v_mul_f32 v253, v253, v18
  v_mfma_f32_16x16x32_bf16 v[36:39], a[212:215], a[52:55], v[36:39]
  ds_read_b64_tr_b16 a[198:199], v10 offset:14048
  buffer_load_dwordx4 v6, s[12:15], s57 offen offset:1024 lds
  v_mfma_f32_16x16x32_bf16 v[36:39], a[216:219], a[56:59], v[36:39]
  ds_read_b64_tr_b16 a[200:201], v10 offset:18656
  v_mul_f32 v254, v254, v18
  v_mfma_f32_16x16x32_bf16 v[36:39], a[220:223], a[60:63], v[36:39]
  s_waitcnt lgkmcnt(5)
  ds_read_b64_tr_b16 a[202:203], v10 offset:23264
  v_mul_f32 v255, v255, v18
  v_mfma_f32_16x16x32_bf16 v[40:43], a[224:227], a[32:35], v[40:43]
  ds_read_b64_tr_b16 a[204:205], v10 offset:27872
  v_mul_f32 v24, v24, v17
  v_mfma_f32_16x16x32_bf16 v[40:43], a[228:231], a[36:39], v[40:43]
  ds_read_b64_tr_b16 a[206:207], v10 offset:32480
  v_mul_f32 v25, v25, v17
  v_mfma_f32_16x16x32_bf16 v[40:43], a[232:235], a[40:43], v[40:43]
  ds_read_b64_tr_b16 a[208:209], v10 offset:256
  buffer_load_dwordx4 v7, s[12:15], s57 offen offset:2048 lds
  v_mfma_f32_16x16x32_bf16 v[40:43], a[236:239], a[44:47], v[40:43]
  ds_read_b64_tr_b16 a[210:211], v10 offset:4864
  v_mul_f32 v26, v26, v17
  v_mfma_f32_16x16x32_bf16 v[44:47], a[224:227], a[48:51], v[44:47]
  ds_read_b64_tr_b16 a[212:213], v10 offset:9472
  v_mul_f32 v27, v27, v17
  v_mfma_f32_16x16x32_bf16 v[44:47], a[228:231], a[52:55], v[44:47]
  ds_read_b64_tr_b16 a[214:215], v10 offset:14080
  v_mul_f32 v28, v28, v18
  v_mfma_f32_16x16x32_bf16 v[44:47], a[232:235], a[56:59], v[44:47]
  ds_read_b64_tr_b16 a[216:217], v10 offset:18688
  buffer_load_dwordx4 v8, s[12:15], s57 offen offset:3072 lds
  v_mfma_f32_16x16x32_bf16 v[44:47], a[236:239], a[60:63], v[44:47]
  s_waitcnt lgkmcnt(5) vmcnt(19)
  s_barrier
  v_mfma_f32_16x16x32_bf16 v[160:163], a[192:195], a[32:35], v[160:163]
  s_add_u32 m0, s64, 45056
  ds_read_b64_tr_b16 a[218:219], v10 offset:23296
  v_mul_f32 v29, v29, v18
  v_mfma_f32_16x16x32_bf16 v[160:163], a[196:199], a[36:39], v[160:163]
  ds_read_b64_tr_b16 a[220:221], v10 offset:27904
  ds_read_b64_tr_b16 a[222:223], v10 offset:32512
  v_mfma_f32_16x16x32_bf16 v[160:163], a[200:203], a[40:43], v[160:163]
  buffer_load_dwordx4 v9, s[12:15], s57 offen lds
  v_mfma_f32_16x16x32_bf16 v[160:163], a[204:207], a[44:47], v[160:163]
  s_add_u32 s90, s72, 32768
  v_subrev_u32 v10, 122880, v10
  v_mul_f32 v30, v30, v18
  v_mfma_f32_16x16x32_bf16 v[164:167], a[192:195], a[48:51], v[164:167]
  ds_read_b64_tr_b16 a[224:225], v10 offset:64
  v_mul_f32 v31, v31, v18
  v_mfma_f32_16x16x32_bf16 v[164:167], a[196:199], a[52:55], v[164:167]
  ds_read_b64_tr_b16 a[226:227], v10 offset:4672
  v_mul_f32 v32, v32, v17
  v_mfma_f32_16x16x32_bf16 v[164:167], a[200:203], a[56:59], v[164:167]
  ds_read_b64_tr_b16 a[228:229], v10 offset:9280
  v_mul_f32 v33, v33, v17
  v_mfma_f32_16x16x32_bf16 v[164:167], a[204:207], a[60:63], v[164:167]
  s_waitcnt lgkmcnt(3)
  ds_read_b64_tr_b16 a[230:231], v10 offset:13888
  v_mul_f32 v34, v34, v17
  v_mfma_f32_16x16x32_bf16 v[168:171], a[208:211], a[32:35], v[168:171]
  ds_read_b64_tr_b16 a[232:233], v10 offset:18496
  buffer_load_dwordx4 a[96:99], v12, s[40:43], s90 offen offset:0 sc1
  v_mfma_f32_16x16x32_bf16 v[168:171], a[212:215], a[36:39], v[168:171]
  ds_read_b64_tr_b16 a[234:235], v10 offset:23104
  ds_read_b64_tr_b16 a[236:237], v10 offset:27712
  ds_read_b64_tr_b16 a[238:239], v10 offset:32320
  v_mfma_f32_16x16x32_bf16 v[168:171], a[216:219], a[40:43], v[168:171]
  ds_read_b64_tr_b16 a[192:193], v10 offset:96
  v_mul_f32 v35, v35, v17
  v_mfma_f32_16x16x32_bf16 v[168:171], a[220:223], a[44:47], v[168:171]
  ds_read_b64_tr_b16 a[194:195], v10 offset:4704
  buffer_load_dwordx4 a[100:103], v12, s[40:43], s90 offen offset:1024 sc1
  v_mfma_f32_16x16x32_bf16 v[172:175], a[208:211], a[48:51], v[172:175]
  ds_read_b64_tr_b16 a[196:197], v10 offset:9312
  v_mul_f32 v36, v36, v18
  v_mfma_f32_16x16x32_bf16 v[172:175], a[212:215], a[52:55], v[172:175]
  ds_read_b64_tr_b16 a[198:199], v10 offset:13920
  v_mul_f32 v37, v37, v18
  v_mfma_f32_16x16x32_bf16 v[172:175], a[216:219], a[56:59], v[172:175]
  s_waitcnt vmcnt(14)
  ds_read_b64_tr_b16 a[200:201], v10 offset:18528
  v_mul_f32 v38, v38, v18
  v_mfma_f32_16x16x32_bf16 v[172:175], a[220:223], a[60:63], v[172:175]
  s_waitcnt lgkmcnt(5)
  ds_read_b64_tr_b16 a[202:203], v10 offset:23136
  v_mul_f32 v39, v39, v18
  v_mfma_f32_16x16x32_bf16 v[240:243], a[224:227], a[64:67], v[240:243]
  ds_read_b64_tr_b16 a[204:205], v10 offset:27744
  buffer_load_dwordx4 a[104:107], v12, s[40:43], s90 offen offset:2048 sc1
  v_mfma_f32_16x16x32_bf16 v[240:243], a[228:231], a[68:71], v[240:243]
  ds_read_b64_tr_b16 a[206:207], v10 offset:32352
  v_mul_f32 v40, v40, v17
  v_mfma_f32_16x16x32_bf16 v[240:243], a[232:235], a[72:75], v[240:243]
  ds_read_b64_tr_b16 v[116:117], v22 offset:0
  v_mul_f32 v41, v41, v17
  v_mfma_f32_16x16x32_bf16 v[240:243], a[236:239], a[76:79], v[240:243]
  ds_read_b64_tr_b16 v[120:121], v22 offset:64
  buffer_load_dwordx4 a[108:111], v12, s[40:43], s90 offen offset:3072 sc1
  v_mfma_f32_16x16x32_bf16 v[244:247], a[224:227], a[80:83], v[244:247]
  s_add_u32 s90, s72, 73728
  ds_read_b64_tr_b16 a[208:209], v10 offset:128
  v_mul_f32 v42, v42, v17
  v_mfma_f32_16x16x32_bf16 v[244:247], a[228:231], a[84:87], v[244:247]
  ds_read_b64_tr_b16 a[210:211], v10 offset:4736
  v_mul_f32 v43, v43, v17
  v_mfma_f32_16x16x32_bf16 v[244:247], a[232:235], a[88:91], v[244:247]
  ds_read_b64_tr_b16 a[212:213], v10 offset:9344
  v_mul_f32 v44, v44, v18
  v_mfma_f32_16x16x32_bf16 v[244:247], a[236:239], a[92:95], v[244:247]
  s_waitcnt lgkmcnt(5)
  ds_read_b64_tr_b16 a[214:215], v10 offset:13952
  v_mul_f32 v45, v45, v18
  v_mfma_f32_16x16x32_bf16 v[248:251], a[192:195], a[64:67], v[248:251]
  ds_read_b64_tr_b16 a[216:217], v10 offset:18560
  buffer_load_dwordx4 a[112:115], v12, s[40:43], s90 offen offset:0 sc1
  v_mfma_f32_16x16x32_bf16 v[248:251], a[196:199], a[68:71], v[248:251]
  ds_read_b64_tr_b16 a[218:219], v10 offset:23168
  ds_read_b64_tr_b16 a[220:221], v10 offset:27776
  ds_read_b64_tr_b16 a[222:223], v10 offset:32384
  v_mfma_f32_16x16x32_bf16 v[248:251], a[200:203], a[72:75], v[248:251]
  ds_read_b64_tr_b16 v[118:119], v22 offset:32
  v_mul_f32 v46, v46, v18
  v_mfma_f32_16x16x32_bf16 v[248:251], a[204:207], a[76:79], v[248:251]
  ds_read_b64_tr_b16 v[122:123], v22 offset:96
  buffer_load_dwordx4 a[116:119], v12, s[40:43], s90 offen offset:1024 sc1
  v_mfma_f32_16x16x32_bf16 v[252:255], a[192:195], a[80:83], v[252:255]
  s_waitcnt vmcnt(16)
  ds_read_b64_tr_b16 a[224:225], v10 offset:160
  v_mul_f32 v47, v47, v18
  v_mfma_f32_16x16x32_bf16 v[252:255], a[196:199], a[84:87], v[252:255]
  s_waitcnt lgkmcnt(11)
  ds_read_b64_tr_b16 a[226:227], v10 offset:4768
  v_mul_f32 v160, v160, v17
  v_mfma_f32_16x16x32_bf16 v[252:255], a[200:203], a[88:91], v[252:255]
  ds_read_b64_tr_b16 a[228:229], v10 offset:9376
  v_mfma_f32_16x16x16_bf16 v[240:243], v[120:121], v[112:113], v[240:243]
  v_mfma_f32_16x16x32_bf16 v[252:255], a[204:207], a[92:95], v[252:255]
  s_waitcnt lgkmcnt(5)
  ds_read_b64_tr_b16 a[230:231], v10 offset:13984
  v_mul_f32 v161, v161, v17
  v_mfma_f32_16x16x32_bf16 v[24:27], a[208:211], a[64:67], v[24:27]
  ds_read_b64_tr_b16 a[232:233], v10 offset:18592
  v_mfma_f32_16x16x16_bf16 v[244:247], v[120:121], v[114:115], v[244:247]
  v_mfma_f32_16x16x32_bf16 v[24:27], a[212:215], a[68:71], v[24:27]
  ds_read_b64_tr_b16 a[234:235], v10 offset:23200
  ds_read_b64_tr_b16 a[236:237], v10 offset:27808
  ds_read_b64_tr_b16 a[238:239], v10 offset:32416
  v_mfma_f32_16x16x32_bf16 v[24:27], a[216:219], a[72:75], v[24:27]
  ds_read_b64_tr_b16 v[124:125], v22 offset:128
  buffer_load_dwordx4 a[120:123], v12, s[40:43], s90 offen offset:2048 sc1
  v_mfma_f32_16x16x32_bf16 v[24:27], a[220:223], a[76:79], v[24:27]
  ds_read_b64_tr_b16 a[192:193], v10 offset:192
  buffer_load_dwordx4 a[124:127], v12, s[40:43], s90 offen offset:3072 sc1
  v_mfma_f32_16x16x32_bf16 v[28:31], a[208:211], a[80:83], v[28:31]
  s_waitcnt lgkmcnt(10)
  ds_read_b64_tr_b16 a[194:195], v10 offset:4800
  v_mul_f32 v162, v162, v17
  v_mfma_f32_16x16x32_bf16 v[28:31], a[212:215], a[84:87], v[28:31]
  ds_read_b64_tr_b16 a[196:197], v10 offset:9408
  v_mfma_f32_16x16x16_bf16 v[248:251], v[122:123], v[112:113], v[248:251]
  v_mfma_f32_16x16x32_bf16 v[28:31], a[216:219], a[88:91], v[28:31]
  ds_read_b64_tr_b16 a[198:199], v10 offset:14016
  v_mfma_f32_16x16x16_bf16 v[252:255], v[122:123], v[114:115], v[252:255]
  v_mfma_f32_16x16x32_bf16 v[28:31], a[220:223], a[92:95], v[28:31]
  s_waitcnt lgkmcnt(5)
  ds_read_b64_tr_b16 a[200:201], v10 offset:18624
  v_mul_f32 v163, v163, v17
  v_mfma_f32_16x16x32_bf16 v[32:35], a[224:227], a[64:67], v[32:35]
  ds_read_b64_tr_b16 a[202:203], v10 offset:23232
  v_mul_f32 v164, v164, v18
  v_mfma_f32_16x16x32_bf16 v[32:35], a[228:231], a[68:71], v[32:35]
  ds_read_b64_tr_b16 a[204:205], v10 offset:27840
  ds_read_b64_tr_b16 a[206:207], v10 offset:32448
  v_mfma_f32_16x16x32_bf16 v[32:35], a[232:235], a[72:75], v[32:35]
  ds_read_b64_tr_b16 v[126:127], v22 offset:160
  v_mul_f32 v165, v165, v18
  v_mfma_f32_16x16x32_bf16 v[32:35], a[236:239], a[76:79], v[32:35]
  ds_read_b64_tr_b16 a[208:209], v10 offset:224
  v_mul_f32 v166, v166, v18
  v_mfma_f32_16x16x32_bf16 v[36:39], a[224:227], a[80:83], v[36:39]
  s_waitcnt lgkmcnt(10)
  ds_read_b64_tr_b16 a[210:211], v10 offset:4832
  v_mul_f32 v167, v167, v18
  v_mfma_f32_16x16x32_bf16 v[36:39], a[228:231], a[84:87], v[36:39]
  ds_read_b64_tr_b16 a[212:213], v10 offset:9440
  v_mfma_f32_16x16x16_bf16 v[24:27], v[124:125], v[112:113], v[24:27]
  v_mfma_f32_16x16x32_bf16 v[36:39], a[232:235], a[88:91], v[36:39]
  ds_read_b64_tr_b16 a[214:215], v10 offset:14048
  v_mfma_f32_16x16x16_bf16 v[28:31], v[124:125], v[114:115], v[28:31]
  v_mfma_f32_16x16x32_bf16 v[36:39], a[236:239], a[92:95], v[36:39]
  s_waitcnt lgkmcnt(5)
  ds_read_b64_tr_b16 a[216:217], v10 offset:18656
  v_mul_f32 v168, v168, v17
  v_mfma_f32_16x16x32_bf16 v[40:43], a[192:195], a[64:67], v[40:43]
  ds_read_b64_tr_b16 a[218:219], v10 offset:23264
  v_mul_f32 v169, v169, v17
  v_mfma_f32_16x16x32_bf16 v[40:43], a[196:199], a[68:71], v[40:43]
  ds_read_b64_tr_b16 a[220:221], v10 offset:27872
  ds_read_b64_tr_b16 a[222:223], v10 offset:32480
  v_mfma_f32_16x16x32_bf16 v[40:43], a[200:203], a[72:75], v[40:43]
  ds_read_b64_tr_b16 v[192:193], v22 offset:192
  v_mul_f32 v170, v170, v17
  v_mfma_f32_16x16x32_bf16 v[40:43], a[204:207], a[76:79], v[40:43]
  ds_read_b64_tr_b16 a[224:225], v10 offset:256
  v_mul_f32 v171, v171, v17
  v_mfma_f32_16x16x32_bf16 v[44:47], a[192:195], a[80:83], v[44:47]
  s_waitcnt lgkmcnt(10)
  ds_read_b64_tr_b16 a[226:227], v10 offset:4864
  v_mul_f32 v172, v172, v18
  v_mfma_f32_16x16x32_bf16 v[44:47], a[196:199], a[84:87], v[44:47]
  ds_read_b64_tr_b16 a[228:229], v10 offset:9472
  v_mfma_f32_16x16x16_bf16 v[32:35], v[126:127], v[112:113], v[32:35]
  v_mfma_f32_16x16x32_bf16 v[44:47], a[200:203], a[88:91], v[44:47]
  ds_read_b64_tr_b16 a[230:231], v10 offset:14080
  v_mfma_f32_16x16x16_bf16 v[36:39], v[126:127], v[114:115], v[36:39]
  v_mfma_f32_16x16x32_bf16 v[44:47], a[204:207], a[92:95], v[44:47]
  s_waitcnt lgkmcnt(5) vmcnt(8)
  s_barrier
  v_mfma_f32_16x16x32_bf16 v[160:163], a[208:211], a[64:67], v[160:163]
  ds_read_b64_tr_b16 a[232:233], v10 offset:18688
  v_mul_f32 v173, v173, v18
  v_mfma_f32_16x16x32_bf16 v[160:163], a[212:215], a[68:71], v[160:163]
  ds_read_b64_tr_b16 a[234:235], v10 offset:23296
  ds_read_b64_tr_b16 a[236:237], v10 offset:27904
  ds_read_b64_tr_b16 a[238:239], v10 offset:32512
  v_mfma_f32_16x16x32_bf16 v[160:163], a[216:219], a[72:75], v[160:163]
  ds_read_b64_tr_b16 v[194:195], v22 offset:224
  v_add_u32 v10, 36864, v10
  v_mfma_f32_16x16x32_bf16 v[160:163], a[220:223], a[76:79], v[160:163]
  ds_read_b64_tr_b16 a[192:193], v10 offset:64
  v_mul_f32 v174, v174, v18
  v_mfma_f32_16x16x32_bf16 v[164:167], a[208:211], a[80:83], v[164:167]
  s_waitcnt lgkmcnt(10)
  ds_read_b64_tr_b16 a[194:195], v10 offset:4672
  v_mul_f32 v175, v175, v18
  v_mfma_f32_16x16x32_bf16 v[164:167], a[212:215], a[84:87], v[164:167]
  ds_read_b64_tr_b16 a[196:197], v10 offset:9280
  v_mfma_f32_16x16x16_bf16 v[40:43], v[192:193], v[112:113], v[40:43]
  v_mfma_f32_16x16x32_bf16 v[164:167], a[216:219], a[88:91], v[164:167]
  ds_read_b64_tr_b16 a[198:199], v10 offset:13888
  v_mfma_f32_16x16x16_bf16 v[44:47], v[192:193], v[114:115], v[44:47]
  v_mfma_f32_16x16x32_bf16 v[164:167], a[220:223], a[92:95], v[164:167]
  s_waitcnt lgkmcnt(5)
  ds_read_b64_tr_b16 a[200:201], v10 offset:18496
  v_mfma_f32_16x16x32_bf16 v[168:171], a[224:227], a[64:67], v[168:171]
  ds_read_b64_tr_b16 a[202:203], v10 offset:23104
  v_mfma_f32_16x16x32_bf16 v[168:171], a[228:231], a[68:71], v[168:171]
  ds_read_b64_tr_b16 a[204:205], v10 offset:27712
  ds_read_b64_tr_b16 a[206:207], v10 offset:32320
  v_mfma_f32_16x16x32_bf16 v[168:171], a[232:235], a[72:75], v[168:171]
  ds_read_b64_tr_b16 v[196:197], v22 offset:256
  v_mfma_f32_16x16x32_bf16 v[168:171], a[236:239], a[76:79], v[168:171]
  ds_read_b64_tr_b16 a[208:209], v10 offset:96
  v_mfma_f32_16x16x32_bf16 v[172:175], a[224:227], a[80:83], v[172:175]
  s_waitcnt lgkmcnt(10)
  ds_read_b64_tr_b16 a[210:211], v10 offset:4704
  v_mfma_f32_16x16x32_bf16 v[172:175], a[228:231], a[84:87], v[172:175]
  ds_read_b64_tr_b16 a[212:213], v10 offset:9312
  v_mfma_f32_16x16x16_bf16 v[160:163], v[194:195], v[112:113], v[160:163]
  v_mfma_f32_16x16x32_bf16 v[172:175], a[232:235], a[88:91], v[172:175]
  ds_read_b64_tr_b16 a[214:215], v10 offset:13920
  v_mfma_f32_16x16x16_bf16 v[164:167], v[194:195], v[114:115], v[164:167]
  v_mfma_f32_16x16x32_bf16 v[172:175], a[236:239], a[92:95], v[172:175]
  s_waitcnt vmcnt(0) lgkmcnt(5)
  v_mfma_f32_16x16x32_bf16 v[240:243], a[192:195], a[96:99], v[240:243]
  ds_read_b64_tr_b16 a[216:217], v10 offset:18528
  v_mfma_f32_16x16x32_bf16 v[240:243], a[196:199], a[100:103], v[240:243]
  ds_read_b64_tr_b16 a[218:219], v10 offset:23136
  ds_read_b64_tr_b16 a[220:221], v10 offset:27744
  ds_read_b64_tr_b16 a[222:223], v10 offset:32352
  v_mfma_f32_16x16x32_bf16 v[240:243], a[200:203], a[104:107], v[240:243]
  ds_read_b64_tr_b16 a[224:225], v10 offset:128
  v_mfma_f32_16x16x32_bf16 v[240:243], a[204:207], a[108:111], v[240:243]
  ds_read_b64_tr_b16 a[226:227], v10 offset:4736
  v_mfma_f32_16x16x32_bf16 v[244:247], a[192:195], a[112:115], v[244:247]
  s_waitcnt lgkmcnt(10)
  ds_read_b64_tr_b16 a[228:229], v10 offset:9344
  v_mfma_f32_16x16x32_bf16 v[244:247], a[196:199], a[116:119], v[244:247]
  ds_read_b64_tr_b16 a[230:231], v10 offset:13952
  v_mfma_f32_16x16x16_bf16 v[168:171], v[196:197], v[112:113], v[168:171]
  v_mfma_f32_16x16x32_bf16 v[244:247], a[200:203], a[120:123], v[244:247]
  ds_read_b64_tr_b16 a[232:233], v10 offset:18560
  v_mfma_f32_16x16x16_bf16 v[172:175], v[196:197], v[114:115], v[172:175]
  v_mfma_f32_16x16x32_bf16 v[244:247], a[204:207], a[124:127], v[244:247]
  s_waitcnt lgkmcnt(5)
  ds_read_b64_tr_b16 a[234:235], v10 offset:23168
  v_mfma_f32_16x16x32_bf16 v[248:251], a[208:211], a[96:99], v[248:251]
  ds_read_b64_tr_b16 a[236:237], v10 offset:27776
  v_mfma_f32_16x16x32_bf16 v[248:251], a[212:215], a[100:103], v[248:251]
  ds_read_b64_tr_b16 a[238:239], v10 offset:32384
  v_mfma_f32_16x16x32_bf16 v[248:251], a[216:219], a[104:107], v[248:251]
  ds_read_b64_tr_b16 a[192:193], v10 offset:160
  v_cvt_pk_bf16_f32 v216, v240, v241
  v_mfma_f32_16x16x32_bf16 v[248:251], a[220:223], a[108:111], v[248:251]
  ds_read_b64_tr_b16 a[194:195], v10 offset:4768
  v_cvt_pk_bf16_f32 v217, v242, v243
  v_mfma_f32_16x16x32_bf16 v[252:255], a[208:211], a[112:115], v[252:255]
  ds_read_b64_tr_b16 a[196:197], v10 offset:9376
  v_cvt_pk_bf16_f32 v218, v244, v245
  v_mfma_f32_16x16x32_bf16 v[252:255], a[212:215], a[116:119], v[252:255]
  ds_read_b64_tr_b16 a[198:199], v10 offset:13984
  v_cvt_pk_bf16_f32 v219, v246, v247
  v_mfma_f32_16x16x32_bf16 v[252:255], a[216:219], a[120:123], v[252:255]
  ds_read_b64_tr_b16 a[200:201], v10 offset:18592
  buffer_store_dwordx4 v[216:219], v11, s[40:43], s86 offen sc1
  v_mfma_f32_16x16x32_bf16 v[252:255], a[220:223], a[124:127], v[252:255]
  s_waitcnt lgkmcnt(5)
  ds_read_b64_tr_b16 a[202:203], v10 offset:23200
  v_mfma_f32_16x16x32_bf16 v[24:27], a[224:227], a[96:99], v[24:27]
  ds_read_b64_tr_b16 a[204:205], v10 offset:27808
  v_mfma_f32_16x16x32_bf16 v[24:27], a[228:231], a[100:103], v[24:27]
  ds_read_b64_tr_b16 a[206:207], v10 offset:32416
  v_mfma_f32_16x16x32_bf16 v[24:27], a[232:235], a[104:107], v[24:27]
  ds_read_b64_tr_b16 a[208:209], v10 offset:192
  v_cvt_pk_bf16_f32 v220, v248, v249
  v_mfma_f32_16x16x32_bf16 v[24:27], a[236:239], a[108:111], v[24:27]
  ds_read_b64_tr_b16 a[210:211], v10 offset:4800
  v_cvt_pk_bf16_f32 v221, v250, v251
  v_mfma_f32_16x16x32_bf16 v[28:31], a[224:227], a[112:115], v[28:31]
  ds_read_b64_tr_b16 a[212:213], v10 offset:9408
  v_cvt_pk_bf16_f32 v222, v252, v253
  v_mfma_f32_16x16x32_bf16 v[28:31], a[228:231], a[116:119], v[28:31]
  ds_read_b64_tr_b16 a[214:215], v10 offset:14016
  v_cvt_pk_bf16_f32 v223, v254, v255
  v_mfma_f32_16x16x32_bf16 v[28:31], a[232:235], a[120:123], v[28:31]
  ds_read_b64_tr_b16 a[216:217], v10 offset:18624
  buffer_store_dwordx4 v[220:223], v11, s[40:43], s87 offen sc1
  v_mfma_f32_16x16x32_bf16 v[28:31], a[236:239], a[124:127], v[28:31]
  s_waitcnt lgkmcnt(5)
  ds_read_b64_tr_b16 a[218:219], v10 offset:23232
  v_mfma_f32_16x16x32_bf16 v[32:35], a[192:195], a[96:99], v[32:35]
  ds_read_b64_tr_b16 a[220:221], v10 offset:27840
  v_mfma_f32_16x16x32_bf16 v[32:35], a[196:199], a[100:103], v[32:35]
  ds_read_b64_tr_b16 a[222:223], v10 offset:32448
  v_mfma_f32_16x16x32_bf16 v[32:35], a[200:203], a[104:107], v[32:35]
  ds_read_b64_tr_b16 a[224:225], v10 offset:224
  v_cvt_pk_bf16_f32 v208, v24, v25
  v_mfma_f32_16x16x32_bf16 v[32:35], a[204:207], a[108:111], v[32:35]
  ds_read_b64_tr_b16 a[226:227], v10 offset:4832
  v_cvt_pk_bf16_f32 v209, v26, v27
  v_mfma_f32_16x16x32_bf16 v[36:39], a[192:195], a[112:115], v[36:39]
  ds_read_b64_tr_b16 a[228:229], v10 offset:9440
  v_cvt_pk_bf16_f32 v210, v28, v29
  v_mfma_f32_16x16x32_bf16 v[36:39], a[196:199], a[116:119], v[36:39]
  ds_read_b64_tr_b16 a[230:231], v10 offset:14048
  v_cvt_pk_bf16_f32 v211, v30, v31
  v_mfma_f32_16x16x32_bf16 v[36:39], a[200:203], a[120:123], v[36:39]
  ds_read_b64_tr_b16 a[232:233], v10 offset:18656
  buffer_store_dwordx4 v[208:211], v11, s[40:43], s3 offen sc1
  v_mfma_f32_16x16x32_bf16 v[36:39], a[204:207], a[124:127], v[36:39]
  s_waitcnt lgkmcnt(5)
  ds_read_b64_tr_b16 a[234:235], v10 offset:23264
  v_mfma_f32_16x16x32_bf16 v[40:43], a[208:211], a[96:99], v[40:43]
  ds_read_b64_tr_b16 a[236:237], v10 offset:27872
  v_mfma_f32_16x16x32_bf16 v[40:43], a[212:215], a[100:103], v[40:43]
  ds_read_b64_tr_b16 a[238:239], v10 offset:32480
  v_mfma_f32_16x16x32_bf16 v[40:43], a[216:219], a[104:107], v[40:43]
  ds_read_b64_tr_b16 a[192:193], v10 offset:256
  v_cvt_pk_bf16_f32 v212, v32, v33
  v_mfma_f32_16x16x32_bf16 v[40:43], a[220:223], a[108:111], v[40:43]
  ds_read_b64_tr_b16 a[194:195], v10 offset:4864
  v_cvt_pk_bf16_f32 v213, v34, v35
  v_mfma_f32_16x16x32_bf16 v[44:47], a[208:211], a[112:115], v[44:47]
  ds_read_b64_tr_b16 a[196:197], v10 offset:9472
  v_cvt_pk_bf16_f32 v214, v36, v37
  v_mfma_f32_16x16x32_bf16 v[44:47], a[212:215], a[116:119], v[44:47]
  ds_read_b64_tr_b16 a[198:199], v10 offset:14080
  v_cvt_pk_bf16_f32 v215, v38, v39
  v_mfma_f32_16x16x32_bf16 v[44:47], a[216:219], a[120:123], v[44:47]
  ds_read_b64_tr_b16 a[200:201], v10 offset:18688
  buffer_store_dwordx4 v[212:215], v11, s[40:43], s100 offen sc1
  v_mfma_f32_16x16x32_bf16 v[44:47], a[220:223], a[124:127], v[44:47]
  s_waitcnt lgkmcnt(5)
  ds_read_b64_tr_b16 a[202:203], v10 offset:23296
  v_mfma_f32_16x16x32_bf16 v[160:163], a[224:227], a[96:99], v[160:163]
  ds_read_b64_tr_b16 a[204:205], v10 offset:27904
  v_mfma_f32_16x16x32_bf16 v[160:163], a[228:231], a[100:103], v[160:163]
  ds_read_b64_tr_b16 a[206:207], v10 offset:32512
  v_add_u32 v10, 36864, v10
  v_mfma_f32_16x16x32_bf16 v[160:163], a[232:235], a[104:107], v[160:163]
  ds_read_b64_tr_b16 a[208:209], v10 offset:0
  v_cvt_pk_bf16_f32 v216, v40, v41
  v_mfma_f32_16x16x32_bf16 v[160:163], a[236:239], a[108:111], v[160:163]
  ds_read_b64_tr_b16 a[210:211], v10 offset:4608
  v_cvt_pk_bf16_f32 v217, v42, v43
  v_mfma_f32_16x16x32_bf16 v[164:167], a[224:227], a[112:115], v[164:167]
  ds_read_b64_tr_b16 a[212:213], v10 offset:9216
  v_cvt_pk_bf16_f32 v218, v44, v45
  v_mfma_f32_16x16x32_bf16 v[164:167], a[228:231], a[116:119], v[164:167]
  ds_read_b64_tr_b16 a[214:215], v10 offset:13824
  v_cvt_pk_bf16_f32 v219, v46, v47
  v_mfma_f32_16x16x32_bf16 v[164:167], a[232:235], a[120:123], v[164:167]
  ds_read_b64_tr_b16 a[216:217], v10 offset:18432
  buffer_store_dwordx4 v[216:219], v11, s[40:43], s101 offen sc1
  v_mfma_f32_16x16x32_bf16 v[164:167], a[236:239], a[124:127], v[164:167]
  s_waitcnt lgkmcnt(5)
  ds_read_b64_tr_b16 a[218:219], v10 offset:23040
  v_mfma_f32_16x16x32_bf16 v[168:171], a[192:195], a[96:99], v[168:171]
  ds_read_b64_tr_b16 a[220:221], v10 offset:27648
  v_mfma_f32_16x16x32_bf16 v[168:171], a[196:199], a[100:103], v[168:171]
  ds_read_b64_tr_b16 a[222:223], v10 offset:32256
  v_add_u32 v10, 49152, v10
  v_mfma_f32_16x16x32_bf16 v[168:171], a[200:203], a[104:107], v[168:171]
  v_cvt_pk_bf16_f32 v220, v160, v161
  v_cvt_pk_bf16_f32 v221, v162, v163
  v_mfma_f32_16x16x32_bf16 v[168:171], a[204:207], a[108:111], v[168:171]
  ds_read_b64_tr_b16 a[224:225], v10 offset:0
  v_cvt_pk_bf16_f32 v222, v164, v165
  v_mfma_f32_16x16x32_bf16 v[172:175], a[192:195], a[112:115], v[172:175]
  ds_read_b64_tr_b16 a[226:227], v10 offset:4608
  v_cvt_pk_bf16_f32 v223, v166, v167
  v_mfma_f32_16x16x32_bf16 v[172:175], a[196:199], a[116:119], v[172:175]
  ds_read_b64_tr_b16 a[228:229], v10 offset:9216
  buffer_store_dwordx4 v[220:223], v11, s[40:43], s97 offen sc1
  v_mfma_f32_16x16x32_bf16 v[172:175], a[200:203], a[120:123], v[172:175]
  ds_read_b64_tr_b16 a[230:231], v10 offset:13824
  v_mfma_f32_16x16x32_bf16 v[172:175], a[204:207], a[124:127], v[172:175]
  s_waitcnt lgkmcnt(4)
  ds_read_b64_tr_b16 a[232:233], v10 offset:18432
  v_mfma_f32_16x16x32_bf16 v[224:227], a[208:211], a[0:3], v[224:227]
  ds_read_b64_tr_b16 a[234:235], v10 offset:23040
  v_mfma_f32_16x16x32_bf16 v[224:227], a[212:215], a[4:7], v[224:227]
  ds_read_b64_tr_b16 a[236:237], v10 offset:27648
  ds_read_b64_tr_b16 a[238:239], v10 offset:32256
  v_mfma_f32_16x16x32_bf16 v[224:227], a[216:219], a[8:11], v[224:227]
  v_cvt_pk_bf16_f32 v208, v168, v169
  v_cvt_pk_bf16_f32 v209, v170, v171
  v_mfma_f32_16x16x32_bf16 v[224:227], a[220:223], a[12:15], v[224:227]
  v_cvt_pk_bf16_f32 v210, v172, v173
  v_mfma_f32_16x16x32_bf16 v[228:231], a[208:211], a[16:19], v[228:231]
  v_cvt_pk_bf16_f32 v211, v174, v175
  v_subrev_u32 v10, 49152, v10
  v_mfma_f32_16x16x32_bf16 v[228:231], a[212:215], a[20:23], v[228:231]
  ds_read_b64_tr_b16 a[192:193], v10 offset:32
  buffer_store_dwordx4 v[208:211], v11, s[40:43], s88 offen sc1
  v_mfma_f32_16x16x32_bf16 v[228:231], a[216:219], a[24:27], v[228:231]
  ds_read_b64_tr_b16 a[194:195], v10 offset:4640
  v_mfma_f32_16x16x32_bf16 v[228:231], a[220:223], a[28:31], v[228:231]
  s_waitcnt lgkmcnt(2)
  ds_read_b64_tr_b16 a[196:197], v10 offset:9248
  v_mfma_f32_16x16x32_bf16 v[224:227], a[224:227], a[32:35], v[224:227]
  ds_read_b64_tr_b16 a[198:199], v10 offset:13856
  v_mfma_f32_16x16x32_bf16 v[224:227], a[228:231], a[36:39], v[224:227]
  ds_read_b64_tr_b16 a[200:201], v10 offset:18464
  ds_read_b64_tr_b16 a[202:203], v10 offset:23072
  ds_read_b64_tr_b16 a[204:205], v10 offset:27680
  ds_read_b64_tr_b16 a[206:207], v10 offset:32288
  v_mfma_f32_16x16x32_bf16 v[224:227], a[232:235], a[40:43], v[224:227]
  v_add_u32 v10, 49152, v10
  v_mfma_f32_16x16x32_bf16 v[224:227], a[236:239], a[44:47], v[224:227]
  ds_read_b64_tr_b16 a[208:209], v10 offset:32
  v_mfma_f32_16x16x32_bf16 v[228:231], a[224:227], a[48:51], v[228:231]
  ds_read_b64_tr_b16 a[210:211], v10 offset:4640
  v_mfma_f32_16x16x32_bf16 v[228:231], a[228:231], a[52:55], v[228:231]
  ds_read_b64_tr_b16 a[212:213], v10 offset:9248
  v_mfma_f32_16x16x32_bf16 v[228:231], a[232:235], a[56:59], v[228:231]
  ds_read_b64_tr_b16 a[214:215], v10 offset:13856
  v_mfma_f32_16x16x32_bf16 v[228:231], a[236:239], a[60:63], v[228:231]
  s_waitcnt lgkmcnt(4)
  ds_read_b64_tr_b16 a[216:217], v10 offset:18464
  v_mfma_f32_16x16x32_bf16 v[232:235], a[192:195], a[0:3], v[232:235]
  ds_read_b64_tr_b16 a[218:219], v10 offset:23072
  v_mfma_f32_16x16x32_bf16 v[232:235], a[196:199], a[4:7], v[232:235]
  ds_read_b64_tr_b16 a[220:221], v10 offset:27680
  ds_read_b64_tr_b16 a[222:223], v10 offset:32288
  v_mfma_f32_16x16x32_bf16 v[232:235], a[200:203], a[8:11], v[232:235]
  v_subrev_u32 v10, 122880, v10
  v_mfma_f32_16x16x32_bf16 v[232:235], a[204:207], a[12:15], v[232:235]
  ds_read_b64_tr_b16 a[224:225], v10 offset:0
  v_mul_f32 v224, v224, v17
  v_mfma_f32_16x16x32_bf16 v[236:239], a[192:195], a[16:19], v[236:239]
  ds_read_b64_tr_b16 a[226:227], v10 offset:4608
  v_mul_f32 v225, v225, v17
  v_mfma_f32_16x16x32_bf16 v[236:239], a[196:199], a[20:23], v[236:239]
  ds_read_b64_tr_b16 a[228:229], v10 offset:9216
  v_mul_f32 v226, v226, v17
  v_mfma_f32_16x16x32_bf16 v[236:239], a[200:203], a[24:27], v[236:239]
  ds_read_b64_tr_b16 a[230:231], v10 offset:13824
  v_mul_f32 v227, v227, v17
  v_mfma_f32_16x16x32_bf16 v[236:239], a[204:207], a[28:31], v[236:239]
  s_waitcnt lgkmcnt(4)
  ds_read_b64_tr_b16 a[232:233], v10 offset:18432
  v_mul_f32 v228, v228, v18
  v_mfma_f32_16x16x32_bf16 v[232:235], a[208:211], a[32:35], v[232:235]
  ds_read_b64_tr_b16 a[234:235], v10 offset:23040
  v_mul_f32 v229, v229, v18
  v_mfma_f32_16x16x32_bf16 v[232:235], a[212:215], a[36:39], v[232:235]
  ds_read_b64_tr_b16 a[236:237], v10 offset:27648
  ds_read_b64_tr_b16 a[238:239], v10 offset:32256
  v_mfma_f32_16x16x32_bf16 v[232:235], a[216:219], a[40:43], v[232:235]
  s_add_u32 s28, s85, 6
  v_add_u32 v10, 36864, v10
  v_mul_f32 v230, v230, v18
  v_mfma_f32_16x16x32_bf16 v[232:235], a[220:223], a[44:47], v[232:235]
  ds_read_b64_tr_b16 a[192:193], v10 offset:0
  v_mul_f32 v231, v231, v18
  v_mfma_f32_16x16x32_bf16 v[236:239], a[208:211], a[48:51], v[236:239]
  ds_read_b64_tr_b16 a[194:195], v10 offset:4608
  v_mov_b32 v55, s28
  v_mfma_f32_16x16x32_bf16 v[236:239], a[212:215], a[52:55], v[236:239]
  ds_read_b64_tr_b16 a[196:197], v10 offset:9216
  v_cmp_eq_u32 vcc, 0, v0
  v_mfma_f32_16x16x32_bf16 v[236:239], a[216:219], a[56:59], v[236:239]
  ds_read_b64_tr_b16 a[198:199], v10 offset:13824
  v_or_b32 v51, 0x7f000000, v60
  v_mfma_f32_16x16x32_bf16 v[236:239], a[220:223], a[60:63], v[236:239]
  s_waitcnt lgkmcnt(4)
  ds_read_b64_tr_b16 a[200:201], v10 offset:18432
  v_cndmask_b32 v51, v51, 0, vcc
  v_mfma_f32_16x16x32_bf16 v[224:227], a[224:227], a[64:67], v[224:227]
  ds_read_b64_tr_b16 a[202:203], v10 offset:23040
  v_mfma_f32_16x16x32_bf16 v[224:227], a[228:231], a[68:71], v[224:227]
  ds_read_b64_tr_b16 a[204:205], v10 offset:27648
  ds_read_b64_tr_b16 a[206:207], v10 offset:32256
  v_mfma_f32_16x16x32_bf16 v[224:227], a[232:235], a[72:75], v[224:227]
  s_waitcnt vmcnt(0)
  v_subrev_u32 v10, 36864, v10
  v_mfma_f32_16x16x32_bf16 v[224:227], a[236:239], a[76:79], v[224:227]
  ds_read_b64_tr_b16 a[208:209], v10 offset:32
  buffer_store_dword v55, v51, s[40:43], s55 offen sc1
  v_mfma_f32_16x16x32_bf16 v[228:231], a[224:227], a[80:83], v[228:231]
  ds_read_b64_tr_b16 a[210:211], v10 offset:4640
  v_mul_f32 v232, v232, v17
  v_mfma_f32_16x16x32_bf16 v[228:231], a[228:231], a[84:87], v[228:231]
  ds_read_b64_tr_b16 a[212:213], v10 offset:9248
  v_mul_f32 v233, v233, v17
  v_mfma_f32_16x16x32_bf16 v[228:231], a[232:235], a[88:91], v[228:231]
  ds_read_b64_tr_b16 a[214:215], v10 offset:13856
  v_mul_f32 v234, v234, v17
  v_mfma_f32_16x16x32_bf16 v[228:231], a[236:239], a[92:95], v[228:231]
  s_waitcnt lgkmcnt(4)
  ds_read_b64_tr_b16 a[216:217], v10 offset:18464
  v_mul_f32 v235, v235, v17
  v_mfma_f32_16x16x32_bf16 v[224:227], a[192:195], a[96:99], v[224:227]
  ds_read_b64_tr_b16 a[218:219], v10 offset:23072
  v_mul_f32 v236, v236, v18
  v_mfma_f32_16x16x32_bf16 v[224:227], a[196:199], a[100:103], v[224:227]
  ds_read_b64_tr_b16 a[220:221], v10 offset:27680
  ds_read_b64_tr_b16 a[222:223], v10 offset:32288
  v_mfma_f32_16x16x32_bf16 v[224:227], a[200:203], a[104:107], v[224:227]
  v_mul_f32 v237, v237, v18
  v_mul_f32 v238, v238, v18
  v_mfma_f32_16x16x32_bf16 v[224:227], a[204:207], a[108:111], v[224:227]
  v_mul_f32 v239, v239, v18
  v_mfma_f32_16x16x32_bf16 v[228:231], a[192:195], a[112:115], v[228:231]
  s_waitcnt lgkmcnt(15)
  v_add_u32 v10, 36864, v10
  v_mfma_f32_16x16x32_bf16 v[228:231], a[196:199], a[116:119], v[228:231]
  ds_read_b64_tr_b16 a[224:225], v10 offset:32
  v_mfma_f32_16x16x16_bf16 v[232:235], v[118:119], v[112:113], v[232:235]
  v_mfma_f32_16x16x32_bf16 v[228:231], a[200:203], a[120:123], v[228:231]
  ds_read_b64_tr_b16 a[226:227], v10 offset:4640
  v_mfma_f32_16x16x16_bf16 v[236:239], v[118:119], v[114:115], v[236:239]
  v_mfma_f32_16x16x32_bf16 v[228:231], a[204:207], a[124:127], v[228:231]
  s_waitcnt lgkmcnt(2)
  ds_read_b64_tr_b16 a[228:229], v10 offset:9248
  v_mfma_f32_16x16x32_bf16 v[232:235], a[208:211], a[64:67], v[232:235]
  ds_read_b64_tr_b16 a[230:231], v10 offset:13856
  v_mfma_f32_16x16x32_bf16 v[232:235], a[212:215], a[68:71], v[232:235]
  ds_read_b64_tr_b16 a[232:233], v10 offset:18464
  ds_read_b64_tr_b16 a[234:235], v10 offset:23072
  ds_read_b64_tr_b16 a[236:237], v10 offset:27680
  ds_read_b64_tr_b16 a[238:239], v10 offset:32288
  v_mfma_f32_16x16x32_bf16 v[232:235], a[216:219], a[72:75], v[232:235]
  v_mfma_f32_16x16x32_bf16 v[232:235], a[220:223], a[76:79], v[232:235]
  v_mfma_f32_16x16x32_bf16 v[236:239], a[208:211], a[80:83], v[236:239]
  s_waitcnt lgkmcnt(15)
  v_mfma_f32_16x16x32_bf16 v[236:239], a[212:215], a[84:87], v[236:239]
  v_mfma_f32_16x16x16_bf16 v[224:227], v[116:117], v[112:113], v[224:227]
  v_mfma_f32_16x16x32_bf16 v[236:239], a[216:219], a[88:91], v[236:239]
  v_mfma_f32_16x16x16_bf16 v[228:231], v[116:117], v[114:115], v[228:231]
  v_mfma_f32_16x16x32_bf16 v[236:239], a[220:223], a[92:95], v[236:239]
  s_waitcnt lgkmcnt(0)
  v_mfma_f32_16x16x32_bf16 v[232:235], a[224:227], a[96:99], v[232:235]
  v_mfma_f32_16x16x32_bf16 v[232:235], a[228:231], a[100:103], v[232:235]
  v_mfma_f32_16x16x32_bf16 v[232:235], a[232:235], a[104:107], v[232:235]
  v_mfma_f32_16x16x32_bf16 v[232:235], a[236:239], a[108:111], v[232:235]
  v_mfma_f32_16x16x32_bf16 v[236:239], a[224:227], a[112:115], v[236:239]
  v_mfma_f32_16x16x32_bf16 v[236:239], a[228:231], a[116:119], v[236:239]
  v_mfma_f32_16x16x32_bf16 v[236:239], a[232:235], a[120:123], v[236:239]
  v_mfma_f32_16x16x32_bf16 v[236:239], a[236:239], a[124:127], v[236:239]
  s_barrier
  s_mov_b32 s29, 0x20000
  buffer_load_dword v20, v59, s[40:43], 0 offen sc1
  s_sleep 2
  buffer_load_dword v22, v59, s[40:43], 0 offen sc1
  s_sleep 2
  buffer_load_dword v23, v59, s[40:43], 0 offen sc1
L_fp_23:
  s_waitcnt vmcnt(2)
  v_subrev_u32 v21, v55, v20
  v_cmp_gt_u32 vcc, 2, v21
  buffer_load_dword v20, v59, s[40:43], 0 offen sc1
  s_and_b32 s83, vcc_lo, 15
  s_cmp_eq_u32 s83, 15
  s_cbranch_scc1 L_fo_24
  s_waitcnt vmcnt(2)
  v_subrev_u32 v21, v55, v22
  v_cmp_gt_u32 vcc, 2, v21
  buffer_load_dword v22, v59, s[40:43], 0 offen sc1
  s_and_b32 s83, vcc_lo, 15
  s_cmp_eq_u32 s83, 15
  s_cbranch_scc1 L_fo_24
  s_waitcnt vmcnt(2)
  v_subrev_u32 v21, v55, v23
  v_cmp_gt_u32 vcc, 2, v21
  buffer_load_dword v23, v59, s[40:43], 0 offen sc1
  s_and_b32 s83, vcc_lo, 15
  s_cmp_eq_u32 s83, 15
  s_cbranch_scc1 L_fo_24
  s_sub_u32 s29, s29, 1
  s_cmp_lg_u32 s29, 0
  s_cbranch_scc1 L_fp_23
L_fo_24:
  buffer_load_dwordx4 v[144:147], v56, s[40:43], s65 offen offset:0 sc1
  buffer_load_dwordx4 v[148:151], v56, s[40:43], s66 offen offset:0 sc1
  buffer_load_dwordx4 v[152:155], v56, s[40:43], s67 offen offset:0 sc1
  buffer_load_dwordx4 v[156:159], v56, s[40:43], s65 offen offset:1024 sc1
  buffer_load_dwordx4 v[176:179], v56, s[40:43], s66 offen offset:1024 sc1
  buffer_load_dwordx4 v[180:183], v56, s[40:43], s67 offen offset:1024 sc1
  buffer_load_dwordx4 v[184:187], v14, s[40:43], s65 offen offset:2048 sc1
  buffer_load_dwordx4 v[188:191], v14, s[40:43], s66 offen offset:2048 sc1
  buffer_load_dwordx4 v[112:115], v14, s[40:43], s67 offen offset:2048 sc1
  s_waitcnt vmcnt(8)
  v_mfma_f32_16x16x32_bf16 v[224:227], v[96:99], v[144:147], v[224:227]
  v_mfma_f32_16x16x32_bf16 v[228:231], v[100:103], v[144:147], v[228:231]
  s_waitcnt vmcnt(7)
  v_mfma_f32_16x16x32_bf16 v[224:227], v[96:99], v[148:151], v[224:227]
  v_mfma_f32_16x16x32_bf16 v[228:231], v[100:103], v[148:151], v[228:231]
  s_waitcnt vmcnt(6)
  v_mfma_f32_16x16x32_bf16 v[224:227], v[96:99], v[152:155], v[224:227]
  v_mfma_f32_16x16x32_bf16 v[228:231], v[100:103], v[152:155], v[228:231]
  s_waitcnt vmcnt(5)
  v_mfma_f32_16x16x32_bf16 v[232:235], v[96:99], v[156:159], v[232:235]
  v_mfma_f32_16x16x32_bf16 v[236:239], v[100:103], v[156:159], v[236:239]
  s_waitcnt vmcnt(4)
  v_mfma_f32_16x16x32_bf16 v[232:235], v[96:99], v[176:179], v[232:235]
  v_mfma_f32_16x16x32_bf16 v[236:239], v[100:103], v[176:179], v[236:239]
  s_waitcnt vmcnt(3)
  v_mfma_f32_16x16x32_bf16 v[232:235], v[96:99], v[180:183], v[232:235]
  v_mfma_f32_16x16x32_bf16 v[236:239], v[100:103], v[180:183], v[236:239]
  s_waitcnt vmcnt(2)
  v_mfma_f32_16x16x32_bf16 v[240:243], v[96:99], v[184:187], v[240:243]
  v_mfma_f32_16x16x32_bf16 v[244:247], v[100:103], v[184:187], v[244:247]
  s_waitcnt vmcnt(1)
  v_mfma_f32_16x16x32_bf16 v[240:243], v[96:99], v[188:191], v[240:243]
  v_mfma_f32_16x16x32_bf16 v[244:247], v[100:103], v[188:191], v[244:247]
  s_waitcnt vmcnt(0)
  v_mfma_f32_16x16x32_bf16 v[240:243], v[96:99], v[112:115], v[240:243]
  v_mfma_f32_16x16x32_bf16 v[244:247], v[100:103], v[112:115], v[244:247]
  v_cvt_pk_bf16_f32 v224, v224, v225
  v_cvt_pk_bf16_f32 v225, v226, v227
  ds_write_b64 v198, v[224:225] offset:0
  v_cvt_pk_bf16_f32 v228, v228, v229
  v_cvt_pk_bf16_f32 v229, v230, v231
  ds_write_b64 v198, v[228:229] offset:1792
  v_cvt_pk_bf16_f32 v232, v232, v233
  v_cvt_pk_bf16_f32 v233, v234, v235
  ds_write_b64 v198, v[232:233] offset:32
  v_cvt_pk_bf16_f32 v236, v236, v237
  v_cvt_pk_bf16_f32 v237, v238, v239
  ds_write_b64 v198, v[236:237] offset:1824
  v_cvt_pk_bf16_f32 v240, v240, v241
  v_cvt_pk_bf16_f32 v241, v242, v243
  ds_write_b64 v198, v[240:241] offset:64
  v_cvt_pk_bf16_f32 v244, v244, v245
  v_cvt_pk_bf16_f32 v245, v246, v247
  ds_write_b64 v198, v[244:245] offset:1856
  ds_read_b128 v[80:83], v199
  ds_read_b128 v[84:87], v200
  ds_read_b128 v[88:91], v201
  s_waitcnt lgkmcnt(2)
  buffer_store_dwordx4 v[80:83], v202, s[32:35], 0 offen sc1
  s_waitcnt lgkmcnt(1)
  buffer_store_dwordx4 v[84:87], v203, s[32:35], 0 offen sc1
  s_waitcnt lgkmcnt(0)
  buffer_store_dwordx4 v[88:91], v204, s[32:35], 0 offen sc1
  s_endpgm
L_slow_5:
  s_mov_b32 s30, 0x40000
L_lp_6:
  s_sleep 1
  buffer_load_dword v55, v59, s[36:39], 0 offen sc1
  s_waitcnt vmcnt(0)
  v_readfirstlane_b32 s85, v55
  s_nop 1
  s_cmp_lg_u32 s85, 0
  s_cbranch_scc1 L_ok_4
  s_sub_u32 s30, s30, 1
  s_cmp_lg_u32 s30, 0
  s_cbranch_scc1 L_lp_6
  s_branch L_ok_4
L_slow_9:
  s_mov_b32 s30, 0x40000
L_lp_10:
  s_sleep 1
  buffer_load_dword v20, v21, s[40:43], 0 offen sc1
  s_waitcnt vmcnt(0)
  v_subrev_u32 v20, s85, v20
  v_add_u32 v20, -1, v20
  v_cmp_gt_u32 s[22:23], 7, v20
  s_nop 1
  s_and_b32 s29, s22, 0xff
  s_cmp_eq_u32 s29, 0xff
  s_cbranch_scc1 L_ok_8
  s_sub_u32 s30, s30, 1
  s_cmp_lg_u32 s30, 0
  s_cbranch_scc1 L_lp_10
  s_branch L_ok_8
L_slow_12:
  s_mov_b32 s30, 0x40000
L_lp_13:
  s_sleep 1
  buffer_load_dword v55, v59, s[40:43], 0 offen sc1
  s_waitcnt vmcnt(0)
  v_subrev_u32 v55, s85, v55
  v_add_u32 v55, -2, v55
  v_cmp_gt_u32 s[22:23], 6, v55
  s_nop 1
  s_and_b32 s29, s22, 0xff
  s_cmp_eq_u32 s29, 0xff
  s_cbranch_scc1 L_ok_11
  s_sub_u32 s30, s30, 1
  s_cmp_lg_u32 s30, 0
  s_cbranch_scc1 L_lp_13
  s_branch L_ok_11
L_slow_15:
  s_mov_b32 s30, 0x40000
L_lp_16:
  s_sleep 1
  buffer_load_dword v20, v21, s[40:43], 0 offen sc1
  s_waitcnt vmcnt(0)
  v_subrev_u32 v20, s85, v20
  v_add_u32 v20, -3, v20
  v_cmp_gt_u32 s[22:23], 5, v20
  s_nop 1
  s_and_b32 s29, s22, 0xff
  s_cmp_eq_u32 s29, 0xff
  s_cbranch_scc1 L_ok_14
  s_sub_u32 s30, s30, 1
  s_cmp_lg_u32 s30, 0
  s_cbranch_scc1 L_lp_16
  s_branch L_ok_14
L_slow_18:
  s_mov_b32 s30, 0x40000
L_lp_19:
  s_sleep 1
  buffer_load_dword v20, v21, s[40:43], 0 offen sc1
  s_waitcnt vmcnt(0)
  v_subrev_u32 v20, s85, v20
  v_add_u32 v20, -4, v20
  v_cmp_gt_u32 s[22:23], 4, v20
  s_nop 1
  s_and_b32 s29, s22, 0xff
  s_cmp_eq_u32 s29, 0xff
  s_cbranch_scc1 L_ok_17
  s_sub_u32 s30, s30, 1
  s_cmp_lg_u32 s30, 0
  s_cbranch_scc1 L_lp_19
  s_branch L_ok_17
L_slow_21:
  s_mov_b32 s30, 0x40000
L_lp_22:
  s_sleep 1
  buffer_load_dword v20, v21, s[40:43], 0 offen sc1
  s_waitcnt vmcnt(0)
  v_subrev_u32 v20, s85, v20
  v_add_u32 v20, -5, v20
  v_cmp_gt_u32 s[22:23], 3, v20
  s_nop 1
  s_and_b32 s29, s22, 0xff
  s_cmp_eq_u32 s29, 0xff
  s_cbranch_scc1 L_ok_20
  s_sub_u32 s30, s30, 1
  s_cmp_lg_u32 s30, 0
  s_cbranch_scc1 L_lp_22
  s_branch L_ok_20
L_end:
  s_endpgm
.section .rodata,"a"
.p2align 6
.amdhsa_kernel gated_mix__linear_attn_block__glu_gated_bilinear__prompt_kernel
  .amdhsa_next_free_vgpr 512
  .amdhsa_next_free_sgpr 102
  .amdhsa_accum_offset 256
  .amdhsa_float_denorm_mode_32 3
  .amdhsa_group_segment_fixed_size 0
  .amdhsa_kernarg_size 88
  .amdhsa_user_sgpr_count 2
  .amdhsa_user_sgpr_kernarg_segment_ptr 1
  .amdhsa_system_sgpr_workgroup_id_x 1
.end_amdhsa_kernel
```
